```python
import torch

def _softmax(x, axis=-1):
    return torch.softmax(x, dim=axis)
def _gelu(x):
    return torch.nn.functional.gelu(x, approximate="tanh")
def _silu(x):
    return torch.nn.functional.silu(x)
def _sigmoid(x):
    return torch.sigmoid(x)
def _layernorm(x, axis=-1, eps=1e-5):
    m = x.mean(dim=axis, keepdim=True)
    v = x.var(dim=axis, keepdim=True, unbiased=False)
    return (x - m) / torch.sqrt(v + eps)
def _scatter_add(tgt, idx, src, axis=0):
    return tgt.clone().index_add_(axis, idx, src)
def _segment_sum(src, seg, n):
    out = torch.zeros((n,) + src.shape[1:], dtype=src.dtype)
    return out.index_add_(0, seg, src)
def _pad(x, pw):
    flat = tuple(v for pair in reversed(pw) for v in pair)
    return torch.nn.functional.pad(x, flat)

kernel_name = 'standalone__adm_resblock__diffusion'

def setup_inputs():

    _w = (lambda a: (lambda t: t.to(torch.bfloat16) if t.is_floating_point() else t)(torch.as_tensor(a)))
    B, C, HW, E = 2, 320, 64, 384
    sc = (9.0 * C) ** -0.5
    return {
        "x": _w((lambda *s: torch.randn(*s, dtype=torch.bfloat16) * 0.05)(B, C, HW, HW)),
        "t_emb": _w((lambda *s: torch.randn(*s, dtype=torch.bfloat16) * 0.4)(B, E)),
        "g1": _w(1.0 + 0.1 * (lambda *s: torch.randn(*s, dtype=torch.bfloat16) * 0.4)(C)),
        "be1": _w(0.1 * (lambda *s: torch.randn(*s, dtype=torch.bfloat16) * 0.4)(C)),
        "w1": _w((lambda *s: torch.randn(*s, dtype=torch.bfloat16) * 0.4)(C, C, 3, 3) * sc),
        "w_emb": _w((lambda *s: torch.randn(*s, dtype=torch.bfloat16) * 0.4)(E, C) * (E ** -0.5)),
        "g2": _w(1.0 + 0.1 * (lambda *s: torch.randn(*s, dtype=torch.bfloat16) * 0.4)(C)),
        "be2": _w(0.1 * (lambda *s: torch.randn(*s, dtype=torch.bfloat16) * 0.4)(C)),
        "w2": _w((lambda *s: torch.randn(*s, dtype=torch.bfloat16) * 0.4)(C, C, 3, 3) * sc),
    }

def reference(x, t_emb, g1, be1, w1, w_emb, g2, be2, w2):
    B, C, H, W = x.shape
    G, eps = 4, 1e-5
    def gn(z, gamma, beta):
        zr = z.reshape(B, G, (C // G) * H * W)
        mu = zr.mean(-1).reshape(B, G, 1)
        var = ((zr - mu) ** 2).mean(-1).reshape(B, G, 1)
        zn = ((zr - mu) / torch.sqrt(var + eps)).reshape(B, C, H, W)
        return zn * gamma.reshape(1, C, 1, 1) + beta.reshape(1, C, 1, 1)
    def conv3(z, w):
        zp = _pad(z, ((0, 0), (0, 0), (1, 1), (1, 1)))
        taps = [torch.einsum("bchw,oc->bohw", zp[:, :, i:i+H, j:j+W], w[:, :, i, j]) for i in range(3) for j in range(3)]
        out = taps[0]
        for t in taps[1:]:
            out = out + t
        return out
    h = conv3(_silu(gn(x, g1, be1)), w1)
    emb = _silu(t_emb) @ w_emb
    h = h + emb.reshape(B, C, 1, 1)
    h = conv3(_silu(gn(h, g2, be2)), w2)
    return x + h
```

```asm
; @launch grid=(256,1,1) block=(256,1,1) lds=163840
.amdgcn_target "amdgcn-amd-amdhsa--gfx950"
.text
.globl standalone__adm_resblock__diffusion_kernel
.p2align 8
.type standalone__adm_resblock__diffusion_kernel,@function
standalone__adm_resblock__diffusion_kernel:
  s_cmpk_ge_u32 s2, 256
  s_cbranch_scc1 L_exit
  s_load_dwordx16 s[4:19], s[0:1], 0
  s_load_dwordx8 s[20:27], s[0:1], 64
  v_lshrrev_b32 v20, 6, v0
  v_and_b32 v1, 63, v0
  v_readfirstlane_b32 s44, v20
  s_getpc_b64 s[70:71]
L_pc:
  s_and_b32 s65, s2, 0xf8
  s_lshl_b32 s65, s65, 8
  v_and_b32 v23, 0xf0, v0
  v_lshl_add_u32 v23, v23, 3, s65
  v_min_u32 v23, L_end-L_pc, v23
  global_load_dword v215, v23, s[70:71]
  s_and_b32 s46, s2, 3
  s_bfe_u32 s45, s2, 0x10002
  s_and_b32 s54, s2, 7
  s_bfe_u32 s48, s2, 0x10003
  s_lshr_b32 s47, s2, 5
  s_lshl_b32 s47, s47, 3
  s_lshl_b32 s48, s48, 4
  s_lshr_b32 s3, s2, 2
  s_and_b32 s63, s3, -2
  s_and_b32 s65, s44, 1
  s_add_u32 s63, s63, s65
  s_lshr_b32 s72, s44, 1
  s_mul_i32 s73, s54, 10
  s_add_u32 s73, s73, s72
  s_lshl_b32 s69, s73, 9
  s_add_u32 s69, s69, s63
  s_lshl_b32 s69, s69, 7
  v_lshlrev_b32 v2, 4, v1
  s_mul_i32 s50, s44, 40960
  v_lshrrev_b32 v21, 3, v1
  v_and_b32 v22, 0x70, v2
  v_lshl_add_u32 v21, v21, 13, v22
  s_mov_b32 s34, 5242880
  s_mov_b32 s35, 0x20000
  s_movk_i32 s42, 640
  s_mov_b32 s43, 0x20000
  s_lshl_b32 s65, s54, 5
  s_lshr_b32 s66, s3, 1
  s_add_u32 s65, s65, s66
  s_lshl2_add_u32 s66, s65, s44
  s_lshl_b32 s66, s66, 7
  s_add_u32 s66, s66, 15990784
  s_lshl_b32 s67, s44, 9
  s_min_u32 s67, s67, 0x500
  s_add_u32 s65, s65, s67
  s_lshl_b32 s65, s65, 7
  s_add_u32 s65, s65, 15728640
  v_cmp_gt_u32 vcc, 4, v1
  v_lshl_add_u32 v155, v1, 17, s66
  v_mov_b32 v154, s65
  v_cndmask_b32 v154, v154, v155, vcc
  s_mov_b32 s67, 16531456
  v_writelane_b32 v154, s67, 63
  s_mov_b32 s30, 33554432
  s_mov_b32 s31, 0x20000
  v_add_u32 v191, 0, v1
  v_mul_u32_u24 v188, 7282, v191
  v_lshrrev_b32 v188, 16, v188
  v_mad_i32_i24 v191, v188, -9, v191
  v_add_u32 v192, 64, v1
  v_mul_u32_u24 v189, 7282, v192
  v_lshrrev_b32 v189, 16, v189
  v_mad_i32_i24 v192, v189, -9, v192
  v_add_u32 v193, 128, v1
  v_mul_u32_u24 v190, 7282, v193
  v_lshrrev_b32 v190, 16, v190
  v_mad_i32_i24 v193, v190, -9, v193
  s_waitcnt lgkmcnt(0)
  s_mov_b64 s[32:33], s[4:5]
  s_mov_b64 s[28:29], s[26:27]
  buffer_load_dword v142, v154, s[28:31], 0 offen sc1
  s_add_u32 m0, s50, 0
  s_mov_b64 s[40:41], s[8:9]
  buffer_load_dwordx4 v2, s[40:43], 0 offen lds
  s_addk_i32 m0, 1024
  s_mov_b64 s[40:41], s[10:11]
  buffer_load_dwordx4 v2, s[40:43], 0 offen lds
  s_add_u32 m0, s50, 4096
  s_nop 0
  buffer_load_dwordx4 v21, s[32:35], s69 offen lds
  s_addk_i32 m0, 1024
  s_add_u32 s69, s69, 131072
  buffer_load_dwordx4 v21, s[32:35], s69 offen lds
  s_addk_i32 m0, 1024
  s_add_u32 s69, s69, 131072
  buffer_load_dwordx4 v21, s[32:35], s69 offen lds
  s_addk_i32 m0, 1024
  s_add_u32 s69, s69, 131072
  buffer_load_dwordx4 v21, s[32:35], s69 offen lds
  s_addk_i32 m0, 1024
  s_add_u32 s69, s69, 131072
  buffer_load_dwordx4 v21, s[32:35], s69 offen lds
  s_mul_i32 s65, s3, 205
  s_lshr_b32 s65, s65, 11
  s_mul_i32 s66, s65, 10
  s_sub_u32 s66, s3, s66
  s_lshl2_add_u32 s66, s66, s44
  s_lshr_b32 s67, s65, 1
  s_and_b32 s68, s65, 1
  s_lshl3_add_u32 s67, s67, s68
  s_lshl2_add_u32 s67, s67, 16
  s_cmp_lt_u32 s65, 4
  s_cselect_b32 s70, 12, 0
  s_cselect_b32 s67, s67, 0
  s_mul_i32 s68, s46, 80
  s_add_u32 s67, s67, s68
  s_mul_i32 s67, s67, 40
  s_add_u32 s67, s67, s66
  s_mul_i32 s67, s67, 144
  s_cmp_ge_u32 s3, 50
  s_cmov_b32 s67, 0x80000000
  s_movk_i32 s68, 360
  v_and_b32 v246, s70, v188
  v_add_u32 v246, v246, v188
  v_mad_u32_u24 v246, v246, s68, v191
  v_lshl_add_u32 v246, v246, 4, s67
  v_and_b32 v247, s70, v189
  v_add_u32 v247, v247, v189
  v_mad_u32_u24 v247, v247, s68, v192
  v_lshl_add_u32 v247, v247, 4, s67
  v_and_b32 v248, s70, v190
  v_add_u32 v248, v248, v190
  v_mad_u32_u24 v248, v248, s68, v193
  v_lshl_add_u32 v248, v248, 4, s67
  s_barrier
  s_add_u32 m0, s50, 9216
  s_mov_b64 s[40:41], s[12:13]
  s_mov_b32 s42, 1843200
  buffer_load_dwordx4 v246, s[40:43], 0 offen lds
  s_addk_i32 m0, 1024
  s_nop 0
  buffer_load_dwordx4 v247, s[40:43], 0 offen lds
  s_addk_i32 m0, 1024
  s_mov_b64 exec, 0xffff
  buffer_load_dwordx4 v248, s[40:43], 0 offen lds
  s_mov_b64 exec, -1
  s_add_u32 m0, s50, 2048
  s_mov_b64 s[40:41], s[16:17]
  s_mov_b32 s42, 640
  buffer_load_dwordx4 v2, s[40:43], 0 offen lds
  s_addk_i32 m0, 1024
  s_mov_b64 s[40:41], s[18:19]
  buffer_load_dwordx4 v2, s[40:43], 0 offen lds
  s_getpc_b64 s[70:71]
  s_add_u32 s70, s70, dma_slots@rel32@lo+4
  s_addc_u32 s71, s71, dma_slots@rel32@hi+12
  s_bfe_u32 s67, s2, 0x20003
  s_mulk_i32 s67, 1536
  v_add_u32 v216, s67, v2
  v_lshl_add_u32 v217, v1, 3, s67
  global_load_dwordx4 v[4:7], v216, s[70:71]
  global_load_dwordx2 v[8:9], v217, s[70:71] offset:1024
  s_mov_b32 s36, s22
  s_mov_b32 s37, s23
  s_mov_b32 s38, 5242880
  s_mov_b32 s39, 0x20000
  s_mov_b32 s23, 0xffff0000
  s_brev_b32 s25, 1
  s_mov_b32 s9, 0
  s_mov_b32 s56, 0xbfb8aa3b
  s_bfe_u32 s16, s2, 0x10004
  s_cselect_b32 s17, -1, 1
  v_and_b32 v19, 48, v1
  s_mul_i32 s67, s66, 205
  s_lshr_b32 s67, s67, 11
  s_mul_i32 s68, s67, 10
  s_sub_u32 s68, s66, s68
  s_mul_i32 s70, s68, 5
  s_add_u32 s70, s70, s65
  s_mul_i32 s70, s70, 12
  s_add_u32 s70, s70, s67
  s_mul_i32 s67, s46, 2400
  s_add_u32 s70, s70, s67
  s_lshl_b32 s5, s70, 8
  s_cmp_ge_u32 s3, 50
  s_cselect_b32 s67, s25, 0
  v_and_b32 v250, 15, v1
  v_mul_u32_u24 v212, 9600, v19
  v_lshl_add_u32 v212, v250, 4, v212
  v_or_b32 v212, s67, v212
  v_lshrrev_b32 v249, 2, v19
  v_lshl_add_u32 v249, v250, 4, v249
  s_add_u32 s67, s50, 9216
  v_mad_u32_u24 v249, v249, 9, s67
  s_mov_b32 s4, 0x44800000
  s_mov_b32 s12, 0x44000000
  s_cmp_ge_u32 s3, 50
  s_cbranch_scc1 L_tl_emb
  s_mul_i32 s65, s3, 205
  s_lshr_b32 s65, s65, 11
  s_mul_i32 s66, s65, 10
  s_sub_u32 s66, s3, s66
  s_lshl2_add_u32 s66, s66, s44
  s_lshl_b32 s67, s65, 4
  s_mul_i32 s68, s46, 80
  s_add_u32 s67, s67, s68
  s_mul_i32 s67, s67, 40
  s_add_u32 s67, s67, s66
  s_mul_i32 s67, s67, 144
  s_cmp_ge_u32 s3, 50
  s_cmov_b32 s67, 0x80000000
  s_movk_i32 s68, 360
  v_mad_u32_u24 v246, v188, s68, v191
  v_lshl_add_u32 v246, v246, 4, s67
  v_mad_u32_u24 v247, v189, s68, v192
  v_lshl_add_u32 v247, v247, 4, s67
  v_mad_u32_u24 v248, v190, s68, v193
  v_lshl_add_u32 v248, v248, 4, s67
  s_add_u32 m0, s50, 12288
  s_mov_b64 s[40:41], s[20:21]
  s_mov_b32 s42, 1843200
  buffer_load_dwordx4 v246, s[40:43], 0 offen lds
  s_addk_i32 m0, 1024
  s_nop 0
  buffer_load_dwordx4 v247, s[40:43], 0 offen lds
  s_addk_i32 m0, 1024
  s_mov_b64 exec, 0xffff
  buffer_load_dwordx4 v248, s[40:43], 0 offen lds
  s_mov_b64 exec, -1
  v_bfrev_b32 v213, 1
L_tl_done:
  s_mul_i32 s96, s72, 512
  s_lshl2_add_u32 s96, s63, s96
  s_lshl_b32 s96, s96, 7
  s_mul_i32 s11, s54, 657408
  s_add_u32 s96, s96, s11
  s_add_u32 s96, s96, 16781312
  s_lshl_b32 s11, s54, 6
  s_add_u32 s11, s11, s63
  s_lshl1_add_u32 s11, s11, s72
  s_lshl_b32 s11, s11, 7
  s_add_u32 s11, s11, 15990784
  s_mul_i32 s69, s46, 160
  s_lshl4_add_u32 s69, s72, s69
  s_add_u32 s69, s69, s50
  v_lshrrev_b32 v26, 5, v1
  v_add_u32 v21, s50, v2
  v_lshl_add_u32 v22, v26, 3, s69
  v_and_b32 v25, 31, v1
  v_lshl_add_u32 v25, v26, 7, v25
  v_lshl_add_u32 v25, v25, 2, s50
  v_add_u32 v26, 128, v25
  s_lshl2_add_u32 s70, s46, s44
  s_mul_i32 s61, s70, 153600
  s_mul_i32 s70, s16, 6144
  s_add_u32 s61, s61, s70
  s_sub_u32 s18, 12288, s70
  v_add_u32 v13, 1024, v2
  s_lshl_b32 s70, s17, 10
  v_subrev_u32 v10, s70, v13
  v_add_u32 v14, s70, v13
  s_cmp_eq_u32 s44, 1
  s_mov_b32 s53, 0xbc00bc00
  s_cmov_b32 s53, 0x3c003c00
  s_mul_i32 s70, s44, 5120
  v_add_u32 v3, s70, v2
  v_add_u32 v27, 81920, v3
  v_lshrrev_b32 v216, 5, v1
  v_bfe_u32 v217, v1, 4, 1
  v_lshlrev_b32 v218, 4, v250
  v_mul_u32_u24 v219, 2560, v19
  v_add_u32 v219, v219, v218
  s_lshl_b32 s70, s44, 3
  s_lshr_b32 s71, 0x14041403, s70
  s_and_b32 s71, s71, 0xff
  s_lshr_b32 s70, 0x15140404, s70
  s_and_b32 s70, s70, 0xff
  v_lshl_add_u32 v11, s71, 4, v219
  v_lshl_add_u32 v12, s70, 4, v219
  s_movk_i32 s70, 4096
  v_mad_u32_u24 v15, v19, s70, v218
  s_mov_b32 s70, 65536
  v_mad_u32_u24 v16, v216, s70, v218
  v_lshl_add_u32 v16, v217, 8, v16
  v_lshl_add_u32 v17, v216, 8, v218
  v_lshl_add_u32 v17, v217, 15, v17
  s_lshr_b32 s65, s47, 0
  v_min_u32 v216, 19, v1
  v_lshrrev_b32 v217, 1, v216
  v_add3_u32 v217, v217, s65, -1
  v_med3_i32 v217, v217, 0, 63
  v_and_b32 v216, 1, v216
  v_lshl_add_u32 v217, v217, 1, v216
  s_lshl2_add_u32 s65, s45, s44
  s_lshl_b32 s65, s65, 14
  v_lshl_add_u32 v18, v217, 7, s65
  s_lshl_b32 s13, s46, 13
  s_lshl_b32 s68, s3, 7
  s_cmp_lg_u32 s44, 0
  s_cmov_b32 s68, s25
  v_mov_b32 v251, s68
  s_add_u32 s51, s13, 15859712
  s_waitcnt vmcnt(15)
  v_readlane_b32 s49, v142, 63
  ds_read_b128 v[164:167], v21
  ds_read_b128 v[252:255], v21 offset:1024
  ds_read_b64 v[132:133], v22 offset:0
  ds_read_b64 v[134:135], v22 offset:32
  ds_read_b64 v[136:137], v22 offset:64
  ds_read_b64 v[138:139], v22 offset:96
  ds_read_b64 v[140:141], v22 offset:128
  ds_read_b64 v[144:145], v22 offset:1024
  ds_read_b64 v[146:147], v22 offset:1056
  ds_read_b64 v[148:149], v22 offset:1088
  ds_read_b64 v[150:151], v22 offset:1120
  ds_read_b64 v[152:153], v22 offset:1152
  s_mul_i32 s49, s49, 0x2c9277b5
  s_add_u32 s49, s49, 0xac564b05
  v_mov_b32 v0, s49
  s_getreg_b32 s94, hwreg(HW_REG_XCC_ID, 0, 4)
  s_add_u32 s94, s94, s49
  s_waitcnt lgkmcnt(10)
  s_waitcnt lgkmcnt(0)
  v_lshlrev_b32 v48, 16, v132
  v_and_b32 v49, s23, v132
  v_lshlrev_b32 v50, 16, v133
  v_and_b32 v51, s23, v133
  v_lshlrev_b32 v52, 16, v134
  v_and_b32 v53, s23, v134
  v_lshlrev_b32 v54, 16, v135
  v_and_b32 v55, s23, v135
  v_lshlrev_b32 v56, 16, v136
  v_and_b32 v57, s23, v136
  v_lshlrev_b32 v58, 16, v137
  v_and_b32 v59, s23, v137
  v_lshlrev_b32 v60, 16, v138
  v_and_b32 v61, s23, v138
  v_lshlrev_b32 v62, 16, v139
  v_and_b32 v63, s23, v139
  v_lshlrev_b32 v64, 16, v140
  v_and_b32 v65, s23, v140
  v_lshlrev_b32 v66, 16, v141
  v_and_b32 v67, s23, v141
  s_lshl_b32 s58, s54, 12
  s_add_u32 s58, s58, 15728640
  s_lshr_b32 s68, s3, 1
  s_lshl2_add_u32 s68, s68, s44
  s_lshl4_add_u32 s69, s68, s58
  s_add_u32 s95, s69, 32768
  s_mov_b32 s93, s94
  s_waitcnt vmcnt(14)
  ds_read2st64_b32 v[108:109], v25 offset0:16 offset1:17
  ds_read2st64_b32 v[110:111], v26 offset0:16 offset1:17
  s_waitcnt vmcnt(13)
  ds_read2st64_b32 v[112:113], v25 offset0:20 offset1:21
  ds_read2st64_b32 v[114:115], v26 offset0:20 offset1:21
  s_waitcnt vmcnt(12)
  ds_read2st64_b32 v[116:117], v25 offset0:24 offset1:25
  ds_read2st64_b32 v[118:119], v26 offset0:24 offset1:25
  s_waitcnt lgkmcnt(4)
  v_lshlrev_b32 v28, 16, v108
  v_and_b32 v88, s23, v108
  v_readfirstlane_b32 s64, v28
  v_lshlrev_b32 v29, 16, v110
  v_and_b32 v89, s23, v110
  v_lshlrev_b32 v30, 16, v109
  v_and_b32 v90, s23, v109
  v_lshlrev_b32 v31, 16, v111
  v_and_b32 v91, s23, v111
  v_pk_add_f32 v[28:29], v[28:29], s[64:65] op_sel_hi:[1,0] neg_lo:[0,1] neg_hi:[0,1]
  v_pk_add_f32 v[30:31], v[30:31], s[64:65] op_sel_hi:[1,0] neg_lo:[0,1] neg_hi:[0,1]
  v_pk_add_f32 v[88:89], v[88:89], s[64:65] op_sel_hi:[1,0] neg_lo:[0,1] neg_hi:[0,1]
  v_pk_add_f32 v[90:91], v[90:91], s[64:65] op_sel_hi:[1,0] neg_lo:[0,1] neg_hi:[0,1]
  v_pk_add_f32 v[20:21], v[28:29], 0 op_sel_hi:[1,0]
  v_pk_mul_f32 v[22:23], v[28:29], v[28:29]
  v_pk_add_f32 v[20:21], v[20:21], v[30:31]
  v_pk_fma_f32 v[22:23], v[30:31], v[30:31], v[22:23]
  v_pk_add_f32 v[20:21], v[20:21], v[88:89]
  v_pk_fma_f32 v[22:23], v[88:89], v[88:89], v[22:23]
  v_pk_add_f32 v[20:21], v[20:21], v[90:91]
  v_pk_fma_f32 v[22:23], v[90:91], v[90:91], v[22:23]
  s_waitcnt vmcnt(11)
  ds_read2st64_b32 v[120:121], v25 offset0:28 offset1:29
  ds_read2st64_b32 v[122:123], v26 offset0:28 offset1:29
  s_waitcnt lgkmcnt(4)
  v_lshlrev_b32 v32, 16, v112
  v_and_b32 v92, s23, v112
  v_lshlrev_b32 v33, 16, v114
  v_and_b32 v93, s23, v114
  v_lshlrev_b32 v34, 16, v113
  v_and_b32 v94, s23, v113
  v_lshlrev_b32 v35, 16, v115
  v_and_b32 v95, s23, v115
  v_pk_add_f32 v[32:33], v[32:33], s[64:65] op_sel_hi:[1,0] neg_lo:[0,1] neg_hi:[0,1]
  v_pk_add_f32 v[34:35], v[34:35], s[64:65] op_sel_hi:[1,0] neg_lo:[0,1] neg_hi:[0,1]
  v_pk_add_f32 v[92:93], v[92:93], s[64:65] op_sel_hi:[1,0] neg_lo:[0,1] neg_hi:[0,1]
  v_pk_add_f32 v[94:95], v[94:95], s[64:65] op_sel_hi:[1,0] neg_lo:[0,1] neg_hi:[0,1]
  v_pk_add_f32 v[20:21], v[20:21], v[32:33]
  v_pk_fma_f32 v[22:23], v[32:33], v[32:33], v[22:23]
  v_pk_add_f32 v[20:21], v[20:21], v[34:35]
  v_pk_fma_f32 v[22:23], v[34:35], v[34:35], v[22:23]
  v_pk_add_f32 v[20:21], v[20:21], v[92:93]
  v_pk_fma_f32 v[22:23], v[92:93], v[92:93], v[22:23]
  v_pk_add_f32 v[20:21], v[20:21], v[94:95]
  v_pk_fma_f32 v[22:23], v[94:95], v[94:95], v[22:23]
  s_waitcnt vmcnt(10)
  ds_read2st64_b32 v[124:125], v25 offset0:32 offset1:33
  ds_read2st64_b32 v[126:127], v26 offset0:32 offset1:33
  s_waitcnt lgkmcnt(4)
  v_lshlrev_b32 v36, 16, v116
  v_and_b32 v96, s23, v116
  v_lshlrev_b32 v37, 16, v118
  v_and_b32 v97, s23, v118
  v_lshlrev_b32 v38, 16, v117
  v_and_b32 v98, s23, v117
  v_lshlrev_b32 v39, 16, v119
  v_and_b32 v99, s23, v119
  v_pk_add_f32 v[36:37], v[36:37], s[64:65] op_sel_hi:[1,0] neg_lo:[0,1] neg_hi:[0,1]
  v_pk_add_f32 v[38:39], v[38:39], s[64:65] op_sel_hi:[1,0] neg_lo:[0,1] neg_hi:[0,1]
  v_pk_add_f32 v[96:97], v[96:97], s[64:65] op_sel_hi:[1,0] neg_lo:[0,1] neg_hi:[0,1]
  v_pk_add_f32 v[98:99], v[98:99], s[64:65] op_sel_hi:[1,0] neg_lo:[0,1] neg_hi:[0,1]
  v_pk_add_f32 v[20:21], v[20:21], v[36:37]
  v_pk_fma_f32 v[22:23], v[36:37], v[36:37], v[22:23]
  v_pk_add_f32 v[20:21], v[20:21], v[38:39]
  v_pk_fma_f32 v[22:23], v[38:39], v[38:39], v[22:23]
  v_pk_add_f32 v[20:21], v[20:21], v[96:97]
  v_pk_fma_f32 v[22:23], v[96:97], v[96:97], v[22:23]
  v_pk_add_f32 v[20:21], v[20:21], v[98:99]
  v_pk_fma_f32 v[22:23], v[98:99], v[98:99], v[22:23]
  s_waitcnt lgkmcnt(2)
  v_lshlrev_b32 v40, 16, v120
  v_and_b32 v100, s23, v120
  v_lshlrev_b32 v41, 16, v122
  v_and_b32 v101, s23, v122
  v_lshlrev_b32 v42, 16, v121
  v_and_b32 v102, s23, v121
  v_lshlrev_b32 v43, 16, v123
  v_and_b32 v103, s23, v123
  v_pk_add_f32 v[40:41], v[40:41], s[64:65] op_sel_hi:[1,0] neg_lo:[0,1] neg_hi:[0,1]
  v_pk_add_f32 v[42:43], v[42:43], s[64:65] op_sel_hi:[1,0] neg_lo:[0,1] neg_hi:[0,1]
  v_pk_add_f32 v[100:101], v[100:101], s[64:65] op_sel_hi:[1,0] neg_lo:[0,1] neg_hi:[0,1]
  v_pk_add_f32 v[102:103], v[102:103], s[64:65] op_sel_hi:[1,0] neg_lo:[0,1] neg_hi:[0,1]
  v_pk_add_f32 v[20:21], v[20:21], v[40:41]
  v_pk_fma_f32 v[22:23], v[40:41], v[40:41], v[22:23]
  v_pk_add_f32 v[20:21], v[20:21], v[42:43]
  v_pk_fma_f32 v[22:23], v[42:43], v[42:43], v[22:23]
  v_pk_add_f32 v[20:21], v[20:21], v[100:101]
  v_pk_fma_f32 v[22:23], v[100:101], v[100:101], v[22:23]
  v_pk_add_f32 v[20:21], v[20:21], v[102:103]
  v_pk_fma_f32 v[22:23], v[102:103], v[102:103], v[22:23]
  s_waitcnt lgkmcnt(0)
  v_lshlrev_b32 v44, 16, v124
  v_and_b32 v104, s23, v124
  v_lshlrev_b32 v45, 16, v126
  v_and_b32 v105, s23, v126
  v_lshlrev_b32 v46, 16, v125
  v_and_b32 v106, s23, v125
  v_lshlrev_b32 v47, 16, v127
  v_and_b32 v107, s23, v127
  v_pk_add_f32 v[44:45], v[44:45], s[64:65] op_sel_hi:[1,0] neg_lo:[0,1] neg_hi:[0,1]
  v_pk_add_f32 v[46:47], v[46:47], s[64:65] op_sel_hi:[1,0] neg_lo:[0,1] neg_hi:[0,1]
  v_pk_add_f32 v[104:105], v[104:105], s[64:65] op_sel_hi:[1,0] neg_lo:[0,1] neg_hi:[0,1]
  v_pk_add_f32 v[106:107], v[106:107], s[64:65] op_sel_hi:[1,0] neg_lo:[0,1] neg_hi:[0,1]
  v_pk_add_f32 v[20:21], v[20:21], v[44:45]
  v_pk_fma_f32 v[22:23], v[44:45], v[44:45], v[22:23]
  v_pk_add_f32 v[20:21], v[20:21], v[46:47]
  v_pk_fma_f32 v[22:23], v[46:47], v[46:47], v[22:23]
  v_pk_add_f32 v[20:21], v[20:21], v[104:105]
  v_pk_fma_f32 v[22:23], v[104:105], v[104:105], v[22:23]
  v_pk_add_f32 v[20:21], v[20:21], v[106:107]
  v_pk_fma_f32 v[22:23], v[106:107], v[106:107], v[22:23]
  v_mov_b32 v129, s49
  v_mov_b32 v131, s94
  v_add_f32 v20, v20, v21
  v_add_f32 v22, v22, v23
  s_nop 1
  v_add_f32_dpp v20, v20, v20 quad_perm:[1,0,3,2] row_mask:0xf bank_mask:0xf
  v_add_f32_dpp v22, v22, v22 quad_perm:[1,0,3,2] row_mask:0xf bank_mask:0xf
  s_nop 0
  v_add_f32_dpp v20, v20, v20 quad_perm:[2,3,0,1] row_mask:0xf bank_mask:0xf
  v_add_f32_dpp v22, v22, v22 quad_perm:[2,3,0,1] row_mask:0xf bank_mask:0xf
  s_nop 0
  v_add_f32_dpp v20, v20, v20 row_half_mirror row_mask:0xf bank_mask:0xf
  v_add_f32_dpp v22, v22, v22 row_half_mirror row_mask:0xf bank_mask:0xf
  s_nop 0
  v_add_f32_dpp v20, v20, v20 row_mirror row_mask:0xf bank_mask:0xf
  v_add_f32_dpp v22, v22, v22 row_mirror row_mask:0xf bank_mask:0xf
  s_nop 0
  v_add_f32_dpp v20, v20, v20 row_bcast:15 row_mask:0xa bank_mask:0xf
  v_add_f32_dpp v22, v22, v22 row_bcast:15 row_mask:0xa bank_mask:0xf
  s_nop 0
  v_add_f32_dpp v20, v20, v20 row_bcast:31 row_mask:0xc bank_mask:0xf
  v_add_f32_dpp v22, v22, v22 row_bcast:31 row_mask:0xc bank_mask:0xf
  s_nop 0
  v_mul_f32 v20, 0x39cccccd, v20
  v_mul_f32 v22, 0x39cccccd, v22
  v_add_f32 v128, s64, v20
  v_fma_f32 v130, -v20, v20, v22
  s_mov_b32 exec_lo, 0
  s_brev_b32 exec_hi, 1
  buffer_store_dwordx4 v[128:131], off, s[28:31], s69
  s_mov_b64 exec, -1
  v_mov_b32 v24, v20
  v_readlane_b32 s67, v128, 63
  s_waitcnt vmcnt(8)
  ds_read2_b32 v[168:169], v249 offset0:0 offset1:1
  ds_read2_b32 v[170:171], v249 offset0:2 offset1:3
  ds_read2_b32 v[172:173], v249 offset0:4 offset1:5
  ds_read2_b32 v[174:175], v249 offset0:6 offset1:7
  ds_read_b32 v176, v249 offset:32
  v_pk_mul_f32 v[28:29], v[28:29], v[48:49]
  v_pk_mul_f32 v[30:31], v[30:31], v[50:51]
  v_pk_mul_f32 v[88:89], v[88:89], v[48:49]
  v_pk_mul_f32 v[90:91], v[90:91], v[50:51]
  v_pk_mul_f32 v[32:33], v[32:33], v[52:53]
  v_pk_mul_f32 v[34:35], v[34:35], v[54:55]
  v_pk_mul_f32 v[92:93], v[92:93], v[52:53]
  v_pk_mul_f32 v[94:95], v[94:95], v[54:55]
  v_pk_mul_f32 v[36:37], v[36:37], v[56:57]
  v_pk_mul_f32 v[38:39], v[38:39], v[58:59]
  v_pk_mul_f32 v[96:97], v[96:97], v[56:57]
  v_pk_mul_f32 v[98:99], v[98:99], v[58:59]
  v_pk_mul_f32 v[40:41], v[40:41], v[60:61]
  v_pk_mul_f32 v[42:43], v[42:43], v[62:63]
  v_pk_mul_f32 v[100:101], v[100:101], v[60:61]
  v_pk_mul_f32 v[102:103], v[102:103], v[62:63]
  v_pk_mul_f32 v[44:45], v[44:45], v[64:65]
  v_pk_mul_f32 v[46:47], v[46:47], v[66:67]
  v_pk_mul_f32 v[104:105], v[104:105], v[64:65]
  v_pk_mul_f32 v[106:107], v[106:107], v[66:67]
  s_waitcnt lgkmcnt(0)
  v_lshlrev_b32 v216, 16, v168
  v_and_b32 v217, s23, v172
  v_and_b32 v218, s23, v168
  v_lshlrev_b32 v219, 16, v173
  v_lshlrev_b32 v220, 16, v169
  v_and_b32 v221, s23, v173
  v_pk_add_f32 v[222:223], v[216:217], v[220:221]
  v_pk_mul_f32 v[216:217], v[216:217], s[4:5] op_sel_hi:[1,0]
  v_pk_mul_f32 v[222:223], v[222:223], s[12:13] op_sel_hi:[1,0]
  v_pk_mul_f32 v[220:221], v[220:221], s[4:5] op_sel_hi:[1,0]
  v_pk_fma_f32 v[224:225], v[218:219], s[12:13], v[222:223] op_sel_hi:[1,0,1]
  v_pk_fma_f32 v[218:219], v[218:219], s[12:13], v[222:223] op_sel_hi:[1,0,1] neg_lo:[1,0,0] neg_hi:[1,0,0]
  v_cvt_pk_f16_f32 v188, v216, v217
  v_cvt_pk_f16_f32 v189, v224, v225
  v_cvt_pk_f16_f32 v190, v218, v219
  v_cvt_pk_f16_f32 v191, v220, v221
  v_and_b32 v226, s23, v169
  v_lshlrev_b32 v227, 16, v174
  v_lshlrev_b32 v228, 16, v170
  v_and_b32 v229, s23, v174
  v_and_b32 v230, s23, v170
  v_lshlrev_b32 v231, 16, v175
  v_pk_add_f32 v[232:233], v[226:227], v[230:231]
  v_pk_mul_f32 v[226:227], v[226:227], s[4:5] op_sel_hi:[1,0]
  v_pk_mul_f32 v[232:233], v[232:233], s[12:13] op_sel_hi:[1,0]
  v_pk_mul_f32 v[230:231], v[230:231], s[4:5] op_sel_hi:[1,0]
  v_pk_fma_f32 v[234:235], v[228:229], s[12:13], v[232:233] op_sel_hi:[1,0,1]
  s_branch L_page0
.p2align 12
L_page0:
  v_pk_fma_f32 v[228:229], v[228:229], s[12:13], v[232:233] op_sel_hi:[1,0,1] neg_lo:[1,0,0] neg_hi:[1,0,0]
  v_cvt_pk_f16_f32 v192, v226, v227
  v_cvt_pk_f16_f32 v193, v234, v235
  v_cvt_pk_f16_f32 v194, v228, v229
  v_cvt_pk_f16_f32 v195, v230, v231
  v_lshlrev_b32 v236, 16, v171
  v_and_b32 v237, s23, v175
  v_and_b32 v238, s23, v171
  v_lshlrev_b32 v239, 16, v176
  v_lshlrev_b32 v240, 16, v172
  v_and_b32 v241, s23, v176
  v_pk_add_f32 v[242:243], v[236:237], v[240:241]
  v_pk_mul_f32 v[236:237], v[236:237], s[4:5] op_sel_hi:[1,0]
  v_pk_mul_f32 v[242:243], v[242:243], s[12:13] op_sel_hi:[1,0]
  v_pk_mul_f32 v[240:241], v[240:241], s[4:5] op_sel_hi:[1,0]
  v_pk_fma_f32 v[244:245], v[238:239], s[12:13], v[242:243] op_sel_hi:[1,0,1]
  v_pk_fma_f32 v[238:239], v[238:239], s[12:13], v[242:243] op_sel_hi:[1,0,1] neg_lo:[1,0,0] neg_hi:[1,0,0]
  v_cvt_pk_f16_f32 v196, v236, v237
  v_cvt_pk_f16_f32 v197, v244, v245
  v_cvt_pk_f16_f32 v198, v238, v239
  v_cvt_pk_f16_f32 v199, v240, v241
  v_permlane32_swap_b32 v188, v190
  v_permlane32_swap_b32 v189, v191
  v_permlane32_swap_b32 v192, v194
  v_permlane32_swap_b32 v193, v195
  v_permlane32_swap_b32 v196, v198
  v_permlane32_swap_b32 v197, v199
  v_permlane16_swap_b32 v188, v189
  v_permlane16_swap_b32 v190, v191
  v_permlane16_swap_b32 v192, v193
  v_permlane16_swap_b32 v194, v195
  v_permlane16_swap_b32 v196, v197
  v_permlane16_swap_b32 v198, v199
  v_min_u32 v187, 49, v1
  v_lshlrev_b32 v187, 7, v187
  buffer_load_dwordx4 v[156:159], v2, s[28:31], s58 offen sc1
  buffer_load_dwordx4 v[160:163], v2, s[28:31], s58 offen offset:1024 sc1
  s_add_u32 s65, s5, 10616832
  buffer_store_dwordx4 v[188:191], v212, s[28:31], s65 offen offset:0 sc1
  buffer_store_dwordx4 v[192:195], v212, s[28:31], s65 offen offset:1024 sc1
  buffer_store_dwordx4 v[196:199], v212, s[28:31], s65 offen offset:2048 sc1
  v_lshlrev_b32 v68, 16, v144
  v_and_b32 v69, s23, v144
  v_pk_mul_f32 v[68:69], v[68:69], s[56:57] op_sel_hi:[1,0]
  v_lshlrev_b32 v70, 16, v145
  v_and_b32 v71, s23, v145
  v_pk_mul_f32 v[70:71], v[70:71], s[56:57] op_sel_hi:[1,0]
  v_lshlrev_b32 v72, 16, v146
  v_and_b32 v73, s23, v146
  v_pk_mul_f32 v[72:73], v[72:73], s[56:57] op_sel_hi:[1,0]
  v_lshlrev_b32 v74, 16, v147
  v_and_b32 v75, s23, v147
  v_pk_mul_f32 v[74:75], v[74:75], s[56:57] op_sel_hi:[1,0]
  v_lshlrev_b32 v76, 16, v148
  v_and_b32 v77, s23, v148
  v_pk_mul_f32 v[76:77], v[76:77], s[56:57] op_sel_hi:[1,0]
  v_lshlrev_b32 v78, 16, v149
  v_and_b32 v79, s23, v149
  v_pk_mul_f32 v[78:79], v[78:79], s[56:57] op_sel_hi:[1,0]
  v_lshlrev_b32 v80, 16, v150
  v_and_b32 v81, s23, v150
  v_pk_mul_f32 v[80:81], v[80:81], s[56:57] op_sel_hi:[1,0]
  v_lshlrev_b32 v82, 16, v151
  v_and_b32 v83, s23, v151
  v_pk_mul_f32 v[82:83], v[82:83], s[56:57] op_sel_hi:[1,0]
  v_lshlrev_b32 v84, 16, v152
  v_and_b32 v85, s23, v152
  v_pk_mul_f32 v[84:85], v[84:85], s[56:57] op_sel_hi:[1,0]
  v_lshlrev_b32 v86, 16, v153
  v_and_b32 v87, s23, v153
  v_pk_mul_f32 v[86:87], v[86:87], s[56:57] op_sel_hi:[1,0]
  v_lshlrev_b32 v216, 16, v164
  v_lshlrev_b32 v217, 16, v165
  v_lshlrev_b32 v218, 16, v166
  v_lshlrev_b32 v219, 16, v167
  v_max3_f32 v164, |v164|, |v165|, |v166|
  v_max3_f32 v164, v164, |v167|, |v216|
  v_max3_f32 v164, v164, |v217|, |v218|
  v_max_f32 v164, v164, |v219|
  v_lshlrev_b32 v216, 16, v252
  v_lshlrev_b32 v217, 16, v253
  v_lshlrev_b32 v218, 16, v254
  v_lshlrev_b32 v219, 16, v255
  v_max3_f32 v252, |v252|, |v253|, |v254|
  v_max3_f32 v252, v252, |v255|, |v216|
  v_max3_f32 v252, v252, |v217|, |v218|
  v_max_f32 v252, v252, |v219|
  v_fmac_f32 v252, 0x440f4000, v164
  s_nop 1
  v_max_f32_dpp v252, v252, v252 quad_perm:[1,0,3,2] row_mask:0xf bank_mask:0xf
  s_nop 1
  v_max_f32_dpp v252, v252, v252 quad_perm:[2,3,0,1] row_mask:0xf bank_mask:0xf
  s_nop 1
  v_max_f32_dpp v252, v252, v252 row_half_mirror row_mask:0xf bank_mask:0xf
  s_nop 1
  v_max_f32_dpp v252, v252, v252 row_mirror row_mask:0xf bank_mask:0xf
  s_nop 1
  v_max_f32_dpp v252, v252, v252 row_bcast:15 row_mask:0xa bank_mask:0xf
  s_nop 1
  v_max_f32_dpp v252, v252, v252 row_bcast:31 row_mask:0xc bank_mask:0xf
  s_nop 1
  v_readlane_b32 s65, v252, 63
  s_lshr_b32 s65, s65, 23
  s_max_u32 s65, s65, 80
  s_min_u32 s65, s65, 200
  s_sub_u32 s65, s65, 13
  s_lshl_b32 s57, s65, 23
  s_add_u32 s60, s57, 2151197243
  s_sub_u32 s22, s57, 83886080
  s_waitcnt vmcnt(3)
  v_bitop3_b32 v20, v157, v161, s49 bitop3:0x7e
  v_bitop3_b32 v21, v159, v163, s93 bitop3:0x7e
  v_or_b32 v20, v20, v21
  v_cmp_ne_u32 vcc, 0, v20
  s_cbranch_vccz L_pdone2
  s_mov_b64 exec, vcc
  s_mov_b32 s55, 65536
L_poll1:
  s_mov_b32 s93, s94
  s_bitset0_b32 s58, 15
  s_and_b32 s66, s55, 15
  s_cmp_lg_u32 s66, 1
  s_cbranch_scc1 L_gl5
  s_mov_b32 s93, s49
  s_bitset1_b32 s58, 15
  s_mov_b64 vcc, exec
  s_mov_b32 exec_lo, 0
  s_brev_b32 exec_hi, 1
  v_mov_b32 v131, s49
  buffer_store_dwordx4 v[128:131], off, s[28:31], s95 sc1
  s_mov_b64 exec, -1
  s_mov_b64 exec, vcc
L_gl5:
  buffer_load_dwordx4 v[156:159], v2, s[28:31], s58 offen sc1
  buffer_load_dwordx4 v[160:163], v2, s[28:31], s58 offen offset:1024 sc1
  s_waitcnt vmcnt(0)
  v_bitop3_b32 v20, v157, v161, s49 bitop3:0x7e
  v_bitop3_b32 v21, v159, v163, s93 bitop3:0x7e
  v_or_b32 v20, v20, v21
  v_cmp_ne_u32 vcc, 0, v20
  s_cbranch_vccz L_prest3
  s_mov_b64 exec, vcc
  s_sub_u32 s55, s55, 1
  s_cbranch_scc0 L_poll1
L_prest3:
  s_mov_b64 exec, -1
L_pdone2:
  v_subrev_f32 v156, s67, v156
  v_subrev_f32 v160, s67, v160
  v_add_f32 v22, v158, v162
  v_add_f32 v20, v156, v160
  v_fmac_f32 v22, v156, v156
  v_fmac_f32 v22, v160, v160
  v_mov_b32 v156, 0x3727c5ac
  s_nop 1
  v_add_f32_dpp v20, v20, v20 quad_perm:[1,0,3,2] row_mask:0xf bank_mask:0xf
  v_add_f32_dpp v22, v22, v22 quad_perm:[1,0,3,2] row_mask:0xf bank_mask:0xf
  s_nop 0
  v_add_f32_dpp v20, v20, v20 quad_perm:[2,3,0,1] row_mask:0xf bank_mask:0xf
  v_add_f32_dpp v22, v22, v22 quad_perm:[2,3,0,1] row_mask:0xf bank_mask:0xf
  s_nop 0
  v_add_f32_dpp v20, v20, v20 row_half_mirror row_mask:0xf bank_mask:0xf
  v_add_f32_dpp v22, v22, v22 row_half_mirror row_mask:0xf bank_mask:0xf
  s_nop 0
  v_add_f32_dpp v20, v20, v20 row_mirror row_mask:0xf bank_mask:0xf
  v_add_f32_dpp v22, v22, v22 row_mirror row_mask:0xf bank_mask:0xf
  s_nop 0
  v_add_f32_dpp v20, v20, v20 row_bcast:15 row_mask:0xa bank_mask:0xf
  v_add_f32_dpp v22, v22, v22 row_bcast:15 row_mask:0xa bank_mask:0xf
  s_nop 0
  v_add_f32_dpp v20, v20, v20 row_bcast:31 row_mask:0xc bank_mask:0xf
  v_add_f32_dpp v22, v22, v22 row_bcast:31 row_mask:0xc bank_mask:0xf
  s_nop 0
  v_mul_f32 v20, 0x3c000000, v20
  v_fmamk_f32 v22, v22, 0x3c000000, v156
  v_fma_f32 v22, -v20, v20, v22
  v_max_f32 v22, v22, v156
  v_rsq_f32 v22, v22
  v_add_f32 v20, v20, v24
  v_mul_f32 v22, 0xbfb8aa3b, v22
  v_mul_f32 v20, v20, v22
  s_nop 0
  v_readlane_b32 s72, v20, 63
  v_readlane_b32 s70, v22, 63
  s_mov_b32 s98, 15990784
  s_mov_b32 s97, 16121856
  s_mov_b32 s66, s96
  v_pk_fma_f32 v[68:69], v[48:49], s[72:73], v[68:69] op_sel_hi:[1,0,1] neg_lo:[1,0,0] neg_hi:[1,0,0]
  v_pk_fma_f32 v[70:71], v[50:51], s[72:73], v[70:71] op_sel_hi:[1,0,1] neg_lo:[1,0,0] neg_hi:[1,0,0]
  v_pk_fma_f32 v[28:29], v[28:29], s[70:71], v[68:69] op_sel_hi:[1,0,1]
  v_pk_fma_f32 v[30:31], v[30:31], s[70:71], v[70:71] op_sel_hi:[1,0,1]
  v_pk_fma_f32 v[88:89], v[88:89], s[70:71], v[68:69] op_sel_hi:[1,0,1]
  v_pk_fma_f32 v[90:91], v[90:91], s[70:71], v[70:71] op_sel_hi:[1,0,1]
  v_exp_f32 v132, v28
  v_exp_f32 v133, v29
  v_exp_f32 v134, v30
  v_exp_f32 v135, v31
  v_exp_f32 v136, v88
  v_exp_f32 v137, v89
  v_exp_f32 v138, v90
  v_exp_f32 v139, v91
  v_pk_fma_f32 v[132:133], v[132:133], s[60:61], s[60:61] op_sel_hi:[1,0,0]
  v_pk_fma_f32 v[134:135], v[134:135], s[60:61], s[60:61] op_sel_hi:[1,0,0]
  v_pk_fma_f32 v[136:137], v[136:137], s[60:61], s[60:61] op_sel_hi:[1,0,0]
  v_pk_fma_f32 v[138:139], v[138:139], s[60:61], s[60:61] op_sel_hi:[1,0,0]
  v_rcp_f32 v132, v132
  v_rcp_f32 v133, v133
  v_rcp_f32 v134, v134
  v_rcp_f32 v135, v135
  v_rcp_f32 v136, v136
  v_rcp_f32 v137, v137
  v_rcp_f32 v138, v138
  v_rcp_f32 v139, v139
  v_pk_mul_f32 v[28:29], v[28:29], v[132:133]
  v_pk_mul_f32 v[30:31], v[30:31], v[134:135]
  v_pk_mul_f32 v[88:89], v[88:89], v[136:137]
  v_pk_mul_f32 v[90:91], v[90:91], v[138:139]
  v_cvt_pk_f16_f32 v108, v28, v29
  v_cvt_pk_f16_f32 v109, v30, v31
  v_cvt_pk_f16_f32 v110, v88, v89
  v_cvt_pk_f16_f32 v111, v90, v91
  s_nop 1
  v_permlane32_swap_b32 v108, v110
  v_permlane32_swap_b32 v109, v111
  buffer_store_dwordx4 v[108:111], v17, s[28:31], s66 offen sc1
  s_add_u32 s66, s66, 131072
  s_sub_u32 s65, 640, s9
  buffer_load_dwordx4 v[204:207], v213, s[40:43], s65 offen
  s_waitcnt vmcnt(2)
  s_barrier
  s_mov_b64 exec, 1
  buffer_store_dword v0, v251, s[28:31], s51 offen sc1
  s_mov_b64 exec, -1
  v_pk_fma_f32 v[72:73], v[52:53], s[72:73], v[72:73] op_sel_hi:[1,0,1] neg_lo:[1,0,0] neg_hi:[1,0,0]
  v_pk_fma_f32 v[74:75], v[54:55], s[72:73], v[74:75] op_sel_hi:[1,0,1] neg_lo:[1,0,0] neg_hi:[1,0,0]
  v_pk_fma_f32 v[32:33], v[32:33], s[70:71], v[72:73] op_sel_hi:[1,0,1]
  v_pk_fma_f32 v[34:35], v[34:35], s[70:71], v[74:75] op_sel_hi:[1,0,1]
  v_pk_fma_f32 v[92:93], v[92:93], s[70:71], v[72:73] op_sel_hi:[1,0,1]
  v_pk_fma_f32 v[94:95], v[94:95], s[70:71], v[74:75] op_sel_hi:[1,0,1]
  v_exp_f32 v132, v32
  v_exp_f32 v133, v33
  v_exp_f32 v134, v34
  v_exp_f32 v135, v35
  v_exp_f32 v136, v92
  v_exp_f32 v137, v93
  v_exp_f32 v138, v94
  v_exp_f32 v139, v95
  v_pk_fma_f32 v[132:133], v[132:133], s[60:61], s[60:61] op_sel_hi:[1,0,0]
  v_pk_fma_f32 v[134:135], v[134:135], s[60:61], s[60:61] op_sel_hi:[1,0,0]
  v_pk_fma_f32 v[136:137], v[136:137], s[60:61], s[60:61] op_sel_hi:[1,0,0]
  v_pk_fma_f32 v[138:139], v[138:139], s[60:61], s[60:61] op_sel_hi:[1,0,0]
  v_rcp_f32 v132, v132
  v_rcp_f32 v133, v133
  v_rcp_f32 v134, v134
  v_rcp_f32 v135, v135
  v_rcp_f32 v136, v136
  v_rcp_f32 v137, v137
  v_rcp_f32 v138, v138
  v_rcp_f32 v139, v139
  v_pk_mul_f32 v[32:33], v[32:33], v[132:133]
  v_pk_mul_f32 v[34:35], v[34:35], v[134:135]
  v_pk_mul_f32 v[92:93], v[92:93], v[136:137]
  v_pk_mul_f32 v[94:95], v[94:95], v[138:139]
  v_cvt_pk_f16_f32 v112, v32, v33
  v_cvt_pk_f16_f32 v113, v34, v35
  v_cvt_pk_f16_f32 v114, v92, v93
  v_cvt_pk_f16_f32 v115, v94, v95
  s_nop 1
  v_permlane32_swap_b32 v112, v114
  v_permlane32_swap_b32 v113, v115
  buffer_store_dwordx4 v[112:115], v17, s[28:31], s66 offen sc1
  s_add_u32 s66, s66, 131072
  v_pk_fma_f32 v[76:77], v[56:57], s[72:73], v[76:77] op_sel_hi:[1,0,1] neg_lo:[1,0,0] neg_hi:[1,0,0]
  v_pk_fma_f32 v[78:79], v[58:59], s[72:73], v[78:79] op_sel_hi:[1,0,1] neg_lo:[1,0,0] neg_hi:[1,0,0]
  v_pk_fma_f32 v[36:37], v[36:37], s[70:71], v[76:77] op_sel_hi:[1,0,1]
  v_pk_fma_f32 v[38:39], v[38:39], s[70:71], v[78:79] op_sel_hi:[1,0,1]
  v_pk_fma_f32 v[96:97], v[96:97], s[70:71], v[76:77] op_sel_hi:[1,0,1]
  v_pk_fma_f32 v[98:99], v[98:99], s[70:71], v[78:79] op_sel_hi:[1,0,1]
  v_exp_f32 v132, v36
  v_exp_f32 v133, v37
  v_exp_f32 v134, v38
  v_exp_f32 v135, v39
  v_exp_f32 v136, v96
  v_exp_f32 v137, v97
  v_exp_f32 v138, v98
  v_exp_f32 v139, v99
  v_pk_fma_f32 v[132:133], v[132:133], s[60:61], s[60:61] op_sel_hi:[1,0,0]
  v_pk_fma_f32 v[134:135], v[134:135], s[60:61], s[60:61] op_sel_hi:[1,0,0]
  v_pk_fma_f32 v[136:137], v[136:137], s[60:61], s[60:61] op_sel_hi:[1,0,0]
  v_pk_fma_f32 v[138:139], v[138:139], s[60:61], s[60:61] op_sel_hi:[1,0,0]
  v_rcp_f32 v132, v132
  v_rcp_f32 v133, v133
  v_rcp_f32 v134, v134
  v_rcp_f32 v135, v135
  v_rcp_f32 v136, v136
  v_rcp_f32 v137, v137
  v_rcp_f32 v138, v138
  v_rcp_f32 v139, v139
  v_pk_mul_f32 v[36:37], v[36:37], v[132:133]
  v_pk_mul_f32 v[38:39], v[38:39], v[134:135]
  v_pk_mul_f32 v[96:97], v[96:97], v[136:137]
  v_pk_mul_f32 v[98:99], v[98:99], v[138:139]
  v_cvt_pk_f16_f32 v116, v36, v37
  v_cvt_pk_f16_f32 v117, v38, v39
  v_cvt_pk_f16_f32 v118, v96, v97
  v_cvt_pk_f16_f32 v119, v98, v99
  s_nop 1
  v_permlane32_swap_b32 v116, v118
  v_permlane32_swap_b32 v117, v119
  buffer_store_dwordx4 v[116:119], v17, s[28:31], s66 offen sc1
  s_add_u32 s66, s66, 131072
  s_waitcnt vmcnt(4)
  s_mov_b64 exec, 1
  buffer_store_dword v0, off, s[28:31], s11 sc1
  s_mov_b64 exec, -1
  v_pk_fma_f32 v[80:81], v[60:61], s[72:73], v[80:81] op_sel_hi:[1,0,1] neg_lo:[1,0,0] neg_hi:[1,0,0]
  v_pk_fma_f32 v[82:83], v[62:63], s[72:73], v[82:83] op_sel_hi:[1,0,1] neg_lo:[1,0,0] neg_hi:[1,0,0]
  v_pk_fma_f32 v[40:41], v[40:41], s[70:71], v[80:81] op_sel_hi:[1,0,1]
  v_pk_fma_f32 v[42:43], v[42:43], s[70:71], v[82:83] op_sel_hi:[1,0,1]
  v_pk_fma_f32 v[100:101], v[100:101], s[70:71], v[80:81] op_sel_hi:[1,0,1]
  v_pk_fma_f32 v[102:103], v[102:103], s[70:71], v[82:83] op_sel_hi:[1,0,1]
  v_exp_f32 v132, v40
  v_exp_f32 v133, v41
  v_exp_f32 v134, v42
  v_exp_f32 v135, v43
  v_exp_f32 v136, v100
  v_exp_f32 v137, v101
  v_exp_f32 v138, v102
  v_exp_f32 v139, v103
  v_pk_fma_f32 v[132:133], v[132:133], s[60:61], s[60:61] op_sel_hi:[1,0,0]
  v_pk_fma_f32 v[134:135], v[134:135], s[60:61], s[60:61] op_sel_hi:[1,0,0]
  v_pk_fma_f32 v[136:137], v[136:137], s[60:61], s[60:61] op_sel_hi:[1,0,0]
  v_pk_fma_f32 v[138:139], v[138:139], s[60:61], s[60:61] op_sel_hi:[1,0,0]
  v_rcp_f32 v132, v132
  v_rcp_f32 v133, v133
  v_rcp_f32 v134, v134
  v_rcp_f32 v135, v135
  v_rcp_f32 v136, v136
  v_rcp_f32 v137, v137
  v_rcp_f32 v138, v138
  v_rcp_f32 v139, v139
  v_pk_mul_f32 v[40:41], v[40:41], v[132:133]
  v_pk_mul_f32 v[42:43], v[42:43], v[134:135]
  v_pk_mul_f32 v[100:101], v[100:101], v[136:137]
  v_pk_mul_f32 v[102:103], v[102:103], v[138:139]
  v_cvt_pk_f16_f32 v120, v40, v41
  v_cvt_pk_f16_f32 v121, v42, v43
  v_cvt_pk_f16_f32 v122, v100, v101
  v_cvt_pk_f16_f32 v123, v102, v103
  s_nop 1
  v_permlane32_swap_b32 v120, v122
  v_permlane32_swap_b32 v121, v123
  buffer_store_dwordx4 v[120:123], v17, s[28:31], s66 offen sc1
  s_add_u32 s66, s66, 131072
  v_pk_fma_f32 v[84:85], v[64:65], s[72:73], v[84:85] op_sel_hi:[1,0,1] neg_lo:[1,0,0] neg_hi:[1,0,0]
  v_pk_fma_f32 v[86:87], v[66:67], s[72:73], v[86:87] op_sel_hi:[1,0,1] neg_lo:[1,0,0] neg_hi:[1,0,0]
  v_pk_fma_f32 v[44:45], v[44:45], s[70:71], v[84:85] op_sel_hi:[1,0,1]
  v_pk_fma_f32 v[46:47], v[46:47], s[70:71], v[86:87] op_sel_hi:[1,0,1]
  v_pk_fma_f32 v[104:105], v[104:105], s[70:71], v[84:85] op_sel_hi:[1,0,1]
  v_pk_fma_f32 v[106:107], v[106:107], s[70:71], v[86:87] op_sel_hi:[1,0,1]
  v_exp_f32 v132, v44
  v_exp_f32 v133, v45
  v_exp_f32 v134, v46
  v_exp_f32 v135, v47
  v_exp_f32 v136, v104
  v_exp_f32 v137, v105
  v_exp_f32 v138, v106
  v_exp_f32 v139, v107
  v_pk_fma_f32 v[132:133], v[132:133], s[60:61], s[60:61] op_sel_hi:[1,0,0]
  v_pk_fma_f32 v[134:135], v[134:135], s[60:61], s[60:61] op_sel_hi:[1,0,0]
  v_pk_fma_f32 v[136:137], v[136:137], s[60:61], s[60:61] op_sel_hi:[1,0,0]
  v_pk_fma_f32 v[138:139], v[138:139], s[60:61], s[60:61] op_sel_hi:[1,0,0]
  v_rcp_f32 v132, v132
  v_rcp_f32 v133, v133
  v_rcp_f32 v134, v134
  v_rcp_f32 v135, v135
  v_rcp_f32 v136, v136
  v_rcp_f32 v137, v137
  v_rcp_f32 v138, v138
  v_rcp_f32 v139, v139
  v_pk_mul_f32 v[44:45], v[44:45], v[132:133]
  v_pk_mul_f32 v[46:47], v[46:47], v[134:135]
  v_pk_mul_f32 v[104:105], v[104:105], v[136:137]
  v_pk_mul_f32 v[106:107], v[106:107], v[138:139]
  v_cvt_pk_f16_f32 v124, v44, v45
  v_cvt_pk_f16_f32 v125, v46, v47
  v_cvt_pk_f16_f32 v126, v104, v105
  v_cvt_pk_f16_f32 v127, v106, v107
  s_nop 1
  v_permlane32_swap_b32 v124, v126
  v_permlane32_swap_b32 v125, v127
  buffer_store_dwordx4 v[124:127], v17, s[28:31], s66 offen sc1
  buffer_load_dword v177, v187, s[28:31], s51 offen sc1
  s_lshl2_add_u32 s8, s45, s44
  s_mul_i32 s8, s8, 657408
  s_lshl_b32 s52, s47, 9
  s_add_u32 s8, s8, s52
  s_add_u32 s8, s8, 16780800
  s_add_u32 s11, s11, 131072
  s_mov_b64 exec, 0
  s_cmp_eq_u32 s44, 0
  s_cbranch_scc1 L_pg0
  s_cmp_eq_u32 s44, 1
  s_cbranch_scc1 L_pg1
  s_cmp_eq_u32 s44, 2
  s_cbranch_scc1 L_pg2
  s_branch L_pg3
L_pgback:
  s_mov_b64 exec, -1
  s_waitcnt vmcnt(7)
  v_mov_b32 v88, 0
  s_cmp_ge_u32 s3, 50
  s_cbranch_scc1 L_emb0
  v_add_u32 v249, 3072, v249
  ds_read2_b32 v[178:179], v249 offset0:0 offset1:1
  ds_read2_b32 v[180:181], v249 offset0:2 offset1:3
  ds_read2_b32 v[182:183], v249 offset0:4 offset1:5
  ds_read2_b32 v[184:185], v249 offset0:6 offset1:7
  ds_read_b32 v186, v249 offset:32
  s_waitcnt lgkmcnt(0)
  v_lshlrev_b32 v216, 16, v178
  v_and_b32 v217, s23, v182
  v_and_b32 v218, s23, v178
  v_lshlrev_b32 v219, 16, v183
  v_lshlrev_b32 v220, 16, v179
  v_and_b32 v221, s23, v183
  v_pk_add_f32 v[222:223], v[216:217], v[220:221]
  v_pk_mul_f32 v[216:217], v[216:217], s[4:5] op_sel_hi:[1,0]
  v_pk_mul_f32 v[222:223], v[222:223], s[12:13] op_sel_hi:[1,0]
  v_pk_mul_f32 v[220:221], v[220:221], s[4:5] op_sel_hi:[1,0]
  v_pk_fma_f32 v[224:225], v[218:219], s[12:13], v[222:223] op_sel_hi:[1,0,1]
  v_pk_fma_f32 v[218:219], v[218:219], s[12:13], v[222:223] op_sel_hi:[1,0,1] neg_lo:[1,0,0] neg_hi:[1,0,0]
  v_cvt_pk_f16_f32 v200, v216, v217
  v_cvt_pk_f16_f32 v201, v224, v225
  v_cvt_pk_f16_f32 v202, v218, v219
  v_cvt_pk_f16_f32 v203, v220, v221
  v_and_b32 v226, s23, v179
  v_lshlrev_b32 v227, 16, v184
  v_lshlrev_b32 v228, 16, v180
  v_and_b32 v229, s23, v184
  v_and_b32 v230, s23, v180
  v_lshlrev_b32 v231, 16, v185
  v_pk_add_f32 v[232:233], v[226:227], v[230:231]
  v_pk_mul_f32 v[226:227], v[226:227], s[4:5] op_sel_hi:[1,0]
  v_pk_mul_f32 v[232:233], v[232:233], s[12:13] op_sel_hi:[1,0]
  v_pk_mul_f32 v[230:231], v[230:231], s[4:5] op_sel_hi:[1,0]
  v_pk_fma_f32 v[234:235], v[228:229], s[12:13], v[232:233] op_sel_hi:[1,0,1]
  v_pk_fma_f32 v[228:229], v[228:229], s[12:13], v[232:233] op_sel_hi:[1,0,1] neg_lo:[1,0,0] neg_hi:[1,0,0]
  v_cvt_pk_f16_f32 v204, v226, v227
  v_cvt_pk_f16_f32 v205, v234, v235
  v_cvt_pk_f16_f32 v206, v228, v229
  v_cvt_pk_f16_f32 v207, v230, v231
  v_lshlrev_b32 v236, 16, v181
  v_and_b32 v237, s23, v185
  v_and_b32 v238, s23, v181
  v_lshlrev_b32 v239, 16, v186
  v_lshlrev_b32 v240, 16, v182
  v_and_b32 v241, s23, v186
  v_pk_add_f32 v[242:243], v[236:237], v[240:241]
  v_pk_mul_f32 v[236:237], v[236:237], s[4:5] op_sel_hi:[1,0]
  v_pk_mul_f32 v[242:243], v[242:243], s[12:13] op_sel_hi:[1,0]
  v_pk_mul_f32 v[240:241], v[240:241], s[4:5] op_sel_hi:[1,0]
  v_pk_fma_f32 v[244:245], v[238:239], s[12:13], v[242:243] op_sel_hi:[1,0,1]
  v_pk_fma_f32 v[238:239], v[238:239], s[12:13], v[242:243] op_sel_hi:[1,0,1] neg_lo:[1,0,0] neg_hi:[1,0,0]
  v_cvt_pk_f16_f32 v208, v236, v237
  v_cvt_pk_f16_f32 v209, v244, v245
  v_cvt_pk_f16_f32 v210, v238, v239
  v_cvt_pk_f16_f32 v211, v240, v241
  v_permlane32_swap_b32 v200, v202
  v_permlane32_swap_b32 v201, v203
  v_permlane32_swap_b32 v204, v206
  v_permlane32_swap_b32 v205, v207
  v_permlane32_swap_b32 v208, v210
  v_permlane32_swap_b32 v209, v211
  v_permlane16_swap_b32 v200, v201
  v_permlane16_swap_b32 v202, v203
  v_permlane16_swap_b32 v204, v205
  v_permlane16_swap_b32 v206, v207
  v_permlane16_swap_b32 v208, v209
  v_permlane16_swap_b32 v210, v211
  v_pk_maximum3_f16 v88, v178, v178, v178 neg_lo:[0,1,0] neg_hi:[0,1,0]
  v_pk_maximum3_f16 v88, v88, v179, v179 neg_lo:[0,0,1] neg_hi:[0,0,1]
  v_pk_maximum3_f16 v88, v88, v180, v180 neg_lo:[0,0,1] neg_hi:[0,0,1]
  v_pk_maximum3_f16 v88, v88, v181, v181 neg_lo:[0,0,1] neg_hi:[0,0,1]
  v_pk_maximum3_f16 v88, v88, v182, v182 neg_lo:[0,0,1] neg_hi:[0,0,1]
  v_pk_maximum3_f16 v88, v88, v183, v183 neg_lo:[0,0,1] neg_hi:[0,0,1]
  v_pk_maximum3_f16 v88, v88, v184, v184 neg_lo:[0,0,1] neg_hi:[0,0,1]
  v_pk_maximum3_f16 v88, v88, v185, v185 neg_lo:[0,0,1] neg_hi:[0,0,1]
  v_pk_maximum3_f16 v88, v88, v186, v186 neg_lo:[0,0,1] neg_hi:[0,0,1]
  v_lshlrev_b32 v89, 16, v88
  v_max_u32 v88, v88, v89
L_noemb0:
  s_waitcnt vmcnt(3)
  buffer_load_dword v25, v18, s[28:31], s98 offen sc1
  s_mul_i32 s65, s16, 56
  s_cmp_eq_u32 s47, s65
  s_cselect_b32 s66, 37, 0
  v_subrev_u32 v216, s66, v1
  v_and_or_b32 v4, v216, s25, v4
  s_sub_u32 s65, 56, s65
  s_cmp_eq_u32 s47, s65
  s_cselect_b32 s66, 6, 63
  v_sub_u32 v216, s66, v1
  v_and_or_b32 v9, v216, s25, v9
  s_waitcnt vmcnt(2)
  s_mov_b64 exec, 1
  buffer_store_dword v0, off, s[28:31], s11 sc1
  s_mov_b64 exec, -1
  s_waitcnt vmcnt(2)
  v_cmp_ne_u32 vcc, s49, v177
  s_cbranch_vccz L_pdone7
  s_mov_b64 exec, vcc
  s_mov_b32 s55, 65536
L_poll6:
  buffer_load_dword v177, v187, s[28:31], s51 offen sc1
  s_waitcnt vmcnt(0)
  v_cmp_ne_u32 vcc, s49, v177
  s_cbranch_vccz L_prest8
  s_mov_b64 exec, vcc
  s_sub_u32 s55, s55, 1
  s_cbranch_scc0 L_poll6
L_prest8:
  s_mov_b64 exec, -1
L_pdone7:
  s_add_u32 s51, s61, 10616832
  buffer_load_dwordx4 a[0:3], v10, s[28:31], s51 offen offset:0 sc1
  buffer_load_dwordx4 a[4:7], v13, s[28:31], s51 offen offset:0 sc1
  buffer_load_dwordx4 a[8:11], v14, s[28:31], s51 offen offset:0 sc1
  buffer_load_dwordx4 a[12:15], v10, s[28:31], s51 offen offset:3072 sc1
  buffer_load_dwordx4 a[16:19], v13, s[28:31], s51 offen offset:3072 sc1
  buffer_load_dwordx4 a[20:23], v14, s[28:31], s51 offen offset:3072 sc1
  s_waitcnt vmcnt(7)
  v_cmp_ne_u32 vcc, s49, v25
  s_cbranch_vccz L_pdone11
  s_mov_b64 exec, vcc
  s_mov_b32 s55, 65536
L_poll10:
  buffer_load_dword v25, v18, s[28:31], s98 offen sc1
  s_waitcnt vmcnt(0)
  v_cmp_ne_u32 vcc, s49, v25
  s_cbranch_vccz L_prest12
  s_mov_b64 exec, vcc
  s_sub_u32 s55, s55, 1
  s_cbranch_scc0 L_poll10
L_prest12:
  s_mov_b64 exec, -1
L_pdone11:
  s_add_u32 m0, s50, 16384
  s_add_u32 s52, s8, 0
  buffer_load_dwordx4 v4, s[28:31], s52 offen sc1 lds
  s_addk_i32 m0, 1024
  s_nop 0
  buffer_load_dwordx4 v5, s[28:31], s52 offen sc1 lds
  s_addk_i32 m0, 1024
  s_nop 0
  buffer_load_dwordx4 v6, s[28:31], s52 offen sc1 lds
  s_addk_i32 m0, 1024
  s_nop 0
  buffer_load_dwordx4 v7, s[28:31], s52 offen sc1 lds
  s_addk_i32 m0, 1024
  s_nop 0
  buffer_load_dwordx4 v8, s[28:31], s52 offen sc1 lds
  s_addk_i32 m0, 1024
  s_nop 0
  buffer_load_dwordx4 v9, s[28:31], s52 offen sc1 lds
  s_add_u32 s19, s51, s18
  buffer_load_dwordx4 a[24:27], v10, s[28:31], s19 offen offset:0 sc1
  v_pk_maximum3_f16 v214, v168, v168, v168 neg_lo:[0,1,0] neg_hi:[0,1,0]
  v_pk_maximum3_f16 v214, v214, v169, v169 neg_lo:[0,0,1] neg_hi:[0,0,1]
  v_pk_maximum3_f16 v214, v214, v170, v170 neg_lo:[0,0,1] neg_hi:[0,0,1]
  v_pk_maximum3_f16 v214, v214, v171, v171 neg_lo:[0,0,1] neg_hi:[0,0,1]
  v_pk_maximum3_f16 v214, v214, v172, v172 neg_lo:[0,0,1] neg_hi:[0,0,1]
  v_pk_maximum3_f16 v214, v214, v173, v173 neg_lo:[0,0,1] neg_hi:[0,0,1]
  v_pk_maximum3_f16 v214, v214, v174, v174 neg_lo:[0,0,1] neg_hi:[0,0,1]
  v_pk_maximum3_f16 v214, v214, v175, v175 neg_lo:[0,0,1] neg_hi:[0,0,1]
  v_pk_maximum3_f16 v214, v214, v176, v176 neg_lo:[0,0,1] neg_hi:[0,0,1]
  v_lshlrev_b32 v215, 16, v214
  v_max_u32 v214, v214, v215
  v_mov_b32 v92, 0x35000000
  v_max_u32 v93, v214, v88
  v_cmp_le_u32 vcc, 0x41800000, v93
  v_cmp_ne_u32 s[70:71], 0, v214
  v_cmp_ge_u32 s[72:73], v214, v92
  v_cmp_ne_u32 s[66:67], 0, v88
  v_cmp_ge_u32 s[68:69], v88, v92
  buffer_load_dwordx4 a[28:31], v13, s[28:31], s19 offen offset:0 sc1
  s_cmp_lg_u64 s[72:73], 0
  s_cmov_b64 s[70:71], 0
  s_cmp_lg_u64 s[68:69], 0
  s_cmov_b64 s[66:67], 0
  s_or_b64 vcc, vcc, s[70:71]
  s_or_b64 vcc, vcc, s[66:67]
  s_cselect_b32 s69, 1, 0
  s_lshl2_add_u32 s68, s44, 1536
  v_mov_b32 v92, s68
  v_mov_b32 v93, s69
  s_mov_b64 exec, 1
  ds_write_b32 v92, v93
  s_mov_b64 exec, -1
  v_add_u32 v94, s50, v2
  ds_read_b128 v[164:167], v94 offset:2048
  ds_read_b128 v[252:255], v94 offset:3072
  buffer_load_dwordx4 a[32:35], v14, s[28:31], s19 offen offset:0 sc1
  s_waitcnt lgkmcnt(0)
  v_lshlrev_b32 v96, 16, v164
  v_lshlrev_b32 v97, 16, v165
  v_lshlrev_b32 v98, 16, v166
  v_lshlrev_b32 v99, 16, v167
  v_max3_f32 v164, |v164|, |v165|, |v166|
  v_max3_f32 v164, v164, |v167|, |v96|
  v_max3_f32 v164, v164, |v97|, |v98|
  v_max_f32 v164, v164, |v99|
  v_lshlrev_b32 v96, 16, v252
  v_lshlrev_b32 v97, 16, v253
  v_lshlrev_b32 v98, 16, v254
  v_lshlrev_b32 v99, 16, v255
  v_max3_f32 v252, |v252|, |v253|, |v254|
  v_max3_f32 v252, v252, |v255|, |v96|
  v_max3_f32 v252, v252, |v97|, |v98|
  v_max_f32 v252, v252, |v99|
  s_add_u32 m0, s50, 22528
  s_add_u32 s52, s8, 65536
  buffer_load_dwordx4 v4, s[28:31], s52 offen sc1 lds
  v_fmac_f32 v252, 0x440f4000, v164
  s_nop 1
  v_max_f32_dpp v252, v252, v252 quad_perm:[1,0,3,2] row_mask:0xf bank_mask:0xf
  s_nop 1
  v_max_f32_dpp v252, v252, v252 quad_perm:[2,3,0,1] row_mask:0xf bank_mask:0xf
  s_nop 1
  v_max_f32_dpp v252, v252, v252 row_half_mirror row_mask:0xf bank_mask:0xf
  s_nop 1
  v_max_f32_dpp v252, v252, v252 row_mirror row_mask:0xf bank_mask:0xf
  s_nop 1
  v_max_f32_dpp v252, v252, v252 row_bcast:15 row_mask:0xa bank_mask:0xf
  s_nop 1
  v_max_f32_dpp v252, v252, v252 row_bcast:31 row_mask:0xc bank_mask:0xf
  s_nop 1
  v_readlane_b32 s69, v252, 63
  s_addk_i32 m0, 1024
  s_nop 0
  buffer_load_dwordx4 v5, s[28:31], s52 offen sc1 lds
  s_lshr_b32 s69, s69, 23
  s_max_u32 s69, s69, 80
  s_min_u32 s69, s69, 200
  s_sub_u32 s69, s69, 13
  s_lshl_b32 s59, s69, 23
  s_add_u32 s62, s59, 2151197243
  s_sub_u32 s24, s59, 83886080
  v_cmp_eq_u32 vcc, 0, v1
  v_ashrrev_i32 v92, 2, v251
  v_bfrev_b32 v93, 1
  v_cndmask_b32 v166, v93, v92, vcc
  s_mov_b32 s10, 0
  s_addk_i32 m0, 1024
  s_nop 0
  buffer_load_dwordx4 v6, s[28:31], s52 offen sc1 lds
  v_min_u32 v164, 59, v1
  v_lshlrev_b32 v164, 5, v164
  s_lshl_b32 s67, s16, 7
  v_lshl_add_u32 v165, v19, 1, s67
  v_add_u32 v167, s50, v2
  s_lshr_b32 s66, s13, 2
  s_add_u32 s66, s66, 15892480
  v_mov_b32 v24, 1536
  s_mul_i32 s67, s54, 320
  s_add_u32 s67, s67, 16527360
  s_addk_i32 m0, 1024
  s_nop 0
  buffer_load_dwordx4 v7, s[28:31], s52 offen sc1 lds
  s_addk_i32 m0, 1024
  s_nop 0
  buffer_load_dwordx4 v8, s[28:31], s52 offen sc1 lds
  s_addk_i32 m0, 1024
  s_nop 0
  buffer_load_dwordx4 v9, s[28:31], s52 offen sc1 lds
  s_addk_i32 s51, 15360
  buffer_load_dwordx4 a[36:39], v10, s[28:31], s51 offen offset:0 sc1
  buffer_load_dwordx4 a[40:43], v13, s[28:31], s51 offen offset:0 sc1
  buffer_load_dwordx4 a[44:47], v14, s[28:31], s51 offen offset:0 sc1
  s_add_u32 s65, s5, 13074432
  buffer_store_dwordx4 v[200:203], v212, s[28:31], s65 offen offset:0 sc1
  buffer_store_dwordx4 v[204:207], v212, s[28:31], s65 offen offset:1024 sc1
  buffer_store_dwordx4 v[208:211], v212, s[28:31], s65 offen offset:2048 sc1
  s_mov_b32 s65, 16527360
  s_mov_b32 exec_lo, 0x10001
  s_mov_b32 exec_hi, 0x10001
  buffer_store_dwordx4 v[52:55], v213, s[28:31], s65 offen sc1
  s_mov_b64 exec, -1
  v_mov_b32 v100, 0
  v_mov_b32 v101, 0
  v_mov_b32 v102, 0
  v_mov_b32 v103, 0
  ds_write_b128 v2, v[100:103]
  ds_write_b128 v2, v[100:103] offset:512
  v_lshlrev_b32 v210, 2, v1
  v_mov_b32 v209, 1
  s_waitcnt lgkmcnt(0)
L_conv1:
  s_waitcnt vmcnt(16)
  buffer_load_dword v26, v18, s[28:31], s97 offen sc1
  s_barrier
  ds_read_b128 v[108:111], v11 offset:16384
  ds_read_b128 v[132:135], v12 offset:16384
  ds_read_b128 v[112:115], v11 offset:16960
  ds_read_b128 v[136:139], v12 offset:16960
  ds_read_b128 v[116:119], v11 offset:17536
  ds_read_b128 v[140:143], v12 offset:17536
  s_waitcnt lgkmcnt(4)
L_pg0:
  s_cbranch_execz L_pgback
  v_pk_fma_f16 v108, v132, s53, v108
  v_pk_fma_f16 v109, v133, s53, v109
  v_pk_fma_f16 v110, v134, s53, v110
  v_pk_fma_f16 v111, v135, s53, v111
  s_waitcnt lgkmcnt(2)
  v_pk_fma_f16 v112, v136, s53, v112
  v_pk_fma_f16 v113, v137, s53, v113
  v_pk_fma_f16 v114, v138, s53, v114
  v_pk_fma_f16 v115, v139, s53, v115
  v_mfma_f32_16x16x32_f16 v[28:31], a[0:3], v[108:111], 0
  ds_read_b128 v[120:123], v11 offset:18112
  v_mfma_f32_16x16x32_f16 v[36:39], a[12:15], v[108:111], 0
  s_waitcnt vmcnt(16)
  ds_read_b128 v[144:147], v12 offset:18112
  v_mfma_f32_16x16x32_f16 v[44:47], a[24:27], v[108:111], 0
  s_waitcnt lgkmcnt(2)
  v_pk_fma_f16 v116, v140, s53, v116
  v_pk_fma_f16 v117, v141, s53, v117
  v_mfma_f32_16x16x32_f16 v[32:35], a[0:3], v[112:115], 0
  buffer_load_dwordx4 a[48:51], v10, s[28:31], s51 offen offset:3072 sc1
  v_mfma_f32_16x16x32_f16 v[40:43], a[12:15], v[112:115], 0
  ds_read_b128 v[124:127], v11 offset:18688
  v_pk_fma_f16 v118, v142, s53, v118
  v_mfma_f32_16x16x32_f16 v[64:67], a[24:27], v[112:115], 0
  ds_read_b128 v[148:151], v12 offset:18688
  v_pk_fma_f16 v119, v143, s53, v119
  v_mfma_f32_16x16x32_f16 v[28:31], a[4:7], v[112:115], v[28:31]
  s_waitcnt lgkmcnt(2)
  ds_read_b128 v[128:131], v11 offset:19264
  v_pk_fma_f16 v120, v144, s53, v120
  v_mfma_f32_16x16x32_f16 v[36:39], a[16:19], v[112:115], v[36:39]
  s_waitcnt vmcnt(16)
  buffer_load_dwordx4 a[52:55], v13, s[28:31], s51 offen offset:3072 sc1
  v_mfma_f32_16x16x32_f16 v[44:47], a[28:31], v[112:115], v[44:47]
  ds_read_b128 v[152:155], v12 offset:19264
  v_pk_fma_f16 v121, v145, s53, v121
  v_mfma_f32_16x16x32_f16 v[48:51], a[0:3], v[116:119], 0
  ds_read_b128 v[224:227], v11 offset:19840
  v_pk_fma_f16 v122, v146, s53, v122
  v_mfma_f32_16x16x32_f16 v[56:59], a[12:15], v[116:119], 0
  ds_read_b128 v[240:243], v12 offset:19840
  v_pk_fma_f16 v123, v147, s53, v123
  v_mfma_f32_16x16x32_f16 v[84:87], a[24:27], v[116:119], 0
  buffer_load_dwordx4 a[56:59], v14, s[28:31], s51 offen offset:3072 sc1
  v_mfma_f32_16x16x32_f16 v[32:35], a[4:7], v[116:119], v[32:35]
  s_waitcnt lgkmcnt(4)
  ds_read_b128 v[228:231], v11 offset:20416
  v_pk_fma_f16 v124, v148, s53, v124
  v_mfma_f32_16x16x32_f16 v[40:43], a[16:19], v[116:119], v[40:43]
  s_add_u32 s19, s51, s18
  ds_read_b128 v[244:247], v12 offset:20416
  v_pk_fma_f16 v125, v149, s53, v125
  v_mfma_f32_16x16x32_f16 v[64:67], a[28:31], v[116:119], v[64:67]
  v_pk_fma_f16 v126, v150, s53, v126
  v_pk_fma_f16 v127, v151, s53, v127
  v_mfma_f32_16x16x32_f16 v[28:31], a[8:11], v[116:119], v[28:31]
  buffer_load_dwordx4 a[60:63], v10, s[28:31], s19 offen offset:0 sc1
  v_mfma_f32_16x16x32_f16 v[36:39], a[20:23], v[116:119], v[36:39]
  s_waitcnt vmcnt(18) lgkmcnt(4)
  ds_read_b128 v[232:235], v11 offset:20992
  v_pk_fma_f16 v128, v152, s53, v128
  v_mfma_f32_16x16x32_f16 v[44:47], a[32:35], v[116:119], v[44:47]
  ds_read_b128 v[248:251], v12 offset:20992
  v_pk_fma_f16 v129, v153, s53, v129
  v_mfma_f32_16x16x32_f16 v[52:55], a[0:3], v[120:123], 0
  ds_read_b128 v[236:239], v11 offset:21568
  v_pk_fma_f16 v130, v154, s53, v130
  v_mfma_f32_16x16x32_f16 v[60:63], a[12:15], v[120:123], 0
  ds_read_b128 v[252:255], v12 offset:21568
  v_pk_fma_f16 v131, v155, s53, v131
  v_mfma_f32_16x16x32_f16 v[104:107], a[24:27], v[120:123], 0
  buffer_load_dwordx4 a[64:67], v13, s[28:31], s19 offen offset:0 sc1
  v_mfma_f32_16x16x32_f16 v[48:51], a[4:7], v[120:123], v[48:51]
  s_waitcnt vmcnt(5) lgkmcnt(6)
  v_pk_fma_f16 v224, v240, s53, v224
  v_cmp_ne_u32 vcc, s49, v26
  v_mfma_f32_16x16x32_f16 v[56:59], a[16:19], v[120:123], v[56:59]
  ds_add_u32 v210, v209 offset:0
  v_pk_fma_f16 v225, v241, s53, v225
  v_mfma_f32_16x16x32_f16 v[84:87], a[28:31], v[120:123], v[84:87]
  s_cbranch_vccnz L_pfail17
L_pdone15:
  v_pk_fma_f16 v226, v242, s53, v226
  v_mfma_f32_16x16x32_f16 v[32:35], a[8:11], v[120:123], v[32:35]
  s_waitcnt lgkmcnt(5)
  v_pk_fma_f16 v227, v243, s53, v227
  v_pk_fma_f16 v228, v244, s53, v228
  v_mfma_f32_16x16x32_f16 v[40:43], a[20:23], v[120:123], v[40:43]
  v_pk_fma_f16 v229, v245, s53, v229
  v_pk_fma_f16 v230, v246, s53, v230
  v_mfma_f32_16x16x32_f16 v[64:67], a[32:35], v[120:123], v[64:67]
  ds_read_b32 v211, v210 offset:0
  v_pk_fma_f16 v231, v247, s53, v231
  v_mfma_f32_16x16x32_f16 v[68:71], a[0:3], v[124:127], 0
  buffer_load_dwordx4 a[68:71], v14, s[28:31], s19 offen offset:0 sc1
  v_mfma_f32_16x16x32_f16 v[76:79], a[12:15], v[124:127], 0
  s_waitcnt lgkmcnt(4)
  v_pk_fma_f16 v232, v248, s53, v232
  v_pk_fma_f16 v233, v249, s53, v233
  v_mfma_f32_16x16x32_f16 v[52:55], a[4:7], v[124:127], v[52:55]
  s_add_u32 m0, s50, 28672
  v_pk_fma_f16 v234, v250, s53, v234
  v_pk_fma_f16 v235, v251, s53, v235
  v_mfma_f32_16x16x32_f16 v[60:63], a[16:19], v[124:127], v[60:63]
  s_waitcnt lgkmcnt(2)
  v_pk_fma_f16 v236, v252, s53, v236
  v_pk_fma_f16 v237, v253, s53, v237
  v_mfma_f32_16x16x32_f16 v[104:107], a[28:31], v[124:127], v[104:107]
  s_add_u32 s52, s8, 131072
  v_pk_fma_f16 v238, v254, s53, v238
  v_pk_fma_f16 v239, v255, s53, v239
  v_mfma_f32_16x16x32_f16 v[48:51], a[8:11], v[124:127], v[48:51]
  buffer_load_dwordx4 v4, s[28:31], s52 offen sc1 lds
  v_mfma_f32_16x16x32_f16 v[56:59], a[20:23], v[124:127], v[56:59]
  s_waitcnt lgkmcnt(0)
  s_addk_i32 m0, 1024
  v_cmp_le_u32 vcc, 4, v211
  v_mfma_f32_16x16x32_f16 v[84:87], a[32:35], v[124:127], v[84:87]
  buffer_load_dwordx4 v5, s[28:31], s52 offen sc1 lds
  v_mfma_f32_16x16x32_f16 v[72:75], a[0:3], v[128:131], 0
  s_addk_i32 m0, 1024
  s_cbranch_vccz L_sfail22
L_sok23:
  v_mfma_f32_16x16x32_f16 v[80:83], a[12:15], v[128:131], 0
  buffer_load_dwordx4 v6, s[28:31], s52 offen sc1 lds
  v_mfma_f32_16x16x32_f16 v[68:71], a[4:7], v[128:131], v[68:71]
  s_addk_i32 m0, 1024
  v_mfma_f32_16x16x32_f16 v[76:79], a[16:19], v[128:131], v[76:79]
  buffer_load_dwordx4 v7, s[28:31], s52 offen sc1 lds
  v_mfma_f32_16x16x32_f16 v[52:55], a[8:11], v[128:131], v[52:55]
  s_addk_i32 m0, 1024
  ds_read_b128 v[132:135], v11 offset:22528
  v_mfma_f32_16x16x32_f16 v[60:63], a[20:23], v[128:131], v[60:63]
  buffer_load_dwordx4 v8, s[28:31], s52 offen sc1 lds
  v_mfma_f32_16x16x32_f16 v[104:107], a[32:35], v[128:131], v[104:107]
  s_addk_i32 m0, 1024
  ds_read_b128 v[156:159], v12 offset:22528
  v_mfma_f32_16x16x32_f16 v[88:91], a[0:3], v[224:227], 0
  v_mfma_f32_16x16x32_f16 v[96:99], a[12:15], v[224:227], 0
  ds_read_b128 v[136:139], v11 offset:23104
  v_mfma_f32_16x16x32_f16 v[72:75], a[4:7], v[224:227], v[72:75]
  buffer_load_dwordx4 v9, s[28:31], s52 offen sc1 lds
  v_mfma_f32_16x16x32_f16 v[80:83], a[16:19], v[224:227], v[80:83]
  s_add_u32 m0, s50, 34816
  s_add_u32 s52, s8, 196608
  ds_read_b128 v[160:163], v12 offset:23104
  v_mfma_f32_16x16x32_f16 v[68:71], a[8:11], v[224:227], v[68:71]
  s_waitcnt lgkmcnt(2)
  v_pk_fma_f16 v132, v156, s53, v132
  v_pk_fma_f16 v133, v157, s53, v133
  v_mfma_f32_16x16x32_f16 v[76:79], a[20:23], v[224:227], v[76:79]
  buffer_load_dwordx4 v4, s[28:31], s52 offen sc1 lds
  v_mfma_f32_16x16x32_f16 v[92:95], a[0:3], v[228:231], 0
  s_addk_i32 m0, 1024
  ds_read_b128 v[140:143], v11 offset:23680
  v_pk_fma_f16 v134, v158, s53, v134
  v_mfma_f32_16x16x32_f16 v[100:103], a[12:15], v[228:231], 0
  v_pk_fma_f16 v135, v159, s53, v135
  v_mfma_f32_16x16x32_f16 v[88:91], a[4:7], v[228:231], v[88:91]
  s_waitcnt lgkmcnt(1)
  ds_read_b128 v[156:159], v12 offset:23680
  v_pk_fma_f16 v136, v160, s53, v136
  v_mfma_f32_16x16x32_f16 v[96:99], a[16:19], v[228:231], v[96:99]
  buffer_load_dwordx4 v5, s[28:31], s52 offen sc1 lds
  v_mfma_f32_16x16x32_f16 v[72:75], a[8:11], v[228:231], v[72:75]
  s_addk_i32 m0, 1024
  ds_read_b128 v[144:147], v11 offset:24256
  v_pk_fma_f16 v137, v161, s53, v137
  v_mfma_f32_16x16x32_f16 v[80:83], a[20:23], v[228:231], v[80:83]
  v_pk_fma_f16 v138, v162, s53, v138
  v_pk_fma_f16 v139, v163, s53, v139
  v_mfma_f32_16x16x32_f16 v[92:95], a[4:7], v[232:235], v[92:95]
  s_waitcnt lgkmcnt(1)
  ds_read_b128 v[160:163], v12 offset:24256
  v_pk_fma_f16 v140, v156, s53, v140
  v_mfma_f32_16x16x32_f16 v[100:103], a[16:19], v[232:235], v[100:103]
  buffer_load_dwordx4 v6, s[28:31], s52 offen sc1 lds
  v_mfma_f32_16x16x32_f16 v[88:91], a[8:11], v[232:235], v[88:91]
  s_addk_i32 m0, 1024
  v_pk_fma_f16 v141, v157, s53, v141
  v_pk_fma_f16 v142, v158, s53, v142
  v_mfma_f32_16x16x32_f16 v[96:99], a[20:23], v[232:235], v[96:99]
  ds_read_b128 v[148:151], v11 offset:24832
  v_pk_fma_f16 v143, v159, s53, v143
  v_mfma_f32_16x16x32_f16 v[92:95], a[8:11], v[236:239], v[92:95]
  buffer_load_dwordx4 v7, s[28:31], s52 offen sc1 lds
  v_mfma_f32_16x16x32_f16 v[100:103], a[20:23], v[236:239], v[100:103]
  s_waitcnt lgkmcnt(1)
  ds_read_b128 v[156:159], v12 offset:24832
  v_pk_fma_f16 v144, v160, s53, v144
  v_mfma_f32_16x16x32_f16 v[28:31], a[36:39], v[132:135], v[28:31]
  s_addk_i32 s51, 15360
  v_pk_fma_f16 v145, v161, s53, v145
  v_pk_fma_f16 v146, v162, s53, v146
  v_mfma_f32_16x16x32_f16 v[28:31], a[40:43], v[136:139], v[28:31]
  v_pk_fma_f16 v147, v163, s53, v147
  v_mfma_f32_16x16x32_f16 v[28:31], a[44:47], v[140:143], v[28:31]
  s_waitcnt vmcnt(13)
  buffer_load_dwordx4 a[72:75], v10, s[28:31], s51 offen offset:0 sc1
  v_mfma_f32_16x16x32_f16 v[36:39], a[48:51], v[132:135], v[36:39]
  ds_read_b128 v[152:155], v11 offset:25408
  v_mfma_f32_16x16x32_f16 v[36:39], a[52:55], v[136:139], v[36:39]
  s_waitcnt lgkmcnt(1)
  ds_read_b128 v[160:163], v12 offset:25408
  v_pk_fma_f16 v148, v156, s53, v148
  v_mfma_f32_16x16x32_f16 v[36:39], a[56:59], v[140:143], v[36:39]
  s_waitcnt vmcnt(11)
  v_pk_fma_f16 v149, v157, s53, v149
  v_pk_fma_f16 v150, v158, s53, v150
  v_mfma_f32_16x16x32_f16 v[44:47], a[60:63], v[132:135], v[44:47]
  buffer_load_dwordx4 a[76:79], v13, s[28:31], s51 offen offset:0 sc1
  v_mfma_f32_16x16x32_f16 v[44:47], a[64:67], v[136:139], v[44:47]
  ds_read_b128 v[240:243], v11 offset:25984
  v_pk_fma_f16 v151, v159, s53, v151
  v_mfma_f32_16x16x32_f16 v[44:47], a[68:71], v[140:143], v[44:47]
  ds_read_b128 v[156:159], v12 offset:25984
  v_mfma_f32_16x16x32_f16 v[32:35], a[36:39], v[136:139], v[32:35]
  buffer_load_dwordx4 a[80:83], v14, s[28:31], s51 offen offset:0 sc1
  v_mfma_f32_16x16x32_f16 v[32:35], a[40:43], v[140:143], v[32:35]
  s_waitcnt lgkmcnt(2)
  v_pk_fma_f16 v152, v160, s53, v152
  v_pk_fma_f16 v153, v161, s53, v153
  v_mfma_f32_16x16x32_f16 v[32:35], a[44:47], v[144:147], v[32:35]
  s_addk_i32 m0, 1024
  v_pk_fma_f16 v154, v162, s53, v154
  v_pk_fma_f16 v155, v163, s53, v155
  v_mfma_f32_16x16x32_f16 v[40:43], a[48:51], v[136:139], v[40:43]
  ds_read_b128 v[244:247], v11 offset:26560
  v_mfma_f32_16x16x32_f16 v[40:43], a[52:55], v[140:143], v[40:43]
  buffer_load_dwordx4 v8, s[28:31], s52 offen sc1 lds
  v_mfma_f32_16x16x32_f16 v[40:43], a[56:59], v[144:147], v[40:43]
  s_waitcnt lgkmcnt(1)
  ds_read_b128 v[160:163], v12 offset:26560
  v_pk_fma_f16 v240, v156, s53, v240
  v_mfma_f32_16x16x32_f16 v[64:67], a[60:63], v[136:139], v[64:67]
  v_pk_fma_f16 v241, v157, s53, v241
  v_pk_fma_f16 v242, v158, s53, v242
  v_mfma_f32_16x16x32_f16 v[64:67], a[64:67], v[140:143], v[64:67]
  v_pk_fma_f16 v243, v159, s53, v243
  v_mfma_f32_16x16x32_f16 v[64:67], a[68:71], v[144:147], v[64:67]
  buffer_load_dwordx4 a[84:87], v10, s[28:31], s51 offen offset:3072 sc1
  v_mfma_f32_16x16x32_f16 v[48:51], a[36:39], v[140:143], v[48:51]
  ds_read_b128 v[248:251], v11 offset:27136
  v_mfma_f32_16x16x32_f16 v[48:51], a[40:43], v[144:147], v[48:51]
  s_waitcnt lgkmcnt(1)
  ds_read_b128 v[156:159], v12 offset:27136
  v_pk_fma_f16 v244, v160, s53, v244
  v_mfma_f32_16x16x32_f16 v[48:51], a[44:47], v[148:151], v[48:51]
  buffer_load_dwordx4 a[88:91], v13, s[28:31], s51 offen offset:3072 sc1
  v_mfma_f32_16x16x32_f16 v[56:59], a[48:51], v[140:143], v[56:59]
  v_pk_fma_f16 v245, v161, s53, v245
  v_pk_fma_f16 v246, v162, s53, v246
  v_mfma_f32_16x16x32_f16 v[56:59], a[52:55], v[144:147], v[56:59]
  s_waitcnt vmcnt(10)
  ds_add_u32 v210, v209 offset:0
  ds_read_b128 v[252:255], v11 offset:27712
  v_mfma_f32_16x16x32_f16 v[56:59], a[56:59], v[148:151], v[56:59]
  v_pk_fma_f16 v247, v163, s53, v247
  v_mfma_f32_16x16x32_f16 v[84:87], a[60:63], v[140:143], v[84:87]
  buffer_load_dwordx4 a[92:95], v14, s[28:31], s51 offen offset:3072 sc1
  v_mfma_f32_16x16x32_f16 v[84:87], a[64:67], v[144:147], v[84:87]
  s_waitcnt lgkmcnt(2)
  ds_read_b128 v[160:163], v12 offset:27712
  v_pk_fma_f16 v248, v156, s53, v248
  v_mfma_f32_16x16x32_f16 v[84:87], a[68:71], v[148:151], v[84:87]
  s_add_u32 s19, s51, s18
  ds_read_b32 v211, v210 offset:0
  v_pk_fma_f16 v249, v157, s53, v249
  v_mfma_f32_16x16x32_f16 v[52:55], a[36:39], v[144:147], v[52:55]
  v_pk_fma_f16 v250, v158, s53, v250
  v_pk_fma_f16 v251, v159, s53, v251
  v_mfma_f32_16x16x32_f16 v[52:55], a[40:43], v[148:151], v[52:55]
  buffer_load_dwordx4 a[96:99], v10, s[28:31], s19 offen offset:0 sc1
  v_mfma_f32_16x16x32_f16 v[52:55], a[44:47], v[152:155], v[52:55]
  s_waitcnt lgkmcnt(1)
  v_pk_fma_f16 v252, v160, s53, v252
  v_pk_fma_f16 v253, v161, s53, v253
  v_mfma_f32_16x16x32_f16 v[60:63], a[48:51], v[144:147], v[60:63]
  v_pk_fma_f16 v254, v162, s53, v254
  v_pk_fma_f16 v255, v163, s53, v255
  v_mfma_f32_16x16x32_f16 v[60:63], a[52:55], v[148:151], v[60:63]
  buffer_load_dwordx4 a[100:103], v13, s[28:31], s19 offen offset:0 sc1
  v_mfma_f32_16x16x32_f16 v[60:63], a[56:59], v[152:155], v[60:63]
  v_mfma_f32_16x16x32_f16 v[104:107], a[60:63], v[144:147], v[104:107]
  s_waitcnt lgkmcnt(0)
  v_cmp_le_u32 vcc, 8, v211
  v_mfma_f32_16x16x32_f16 v[104:107], a[64:67], v[148:151], v[104:107]
  v_mfma_f32_16x16x32_f16 v[104:107], a[68:71], v[152:155], v[104:107]
  buffer_load_dwordx4 a[104:107], v14, s[28:31], s19 offen offset:0 sc1
  v_mfma_f32_16x16x32_f16 v[68:71], a[36:39], v[148:151], v[68:71]
  s_addk_i32 m0, 1024
  s_cbranch_vccz L_sfail25
L_sok26:
  v_mfma_f32_16x16x32_f16 v[68:71], a[40:43], v[152:155], v[68:71]
  v_mfma_f32_16x16x32_f16 v[68:71], a[44:47], v[240:243], v[68:71]
  ds_read_b128 v[108:111], v11 offset:28672
  v_mfma_f32_16x16x32_f16 v[76:79], a[48:51], v[148:151], v[76:79]
  buffer_load_dwordx4 v9, s[28:31], s52 offen sc1 lds
  v_mfma_f32_16x16x32_f16 v[76:79], a[52:55], v[152:155], v[76:79]
  s_add_u32 m0, s50, 4096
  ds_read_b128 v[20:23], v24
  ds_read_b128 v[156:159], v12 offset:28672
  v_mfma_f32_16x16x32_f16 v[76:79], a[56:59], v[240:243], v[76:79]
  s_add_u32 s52, s8, 262144
  v_mfma_f32_16x16x32_f16 v[72:75], a[36:39], v[152:155], v[72:75]
  buffer_load_dwordx4 v4, s[28:31], s52 offen sc1 lds
  v_mfma_f32_16x16x32_f16 v[72:75], a[40:43], v[240:243], v[72:75]
  s_addk_i32 m0, 1024
  ds_read_b128 v[112:115], v11 offset:29248
  v_mfma_f32_16x16x32_f16 v[72:75], a[44:47], v[244:247], v[72:75]
  ds_read_b128 v[160:163], v12 offset:29248
  v_mfma_f32_16x16x32_f16 v[80:83], a[48:51], v[152:155], v[80:83]
  s_waitcnt lgkmcnt(2)
  v_pk_fma_f16 v108, v156, s53, v108
  v_pk_fma_f16 v109, v157, s53, v109
  v_mfma_f32_16x16x32_f16 v[80:83], a[52:55], v[240:243], v[80:83]
  buffer_load_dwordx4 v5, s[28:31], s52 offen sc1 lds
  v_mfma_f32_16x16x32_f16 v[80:83], a[56:59], v[244:247], v[80:83]
  s_addk_i32 m0, 1024
  ds_read_b128 v[116:119], v11 offset:29824
  v_pk_fma_f16 v110, v158, s53, v110
  v_mfma_f32_16x16x32_f16 v[88:91], a[36:39], v[240:243], v[88:91]
  v_pk_fma_f16 v111, v159, s53, v111
  v_or3_b32 v20, v20, v21, v22
  v_mfma_f32_16x16x32_f16 v[88:91], a[40:43], v[244:247], v[88:91]
  s_waitcnt lgkmcnt(1)
  ds_read_b128 v[156:159], v12 offset:29824
  v_pk_fma_f16 v112, v160, s53, v112
  v_mfma_f32_16x16x32_f16 v[88:91], a[44:47], v[248:251], v[88:91]
  buffer_load_dwordx4 v6, s[28:31], s52 offen sc1 lds
  v_mfma_f32_16x16x32_f16 v[96:99], a[48:51], v[240:243], v[96:99]
  s_addk_i32 m0, 1024
  v_pk_fma_f16 v113, v161, s53, v113
  v_pk_fma_f16 v114, v162, s53, v114
  v_mfma_f32_16x16x32_f16 v[96:99], a[52:55], v[244:247], v[96:99]
  ds_read_b128 v[120:123], v11 offset:30400
  v_pk_fma_f16 v115, v163, s53, v115
  v_mfma_f32_16x16x32_f16 v[96:99], a[56:59], v[248:251], v[96:99]
  buffer_load_dwordx4 v7, s[28:31], s52 offen sc1 lds
  v_mfma_f32_16x16x32_f16 v[92:95], a[36:39], v[244:247], v[92:95]
  s_waitcnt lgkmcnt(1)
  ds_read_b128 v[160:163], v12 offset:30400
  v_pk_fma_f16 v116, v156, s53, v116
  v_mfma_f32_16x16x32_f16 v[92:95], a[40:43], v[248:251], v[92:95]
  s_addk_i32 m0, 1024
  v_pk_fma_f16 v117, v157, s53, v117
  v_pk_fma_f16 v118, v158, s53, v118
  v_mfma_f32_16x16x32_f16 v[92:95], a[44:47], v[252:255], v[92:95]
  v_pk_fma_f16 v119, v159, s53, v119
  v_or_b32 v20, v20, v23
  v_mfma_f32_16x16x32_f16 v[100:103], a[48:51], v[244:247], v[100:103]
  buffer_load_dwordx4 v8, s[28:31], s52 offen sc1 lds
  v_mfma_f32_16x16x32_f16 v[100:103], a[52:55], v[248:251], v[100:103]
  s_addk_i32 s51, 15360
  ds_read_b128 v[124:127], v11 offset:30976
  v_add_u32 v20, s49, v20
  v_mfma_f32_16x16x32_f16 v[100:103], a[56:59], v[252:255], v[100:103]
  s_waitcnt vmcnt(13)
  buffer_store_dword v20, v166, s[28:31], s66 offen sc1
  v_mfma_f32_16x16x32_f16 v[28:31], a[72:75], v[108:111], v[28:31]
  s_waitcnt lgkmcnt(1)
  ds_read_b128 v[156:159], v12 offset:30976
  v_pk_fma_f16 v120, v160, s53, v120
  v_mfma_f32_16x16x32_f16 v[28:31], a[76:79], v[112:115], v[28:31]
  buffer_load_dwordx4 a[108:111], v10, s[28:31], s51 offen offset:0 sc1
  v_mfma_f32_16x16x32_f16 v[28:31], a[80:83], v[116:119], v[28:31]
  s_waitcnt vmcnt(11)
  ds_read_b128 v[128:131], v11 offset:31552
  v_pk_fma_f16 v121, v161, s53, v121
  v_mfma_f32_16x16x32_f16 v[36:39], a[84:87], v[108:111], v[36:39]
  s_mul_i32 s65, s46, 160
  v_pk_fma_f16 v122, v162, s53, v122
  v_pk_fma_f16 v123, v163, s53, v123
  v_mfma_f32_16x16x32_f16 v[36:39], a[88:91], v[112:115], v[36:39]
  buffer_load_dwordx4 a[112:115], v13, s[28:31], s51 offen offset:0 sc1
  v_mfma_f32_16x16x32_f16 v[36:39], a[92:95], v[116:119], v[36:39]
  s_waitcnt vmcnt(9) lgkmcnt(1)
  ds_read_b128 v[160:163], v12 offset:31552
  v_pk_fma_f16 v124, v156, s53, v124
  v_mfma_f32_16x16x32_f16 v[44:47], a[96:99], v[108:111], v[44:47]
  s_add_u32 s65, s65, s50
  v_pk_fma_f16 v125, v157, s53, v125
  v_pk_fma_f16 v126, v158, s53, v126
  v_mfma_f32_16x16x32_f16 v[44:47], a[100:103], v[112:115], v[44:47]
  ds_read_b128 v[224:227], v11 offset:32128
  v_pk_fma_f16 v127, v159, s53, v127
  v_mfma_f32_16x16x32_f16 v[44:47], a[104:107], v[116:119], v[44:47]
  buffer_load_dwordx4 a[116:119], v14, s[28:31], s51 offen offset:0 sc1
  v_mfma_f32_16x16x32_f16 v[32:35], a[72:75], v[112:115], v[32:35]
  s_waitcnt lgkmcnt(1)
  ds_read_b128 v[156:159], v12 offset:32128
  v_pk_fma_f16 v128, v160, s53, v128
  v_mfma_f32_16x16x32_f16 v[32:35], a[76:79], v[116:119], v[32:35]
  s_addk_i32 m0, 1024
  v_pk_fma_f16 v129, v161, s53, v129
  v_pk_fma_f16 v130, v162, s53, v130
  v_mfma_f32_16x16x32_f16 v[32:35], a[80:83], v[120:123], v[32:35]
  v_pk_fma_f16 v131, v163, s53, v131
  v_lshrrev_b32 v22, 1, v165
  v_mfma_f32_16x16x32_f16 v[40:43], a[84:87], v[112:115], v[40:43]
  buffer_load_dwordx4 v9, s[28:31], s52 offen sc1 lds
  v_mfma_f32_16x16x32_f16 v[40:43], a[88:91], v[116:119], v[40:43]
  ds_read_b128 v[228:231], v11 offset:32704
  v_add_u32 v22, s65, v22
  v_mfma_f32_16x16x32_f16 v[40:43], a[92:95], v[120:123], v[40:43]
  s_waitcnt lgkmcnt(1)
  ds_read_b128 v[160:163], v12 offset:32704
  v_pk_fma_f16 v224, v156, s53, v224
  v_mfma_f32_16x16x32_f16 v[64:67], a[96:99], v[112:115], v[64:67]
  buffer_load_dwordx4 a[120:123], v10, s[28:31], s51 offen offset:3072 sc1
  v_mfma_f32_16x16x32_f16 v[64:67], a[100:103], v[116:119], v[64:67]
  s_waitcnt vmcnt(11)
  ds_add_u32 v210, v209 offset:0
  v_pk_fma_f16 v225, v157, s53, v225
  v_mfma_f32_16x16x32_f16 v[64:67], a[104:107], v[120:123], v[64:67]
  ds_read_b128 v[232:235], v11 offset:33280
  v_pk_fma_f16 v226, v158, s53, v226
  v_mfma_f32_16x16x32_f16 v[48:51], a[72:75], v[116:119], v[48:51]
  v_pk_fma_f16 v227, v159, s53, v227
  v_lshrrev_b32 v23, 1, v19
  v_mfma_f32_16x16x32_f16 v[48:51], a[76:79], v[120:123], v[48:51]
  buffer_load_dwordx4 a[124:127], v13, s[28:31], s51 offen offset:3072 sc1
  v_mfma_f32_16x16x32_f16 v[48:51], a[80:83], v[124:127], v[48:51]
  ds_read_b32 v211, v210 offset:0
  ds_read_b128 v[156:159], v12 offset:33280
  v_mfma_f32_16x16x32_f16 v[56:59], a[84:87], v[116:119], v[56:59]
  s_waitcnt lgkmcnt(4)
  v_pk_fma_f16 v228, v160, s53, v228
  v_pk_fma_f16 v229, v161, s53, v229
  v_mfma_f32_16x16x32_f16 v[56:59], a[88:91], v[120:123], v[56:59]
  ds_read_b128 v[236:239], v11 offset:33856
  v_pk_fma_f16 v230, v162, s53, v230
  v_mfma_f32_16x16x32_f16 v[56:59], a[92:95], v[124:127], v[56:59]
  v_pk_fma_f16 v231, v163, s53, v231
  v_add_u32 v23, s65, v23
  v_mfma_f32_16x16x32_f16 v[84:87], a[96:99], v[116:119], v[84:87]
  buffer_load_dwordx4 a[128:131], v14, s[28:31], s51 offen offset:3072 sc1
  v_mfma_f32_16x16x32_f16 v[84:87], a[100:103], v[120:123], v[84:87]
  s_waitcnt lgkmcnt(1)
  ds_read_b128 v[160:163], v12 offset:33856
  v_pk_fma_f16 v232, v156, s53, v232
  v_mfma_f32_16x16x32_f16 v[84:87], a[104:107], v[124:127], v[84:87]
  s_add_u32 s19, s51, s18
  v_pk_fma_f16 v233, v157, s53, v233
  v_pk_fma_f16 v234, v158, s53, v234
  v_mfma_f32_16x16x32_f16 v[52:55], a[72:75], v[120:123], v[52:55]
  buffer_load_dwordx4 a[132:135], v10, s[28:31], s19 offen offset:0 sc1
  v_mfma_f32_16x16x32_f16 v[52:55], a[76:79], v[124:127], v[52:55]
  v_pk_fma_f16 v235, v159, s53, v235
  v_cmp_le_u32 vcc, 12, v211
  v_mfma_f32_16x16x32_f16 v[52:55], a[80:83], v[128:131], v[52:55]
  s_waitcnt lgkmcnt(0)
  v_pk_fma_f16 v236, v160, s53, v236
  v_pk_fma_f16 v237, v161, s53, v237
  v_mfma_f32_16x16x32_f16 v[60:63], a[84:87], v[120:123], v[60:63]
  s_cbranch_vccz L_sfail28
L_sok29:
  v_pk_fma_f16 v238, v162, s53, v238
  v_mfma_f32_16x16x32_f16 v[60:63], a[88:91], v[124:127], v[60:63]
  buffer_load_dwordx4 a[136:139], v13, s[28:31], s19 offen offset:0 sc1
  v_mfma_f32_16x16x32_f16 v[60:63], a[92:95], v[128:131], v[60:63]
  ds_read_b128 v[132:135], v11 offset:34816
  v_pk_fma_f16 v239, v163, s53, v239
  v_mfma_f32_16x16x32_f16 v[104:107], a[96:99], v[120:123], v[104:107]
  ds_read_b128 v[192:195], v22 offset:2080
  ds_read_b128 v[156:159], v12 offset:34816
  v_mfma_f32_16x16x32_f16 v[104:107], a[100:103], v[124:127], v[104:107]
  buffer_load_dwordx4 a[140:143], v14, s[28:31], s19 offen offset:0 sc1
  v_mfma_f32_16x16x32_f16 v[104:107], a[104:107], v[128:131], v[104:107]
  s_add_u32 m0, s50, 10240
  s_add_u32 s52, s8, 327680
  ds_read_b64 v[196:197], v23 offset:2048
  v_mfma_f32_16x16x32_f16 v[68:71], a[72:75], v[124:127], v[68:71]
  ds_read_b128 v[200:203], v22 offset:3104
  ds_read_b128 v[136:139], v11 offset:35392
  v_mfma_f32_16x16x32_f16 v[68:71], a[76:79], v[128:131], v[68:71]
  buffer_load_dwordx4 v4, s[28:31], s52 offen sc1 lds
  v_mfma_f32_16x16x32_f16 v[68:71], a[80:83], v[224:227], v[68:71]
  s_addk_i32 m0, 1024
  ds_read_b64 v[204:205], v23 offset:3072
  ds_read_b128 v[160:163], v12 offset:35392
  v_mfma_f32_16x16x32_f16 v[76:79], a[84:87], v[124:127], v[76:79]
  s_waitcnt lgkmcnt(5)
  v_pk_fma_f16 v132, v156, s53, v132
  v_pk_fma_f16 v133, v157, s53, v133
  v_mfma_f32_16x16x32_f16 v[76:79], a[88:91], v[128:131], v[76:79]
  v_pk_fma_f16 v134, v158, s53, v134
  v_pk_fma_f16 v135, v159, s53, v135
  v_mfma_f32_16x16x32_f16 v[76:79], a[92:95], v[224:227], v[76:79]
  buffer_load_dwordx4 v5, s[28:31], s52 offen sc1 lds
  v_mfma_f32_16x16x32_f16 v[72:75], a[72:75], v[128:131], v[72:75]
  s_addk_i32 m0, 1024
  ds_read_b128 v[140:143], v11 offset:35968
  v_mfma_f32_16x16x32_f16 v[72:75], a[76:79], v[224:227], v[72:75]
  s_waitcnt lgkmcnt(1)
  ds_read_b128 v[156:159], v12 offset:35968
  v_pk_fma_f16 v136, v160, s53, v136
  v_mfma_f32_16x16x32_f16 v[72:75], a[80:83], v[228:231], v[72:75]
  v_pk_fma_f16 v137, v161, s53, v137
  v_pk_fma_f16 v138, v162, s53, v138
  v_mfma_f32_16x16x32_f16 v[80:83], a[84:87], v[128:131], v[80:83]
  buffer_load_dwordx4 v6, s[28:31], s52 offen sc1 lds
  v_mfma_f32_16x16x32_f16 v[80:83], a[88:91], v[224:227], v[80:83]
  s_addk_i32 m0, 1024
  ds_read_b128 v[144:147], v11 offset:36544
  v_pk_fma_f16 v139, v163, s53, v139
  v_mfma_f32_16x16x32_f16 v[80:83], a[92:95], v[228:231], v[80:83]
  ds_read_b128 v[160:163], v12 offset:36544
  v_lshlrev_b32 v168, 16, v192
  v_mfma_f32_16x16x32_f16 v[88:91], a[72:75], v[224:227], v[88:91]
  buffer_load_dwordx4 v7, s[28:31], s52 offen sc1 lds
  v_mfma_f32_16x16x32_f16 v[88:91], a[76:79], v[228:231], v[88:91]
  s_waitcnt lgkmcnt(2)
  v_pk_fma_f16 v140, v156, s53, v140
  v_pk_fma_f16 v141, v157, s53, v141
  v_mfma_f32_16x16x32_f16 v[88:91], a[80:83], v[232:235], v[88:91]
  s_addk_i32 m0, 1024
  v_pk_fma_f16 v142, v158, s53, v142
  v_pk_fma_f16 v143, v159, s53, v143
  v_mfma_f32_16x16x32_f16 v[96:99], a[84:87], v[224:227], v[96:99]
  ds_read_b128 v[148:151], v11 offset:37120
  v_and_b32 v169, s23, v192
  v_mfma_f32_16x16x32_f16 v[96:99], a[88:91], v[228:231], v[96:99]
  buffer_load_dwordx4 v8, s[28:31], s52 offen sc1 lds
  v_mfma_f32_16x16x32_f16 v[96:99], a[92:95], v[232:235], v[96:99]
  s_waitcnt lgkmcnt(1)
  ds_read_b128 v[156:159], v12 offset:37120
  v_pk_fma_f16 v144, v160, s53, v144
  v_mfma_f32_16x16x32_f16 v[92:95], a[72:75], v[228:231], v[92:95]
  s_addk_i32 m0, 1024
  v_pk_fma_f16 v145, v161, s53, v145
  v_pk_fma_f16 v146, v162, s53, v146
  v_mfma_f32_16x16x32_f16 v[92:95], a[76:79], v[232:235], v[92:95]
  v_pk_fma_f16 v147, v163, s53, v147
  v_lshlrev_b32 v170, 16, v193
  v_mfma_f32_16x16x32_f16 v[92:95], a[80:83], v[236:239], v[92:95]
  buffer_load_dwordx4 v9, s[28:31], s52 offen sc1 lds
  v_mfma_f32_16x16x32_f16 v[100:103], a[84:87], v[228:231], v[100:103]
  s_add_u32 m0, s50, 16384
  ds_read_b128 v[152:155], v11 offset:37696
  v_and_b32 v171, s23, v193
  v_mfma_f32_16x16x32_f16 v[100:103], a[88:91], v[232:235], v[100:103]
  s_waitcnt lgkmcnt(1)
  ds_read_b128 v[160:163], v12 offset:37696
  v_pk_fma_f16 v148, v156, s53, v148
  v_mfma_f32_16x16x32_f16 v[100:103], a[92:95], v[236:239], v[100:103]
  s_waitcnt vmcnt(13)
  v_pk_fma_f16 v149, v157, s53, v149
  v_pk_fma_f16 v150, v158, s53, v150
  v_mfma_f32_16x16x32_f16 v[28:31], a[108:111], v[132:135], v[28:31]
  s_add_u32 s52, s8, 393216
  v_pk_fma_f16 v151, v159, s53, v151
  v_lshlrev_b32 v172, 16, v194
  v_mfma_f32_16x16x32_f16 v[28:31], a[112:115], v[136:139], v[28:31]
  buffer_load_dwordx4 v4, s[28:31], s52 offen sc1 lds
  v_mfma_f32_16x16x32_f16 v[28:31], a[116:119], v[140:143], v[28:31]
  s_waitcnt vmcnt(10)
  ds_read_b128 v[240:243], v11 offset:38272
  v_and_b32 v173, s23, v194
  v_mfma_f32_16x16x32_f16 v[36:39], a[120:123], v[132:135], v[36:39]
  s_waitcnt lgkmcnt(1)
  ds_read_b128 v[156:159], v12 offset:38272
  v_pk_fma_f16 v152, v160, s53, v152
  v_mfma_f32_16x16x32_f16 v[36:39], a[124:127], v[136:139], v[36:39]
  s_addk_i32 s51, 15360
  v_pk_fma_f16 v153, v161, s53, v153
  v_pk_fma_f16 v154, v162, s53, v154
  v_mfma_f32_16x16x32_f16 v[36:39], a[128:131], v[140:143], v[36:39]
L_pg1:
  s_cbranch_execz L_pgback
  s_waitcnt vmcnt(7)
  buffer_load_dwordx4 a[144:147], v10, s[28:31], s51 offen offset:0 sc1
  v_mfma_f32_16x16x32_f16 v[44:47], a[132:135], v[132:135], v[44:47]
  ds_read_b128 v[244:247], v11 offset:38848
  v_pk_fma_f16 v155, v163, s53, v155
  v_mfma_f32_16x16x32_f16 v[44:47], a[136:139], v[136:139], v[44:47]
  buffer_load_dwordx4 a[148:151], v13, s[28:31], s51 offen offset:0 sc1
  v_mfma_f32_16x16x32_f16 v[44:47], a[140:143], v[140:143], v[44:47]
  ds_add_u32 v210, v209 offset:0
  ds_read_b128 v[160:163], v12 offset:38848
  v_mfma_f32_16x16x32_f16 v[32:35], a[108:111], v[136:139], v[32:35]
  s_waitcnt lgkmcnt(3)
  v_pk_fma_f16 v240, v156, s53, v240
  v_pk_fma_f16 v241, v157, s53, v241
  v_mfma_f32_16x16x32_f16 v[32:35], a[112:115], v[140:143], v[32:35]
  v_pk_fma_f16 v242, v158, s53, v242
  v_pk_fma_f16 v243, v159, s53, v243
  v_mfma_f32_16x16x32_f16 v[32:35], a[116:119], v[144:147], v[32:35]
  buffer_load_dwordx4 a[152:155], v14, s[28:31], s51 offen offset:0 sc1
  v_mfma_f32_16x16x32_f16 v[40:43], a[120:123], v[136:139], v[40:43]
  ds_read_b32 v211, v210 offset:0
  ds_read_b128 v[248:251], v11 offset:39424
  v_mfma_f32_16x16x32_f16 v[40:43], a[124:127], v[140:143], v[40:43]
  s_waitcnt lgkmcnt(2)
  ds_read_b128 v[156:159], v12 offset:39424
  v_pk_fma_f16 v244, v160, s53, v244
  v_mfma_f32_16x16x32_f16 v[40:43], a[128:131], v[144:147], v[40:43]
  buffer_load_dwordx4 a[156:159], v10, s[28:31], s51 offen offset:3072 sc1
  v_mfma_f32_16x16x32_f16 v[64:67], a[132:135], v[136:139], v[64:67]
  v_pk_fma_f16 v245, v161, s53, v245
  v_pk_fma_f16 v246, v162, s53, v246
  v_mfma_f32_16x16x32_f16 v[64:67], a[136:139], v[140:143], v[64:67]
  ds_read_b128 v[252:255], v11 offset:40000
  v_pk_fma_f16 v247, v163, s53, v247
  v_mfma_f32_16x16x32_f16 v[64:67], a[140:143], v[144:147], v[64:67]
  ds_read_b128 v[160:163], v12 offset:40000
  v_lshlrev_b32 v174, 16, v195
  v_mfma_f32_16x16x32_f16 v[48:51], a[108:111], v[140:143], v[48:51]
  buffer_load_dwordx4 a[160:163], v13, s[28:31], s51 offen offset:3072 sc1
  v_mfma_f32_16x16x32_f16 v[48:51], a[112:115], v[144:147], v[48:51]
  s_waitcnt lgkmcnt(2)
  v_pk_fma_f16 v248, v156, s53, v248
  v_cmp_le_u32 vcc, 16, v211
  v_mfma_f32_16x16x32_f16 v[48:51], a[116:119], v[148:151], v[48:51]
  v_pk_fma_f16 v249, v157, s53, v249
  v_pk_fma_f16 v250, v158, s53, v250
  v_mfma_f32_16x16x32_f16 v[56:59], a[120:123], v[140:143], v[56:59]
  s_cbranch_vccz L_sfail31
L_sok32:
  v_pk_fma_f16 v251, v159, s53, v251
  v_mfma_f32_16x16x32_f16 v[56:59], a[124:127], v[144:147], v[56:59]
  buffer_load_dwordx4 a[164:167], v14, s[28:31], s51 offen offset:3072 sc1
  v_mfma_f32_16x16x32_f16 v[56:59], a[128:131], v[148:151], v[56:59]
  s_waitcnt lgkmcnt(0)
  ds_read_b128 v[108:111], v11 offset:4096
  v_pk_fma_f16 v252, v160, s53, v252
  v_mfma_f32_16x16x32_f16 v[84:87], a[132:135], v[140:143], v[84:87]
  s_add_u32 s19, s51, s18
  ds_read_b128 v[156:159], v12 offset:4096
  v_pk_fma_f16 v253, v161, s53, v253
  v_mfma_f32_16x16x32_f16 v[84:87], a[136:139], v[144:147], v[84:87]
  buffer_load_dwordx4 a[168:171], v10, s[28:31], s19 offen offset:0 sc1
  v_mfma_f32_16x16x32_f16 v[84:87], a[140:143], v[148:151], v[84:87]
  v_pk_fma_f16 v254, v162, s53, v254
  v_pk_fma_f16 v255, v163, s53, v255
  v_mfma_f32_16x16x32_f16 v[52:55], a[108:111], v[144:147], v[52:55]
  ds_read_b128 v[112:115], v11 offset:4672
  v_and_b32 v175, s23, v195
  v_mfma_f32_16x16x32_f16 v[52:55], a[112:115], v[148:151], v[52:55]
  ds_read_b128 v[160:163], v12 offset:4672
  v_lshlrev_b32 v176, 16, v196
  v_mfma_f32_16x16x32_f16 v[52:55], a[116:119], v[152:155], v[52:55]
  buffer_load_dwordx4 a[172:175], v13, s[28:31], s19 offen offset:0 sc1
  v_mfma_f32_16x16x32_f16 v[60:63], a[120:123], v[144:147], v[60:63]
  s_waitcnt lgkmcnt(2)
  v_pk_fma_f16 v108, v156, s53, v108
  v_pk_fma_f16 v109, v157, s53, v109
  v_mfma_f32_16x16x32_f16 v[60:63], a[124:127], v[148:151], v[60:63]
  s_addk_i32 m0, 1024
  v_pk_fma_f16 v110, v158, s53, v110
  v_pk_fma_f16 v111, v159, s53, v111
  v_mfma_f32_16x16x32_f16 v[60:63], a[128:131], v[152:155], v[60:63]
  ds_read_b128 v[116:119], v11 offset:5248
  v_and_b32 v177, s23, v196
  v_mfma_f32_16x16x32_f16 v[104:107], a[132:135], v[144:147], v[104:107]
  buffer_load_dwordx4 v5, s[28:31], s52 offen sc1 lds
  v_mfma_f32_16x16x32_f16 v[104:107], a[136:139], v[148:151], v[104:107]
  s_waitcnt lgkmcnt(1)
  ds_read_b128 v[156:159], v12 offset:5248
  v_pk_fma_f16 v112, v160, s53, v112
  v_mfma_f32_16x16x32_f16 v[104:107], a[140:143], v[152:155], v[104:107]
  v_pk_fma_f16 v113, v161, s53, v113
  v_pk_fma_f16 v114, v162, s53, v114
  v_mfma_f32_16x16x32_f16 v[68:71], a[108:111], v[148:151], v[68:71]
  buffer_load_dwordx4 a[176:179], v14, s[28:31], s19 offen offset:0 sc1
  v_mfma_f32_16x16x32_f16 v[68:71], a[112:115], v[152:155], v[68:71]
  s_addk_i32 m0, 1024
  ds_read_b128 v[120:123], v11 offset:5824
  v_pk_fma_f16 v115, v163, s53, v115
  v_mfma_f32_16x16x32_f16 v[68:71], a[116:119], v[240:243], v[68:71]
  ds_read_b128 v[160:163], v12 offset:5824
  v_lshlrev_b32 v178, 16, v197
  v_mfma_f32_16x16x32_f16 v[76:79], a[120:123], v[148:151], v[76:79]
  s_waitcnt lgkmcnt(2)
  v_pk_fma_f16 v116, v156, s53, v116
  v_pk_fma_f16 v117, v157, s53, v117
  v_mfma_f32_16x16x32_f16 v[76:79], a[124:127], v[152:155], v[76:79]
  buffer_load_dwordx4 v6, s[28:31], s52 offen sc1 lds
  v_mfma_f32_16x16x32_f16 v[76:79], a[128:131], v[240:243], v[76:79]
  s_addk_i32 m0, 1024
  v_pk_fma_f16 v118, v158, s53, v118
  v_pk_fma_f16 v119, v159, s53, v119
  v_mfma_f32_16x16x32_f16 v[72:75], a[108:111], v[152:155], v[72:75]
  ds_read_b128 v[124:127], v11 offset:6400
  v_and_b32 v179, s23, v197
  v_mfma_f32_16x16x32_f16 v[72:75], a[112:115], v[240:243], v[72:75]
  ds_read_b128 v[156:159], v12 offset:6400
  v_lshlrev_b32 v180, 16, v200
  v_mfma_f32_16x16x32_f16 v[72:75], a[116:119], v[244:247], v[72:75]
  buffer_load_dwordx4 v7, s[28:31], s52 offen sc1 lds
  v_mfma_f32_16x16x32_f16 v[80:83], a[120:123], v[152:155], v[80:83]
  s_waitcnt lgkmcnt(2)
  v_pk_fma_f16 v120, v160, s53, v120
  v_pk_fma_f16 v121, v161, s53, v121
  v_mfma_f32_16x16x32_f16 v[80:83], a[124:127], v[240:243], v[80:83]
  s_addk_i32 m0, 1024
  v_pk_fma_f16 v122, v162, s53, v122
  v_pk_fma_f16 v123, v163, s53, v123
  v_mfma_f32_16x16x32_f16 v[80:83], a[128:131], v[244:247], v[80:83]
  buffer_load_dwordx4 v8, s[28:31], s52 offen sc1 lds
  v_mfma_f32_16x16x32_f16 v[88:91], a[108:111], v[240:243], v[88:91]
  s_addk_i32 m0, 1024
  ds_read_b128 v[128:131], v11 offset:6976
  v_and_b32 v181, s23, v200
  v_mfma_f32_16x16x32_f16 v[88:91], a[112:115], v[244:247], v[88:91]
  s_waitcnt lgkmcnt(1)
  ds_read_b128 v[160:163], v12 offset:6976
  v_pk_fma_f16 v124, v156, s53, v124
  v_mfma_f32_16x16x32_f16 v[88:91], a[116:119], v[248:251], v[88:91]
  v_pk_fma_f16 v125, v157, s53, v125
  v_pk_fma_f16 v126, v158, s53, v126
  v_mfma_f32_16x16x32_f16 v[96:99], a[120:123], v[240:243], v[96:99]
  buffer_load_dwordx4 v9, s[28:31], s52 offen sc1 lds
  v_mfma_f32_16x16x32_f16 v[96:99], a[124:127], v[244:247], v[96:99]
  s_add_u32 m0, s50, 22528
  ds_read_b128 v[224:227], v11 offset:7552
  v_pk_fma_f16 v127, v159, s53, v127
  v_mfma_f32_16x16x32_f16 v[96:99], a[128:131], v[248:251], v[96:99]
  s_add_u32 s52, s8, 458752
  ds_read_b128 v[156:159], v12 offset:7552
  v_mul_f32 v180, s56, v180
  v_mfma_f32_16x16x32_f16 v[92:95], a[108:111], v[244:247], v[92:95]
  s_waitcnt lgkmcnt(2)
  v_pk_fma_f16 v128, v160, s53, v128
  v_pk_fma_f16 v129, v161, s53, v129
  v_mfma_f32_16x16x32_f16 v[92:95], a[112:115], v[248:251], v[92:95]
  buffer_load_dwordx4 v4, s[28:31], s52 offen sc1 lds
  v_mfma_f32_16x16x32_f16 v[92:95], a[116:119], v[252:255], v[92:95]
  s_waitcnt vmcnt(16)
  ds_add_u32 v210, v209 offset:0
  v_pk_fma_f16 v130, v162, s53, v130
  v_mfma_f32_16x16x32_f16 v[100:103], a[120:123], v[244:247], v[100:103]
  s_addk_i32 m0, 1024
  ds_read_b128 v[228:231], v11 offset:8128
  v_pk_fma_f16 v131, v163, s53, v131
  v_mfma_f32_16x16x32_f16 v[100:103], a[124:127], v[248:251], v[100:103]
  buffer_load_dwordx4 v5, s[28:31], s52 offen sc1 lds
  v_mfma_f32_16x16x32_f16 v[100:103], a[128:131], v[252:255], v[100:103]
  s_waitcnt vmcnt(13) lgkmcnt(2)
  ds_read_b128 v[160:163], v12 offset:8128
  v_pk_fma_f16 v224, v156, s53, v224
  v_mfma_f32_16x16x32_f16 v[28:31], a[144:147], v[108:111], v[28:31]
  s_addk_i32 s51, 15360
  ds_read_b32 v211, v210 offset:0
  v_pk_fma_f16 v225, v157, s53, v225
  v_mfma_f32_16x16x32_f16 v[28:31], a[148:151], v[112:115], v[28:31]
  v_pk_fma_f16 v226, v158, s53, v226
  v_pk_fma_f16 v227, v159, s53, v227
  v_mfma_f32_16x16x32_f16 v[28:31], a[152:155], v[116:119], v[28:31]
  s_waitcnt vmcnt(10)
  buffer_load_dwordx4 a[180:183], v10, s[28:31], s51 offen offset:0 sc1
  v_mfma_f32_16x16x32_f16 v[36:39], a[156:159], v[108:111], v[36:39]
  ds_read_b128 v[232:235], v11 offset:8704
  v_mul_f32 v181, s56, v181
  v_mfma_f32_16x16x32_f16 v[36:39], a[160:163], v[112:115], v[36:39]
  s_waitcnt lgkmcnt(2)
  ds_read_b128 v[156:159], v12 offset:8704
  v_pk_fma_f16 v228, v160, s53, v228
  v_mfma_f32_16x16x32_f16 v[36:39], a[164:167], v[116:119], v[36:39]
  s_waitcnt vmcnt(7)
  v_pk_fma_f16 v229, v161, s53, v229
  v_pk_fma_f16 v230, v162, s53, v230
  v_mfma_f32_16x16x32_f16 v[44:47], a[168:171], v[108:111], v[44:47]
  buffer_load_dwordx4 a[184:187], v13, s[28:31], s51 offen offset:0 sc1
  v_mfma_f32_16x16x32_f16 v[44:47], a[172:175], v[112:115], v[44:47]
  s_waitcnt lgkmcnt(2)
  ds_read_b128 v[236:239], v11 offset:9280
  v_cmp_le_u32 vcc, 20, v211
  v_mfma_f32_16x16x32_f16 v[44:47], a[176:179], v[116:119], v[44:47]
  v_pk_fma_f16 v231, v163, s53, v231
  v_lshlrev_b32 v182, 16, v201
  v_mfma_f32_16x16x32_f16 v[32:35], a[144:147], v[112:115], v[32:35]
  buffer_load_dwordx4 a[188:191], v14, s[28:31], s51 offen offset:0 sc1
  v_mfma_f32_16x16x32_f16 v[32:35], a[148:151], v[116:119], v[32:35]
  s_cbranch_vccz L_sfail34
L_sok35:
  ds_read_b128 v[160:163], v12 offset:9280
  v_mfma_f32_16x16x32_f16 v[32:35], a[152:155], v[120:123], v[32:35]
  s_waitcnt lgkmcnt(2)
  v_pk_fma_f16 v232, v156, s53, v232
  v_pk_fma_f16 v233, v157, s53, v233
  v_mfma_f32_16x16x32_f16 v[40:43], a[156:159], v[112:115], v[40:43]
  ds_read_b128 v[132:135], v11 offset:10240
  v_pk_fma_f16 v234, v158, s53, v234
  v_mfma_f32_16x16x32_f16 v[40:43], a[160:163], v[116:119], v[40:43]
  v_pk_fma_f16 v235, v159, s53, v235
  v_and_b32 v183, s23, v201
  v_mfma_f32_16x16x32_f16 v[40:43], a[164:167], v[120:123], v[40:43]
  buffer_load_dwordx4 a[192:195], v10, s[28:31], s51 offen offset:3072 sc1
  v_mfma_f32_16x16x32_f16 v[64:67], a[168:171], v[112:115], v[64:67]
  s_waitcnt lgkmcnt(1)
  ds_read_b128 v[156:159], v12 offset:10240
  v_pk_fma_f16 v236, v160, s53, v236
  v_mfma_f32_16x16x32_f16 v[64:67], a[172:175], v[116:119], v[64:67]
  s_addk_i32 m0, 1024
  v_pk_fma_f16 v237, v161, s53, v237
  v_pk_fma_f16 v238, v162, s53, v238
  v_mfma_f32_16x16x32_f16 v[64:67], a[176:179], v[120:123], v[64:67]
  buffer_load_dwordx4 v6, s[28:31], s52 offen sc1 lds
  v_mfma_f32_16x16x32_f16 v[48:51], a[144:147], v[116:119], v[48:51]
  ds_read_b128 v[136:139], v11 offset:10816
  v_pk_fma_f16 v239, v163, s53, v239
  v_mfma_f32_16x16x32_f16 v[48:51], a[148:151], v[120:123], v[48:51]
  s_waitcnt lgkmcnt(1)
  ds_read_b128 v[160:163], v12 offset:10816
  v_pk_fma_f16 v132, v156, s53, v132
  v_mfma_f32_16x16x32_f16 v[48:51], a[152:155], v[124:127], v[48:51]
  buffer_load_dwordx4 a[196:199], v13, s[28:31], s51 offen offset:3072 sc1
  v_mfma_f32_16x16x32_f16 v[56:59], a[156:159], v[116:119], v[56:59]
  ds_read_b128 v[140:143], v11 offset:11392
  v_pk_fma_f16 v133, v157, s53, v133
  v_mfma_f32_16x16x32_f16 v[56:59], a[160:163], v[120:123], v[56:59]
  v_pk_fma_f16 v134, v158, s53, v134
  v_pk_fma_f16 v135, v159, s53, v135
  v_mfma_f32_16x16x32_f16 v[56:59], a[164:167], v[124:127], v[56:59]
  ds_read_b128 v[156:159], v12 offset:11392
  v_mul_f32 v182, s56, v182
  v_mfma_f32_16x16x32_f16 v[84:87], a[168:171], v[116:119], v[84:87]
  buffer_load_dwordx4 a[200:203], v14, s[28:31], s51 offen offset:3072 sc1
  v_mfma_f32_16x16x32_f16 v[84:87], a[172:175], v[120:123], v[84:87]
  s_waitcnt lgkmcnt(2)
  v_pk_fma_f16 v136, v160, s53, v136
  v_pk_fma_f16 v137, v161, s53, v137
  v_mfma_f32_16x16x32_f16 v[84:87], a[176:179], v[124:127], v[84:87]
  s_add_u32 s19, s51, s18
  ds_read_b128 v[144:147], v11 offset:11968
  v_pk_fma_f16 v138, v162, s53, v138
  v_mfma_f32_16x16x32_f16 v[52:55], a[144:147], v[120:123], v[52:55]
  v_pk_fma_f16 v139, v163, s53, v139
  v_mul_f32 v183, s56, v183
  v_mfma_f32_16x16x32_f16 v[52:55], a[148:151], v[124:127], v[52:55]
  buffer_load_dwordx4 a[204:207], v10, s[28:31], s19 offen offset:0 sc1
  v_mfma_f32_16x16x32_f16 v[52:55], a[152:155], v[128:131], v[52:55]
  s_waitcnt lgkmcnt(1)
  ds_read_b128 v[160:163], v12 offset:11968
  v_pk_fma_f16 v140, v156, s53, v140
  v_mfma_f32_16x16x32_f16 v[60:63], a[156:159], v[120:123], v[60:63]
  v_pk_fma_f16 v141, v157, s53, v141
  v_pk_fma_f16 v142, v158, s53, v142
  v_mfma_f32_16x16x32_f16 v[60:63], a[160:163], v[124:127], v[60:63]
  buffer_load_dwordx4 a[208:211], v13, s[28:31], s19 offen offset:0 sc1
  v_mfma_f32_16x16x32_f16 v[60:63], a[164:167], v[128:131], v[60:63]
  ds_read_b128 v[148:151], v11 offset:12544
  v_pk_fma_f16 v143, v159, s53, v143
  v_mfma_f32_16x16x32_f16 v[104:107], a[168:171], v[120:123], v[104:107]
  s_waitcnt lgkmcnt(1)
  ds_read_b128 v[156:159], v12 offset:12544
  v_pk_fma_f16 v144, v160, s53, v144
  v_mfma_f32_16x16x32_f16 v[104:107], a[172:175], v[124:127], v[104:107]
  v_pk_fma_f16 v145, v161, s53, v145
  v_pk_fma_f16 v146, v162, s53, v146
  v_mfma_f32_16x16x32_f16 v[104:107], a[176:179], v[128:131], v[104:107]
  buffer_load_dwordx4 a[212:215], v14, s[28:31], s19 offen offset:0 sc1
  v_mfma_f32_16x16x32_f16 v[68:71], a[144:147], v[124:127], v[68:71]
  s_addk_i32 m0, 1024
  ds_read_b128 v[152:155], v11 offset:13120
  v_pk_fma_f16 v147, v163, s53, v147
  v_mfma_f32_16x16x32_f16 v[68:71], a[148:151], v[128:131], v[68:71]
  ds_read_b128 v[160:163], v12 offset:13120
  v_lshlrev_b32 v184, 16, v202
  v_mfma_f32_16x16x32_f16 v[68:71], a[152:155], v[224:227], v[68:71]
  s_waitcnt lgkmcnt(2)
  v_pk_fma_f16 v148, v156, s53, v148
  v_pk_fma_f16 v149, v157, s53, v149
  v_mfma_f32_16x16x32_f16 v[76:79], a[156:159], v[124:127], v[76:79]
  buffer_load_dwordx4 v7, s[28:31], s52 offen sc1 lds
  v_mfma_f32_16x16x32_f16 v[76:79], a[160:163], v[128:131], v[76:79]
  s_addk_i32 m0, 1024
  v_pk_fma_f16 v150, v158, s53, v150
  v_pk_fma_f16 v151, v159, s53, v151
  v_mfma_f32_16x16x32_f16 v[76:79], a[164:167], v[224:227], v[76:79]
  ds_read_b128 v[240:243], v11 offset:13696
  v_and_b32 v185, s23, v202
  v_mfma_f32_16x16x32_f16 v[72:75], a[144:147], v[128:131], v[72:75]
  buffer_load_dwordx4 v8, s[28:31], s52 offen sc1 lds
  v_mfma_f32_16x16x32_f16 v[72:75], a[148:151], v[224:227], v[72:75]
  s_waitcnt lgkmcnt(1)
  ds_read_b128 v[156:159], v12 offset:13696
  v_pk_fma_f16 v152, v160, s53, v152
  v_mfma_f32_16x16x32_f16 v[72:75], a[152:155], v[228:231], v[72:75]
  s_waitcnt vmcnt(14)
  ds_add_u32 v210, v209 offset:0
  v_pk_fma_f16 v153, v161, s53, v153
  v_mfma_f32_16x16x32_f16 v[80:83], a[156:159], v[128:131], v[80:83]
  s_addk_i32 m0, 1024
  v_pk_fma_f16 v154, v162, s53, v154
  v_pk_fma_f16 v155, v163, s53, v155
  v_mfma_f32_16x16x32_f16 v[80:83], a[160:163], v[224:227], v[80:83]
  buffer_load_dwordx4 v9, s[28:31], s52 offen sc1 lds
  v_mfma_f32_16x16x32_f16 v[80:83], a[164:167], v[228:231], v[80:83]
  s_add_u32 m0, s50, 28672
  ds_read_b128 v[244:247], v11 offset:14272
  v_mul_f32 v184, s56, v184
  v_mfma_f32_16x16x32_f16 v[88:91], a[144:147], v[224:227], v[88:91]
  s_add_u32 s52, s8, 524288
  ds_read_b32 v211, v210 offset:0
  ds_read_b128 v[160:163], v12 offset:14272
  v_mfma_f32_16x16x32_f16 v[88:91], a[148:151], v[228:231], v[88:91]
  s_waitcnt lgkmcnt(4)
  v_pk_fma_f16 v240, v156, s53, v240
  v_pk_fma_f16 v241, v157, s53, v241
  v_mfma_f32_16x16x32_f16 v[88:91], a[152:155], v[232:235], v[88:91]
  buffer_load_dwordx4 v4, s[28:31], s52 offen sc1 lds
  v_mfma_f32_16x16x32_f16 v[96:99], a[156:159], v[224:227], v[96:99]
  s_addk_i32 m0, 1024
  ds_read_b128 v[248:251], v11 offset:14848
  v_pk_fma_f16 v242, v158, s53, v242
  v_mfma_f32_16x16x32_f16 v[96:99], a[160:163], v[228:231], v[96:99]
  v_pk_fma_f16 v243, v159, s53, v243
  v_mul_f32 v185, s56, v185
  v_mfma_f32_16x16x32_f16 v[96:99], a[164:167], v[232:235], v[96:99]
  buffer_load_dwordx4 v5, s[28:31], s52 offen sc1 lds
  v_mfma_f32_16x16x32_f16 v[92:95], a[144:147], v[228:231], v[92:95]
  s_waitcnt lgkmcnt(1)
  ds_read_b128 v[156:159], v12 offset:14848
  v_pk_fma_f16 v244, v160, s53, v244
  v_mfma_f32_16x16x32_f16 v[92:95], a[148:151], v[232:235], v[92:95]
  s_addk_i32 m0, 1024
  v_pk_fma_f16 v245, v161, s53, v245
  v_cmp_le_u32 vcc, 24, v211
  v_mfma_f32_16x16x32_f16 v[92:95], a[152:155], v[236:239], v[92:95]
  ds_read_b128 v[252:255], v11 offset:15424
  v_pk_fma_f16 v246, v162, s53, v246
  v_mfma_f32_16x16x32_f16 v[100:103], a[156:159], v[228:231], v[100:103]
  s_cbranch_vccz L_sfail37
L_sok38:
  v_pk_fma_f16 v247, v163, s53, v247
  v_mfma_f32_16x16x32_f16 v[100:103], a[160:163], v[232:235], v[100:103]
  buffer_load_dwordx4 v6, s[28:31], s52 offen sc1 lds
  v_mfma_f32_16x16x32_f16 v[100:103], a[164:167], v[236:239], v[100:103]
  s_waitcnt vmcnt(13) lgkmcnt(1)
  ds_read_b128 v[160:163], v12 offset:15424
  v_pk_fma_f16 v248, v156, s53, v248
  v_mfma_f32_16x16x32_f16 v[28:31], a[180:183], v[132:135], v[28:31]
  s_addk_i32 m0, 1024
  v_pk_fma_f16 v249, v157, s53, v249
  v_pk_fma_f16 v250, v158, s53, v250
  v_mfma_f32_16x16x32_f16 v[28:31], a[184:187], v[136:139], v[28:31]
  buffer_load_dwordx4 v7, s[28:31], s52 offen sc1 lds
  v_mfma_f32_16x16x32_f16 v[28:31], a[188:191], v[140:143], v[28:31]
  s_waitcnt vmcnt(10)
  ds_read_b128 v[108:111], v11 offset:16384
  v_pk_fma_f16 v251, v159, s53, v251
  v_mfma_f32_16x16x32_f16 v[36:39], a[192:195], v[132:135], v[36:39]
  s_waitcnt lgkmcnt(1)
  ds_read_b128 v[156:159], v12 offset:16384
  v_pk_fma_f16 v252, v160, s53, v252
  v_mfma_f32_16x16x32_f16 v[36:39], a[196:199], v[136:139], v[36:39]
  s_addk_i32 s51, 15360
  v_pk_fma_f16 v253, v161, s53, v253
  v_pk_fma_f16 v254, v162, s53, v254
  v_mfma_f32_16x16x32_f16 v[36:39], a[200:203], v[140:143], v[36:39]
  s_waitcnt vmcnt(7)
  buffer_load_dwordx4 a[216:219], v10, s[28:31], s51 offen offset:0 sc1
  v_mfma_f32_16x16x32_f16 v[44:47], a[204:207], v[132:135], v[44:47]
  ds_read_b128 v[112:115], v11 offset:16960
  v_pk_fma_f16 v255, v163, s53, v255
  v_mfma_f32_16x16x32_f16 v[44:47], a[208:211], v[136:139], v[44:47]
  ds_read_b128 v[160:163], v12 offset:16960
  v_lshlrev_b32 v186, 16, v203
  v_mfma_f32_16x16x32_f16 v[44:47], a[212:215], v[140:143], v[44:47]
  buffer_load_dwordx4 a[220:223], v13, s[28:31], s51 offen offset:0 sc1
  v_mfma_f32_16x16x32_f16 v[32:35], a[180:183], v[136:139], v[32:35]
  s_waitcnt lgkmcnt(2)
  v_pk_fma_f16 v108, v156, s53, v108
  v_pk_fma_f16 v109, v157, s53, v109
  v_mfma_f32_16x16x32_f16 v[32:35], a[184:187], v[140:143], v[32:35]
  v_pk_fma_f16 v110, v158, s53, v110
  v_pk_fma_f16 v111, v159, s53, v111
  v_mfma_f32_16x16x32_f16 v[32:35], a[188:191], v[144:147], v[32:35]
  ds_read_b128 v[116:119], v11 offset:17536
  v_and_b32 v187, s23, v203
  v_mfma_f32_16x16x32_f16 v[40:43], a[192:195], v[136:139], v[40:43]
  buffer_load_dwordx4 a[224:227], v14, s[28:31], s51 offen offset:0 sc1
  v_mfma_f32_16x16x32_f16 v[40:43], a[196:199], v[140:143], v[40:43]
  s_waitcnt lgkmcnt(1)
  ds_read_b128 v[156:159], v12 offset:17536
  v_pk_fma_f16 v112, v160, s53, v112
  v_mfma_f32_16x16x32_f16 v[40:43], a[200:203], v[144:147], v[40:43]
  v_pk_fma_f16 v113, v161, s53, v113
  v_pk_fma_f16 v114, v162, s53, v114
  v_mfma_f32_16x16x32_f16 v[64:67], a[204:207], v[136:139], v[64:67]
  buffer_load_dwordx4 a[228:231], v10, s[28:31], s51 offen offset:3072 sc1
  v_mfma_f32_16x16x32_f16 v[64:67], a[208:211], v[140:143], v[64:67]
  ds_read_b128 v[120:123], v11 offset:18112
  v_pk_fma_f16 v115, v163, s53, v115
  v_mfma_f32_16x16x32_f16 v[64:67], a[212:215], v[144:147], v[64:67]
  ds_read_b128 v[160:163], v12 offset:18112
  v_mul_f32 v186, s56, v186
  v_mfma_f32_16x16x32_f16 v[48:51], a[180:183], v[140:143], v[48:51]
  s_waitcnt lgkmcnt(2)
  v_pk_fma_f16 v116, v156, s53, v116
  v_pk_fma_f16 v117, v157, s53, v117
  v_mfma_f32_16x16x32_f16 v[48:51], a[184:187], v[144:147], v[48:51]
  buffer_load_dwordx4 a[232:235], v13, s[28:31], s51 offen offset:3072 sc1
  v_mfma_f32_16x16x32_f16 v[48:51], a[188:191], v[148:151], v[48:51]
  ds_read_b128 v[124:127], v11 offset:18688
  v_pk_fma_f16 v118, v158, s53, v118
  v_mfma_f32_16x16x32_f16 v[56:59], a[192:195], v[140:143], v[56:59]
  v_pk_fma_f16 v119, v159, s53, v119
  v_mul_f32 v187, s56, v187
  v_mfma_f32_16x16x32_f16 v[56:59], a[196:199], v[144:147], v[56:59]
  ds_read_b128 v[156:159], v12 offset:18688
  v_lshlrev_b32 v188, 16, v204
  v_mfma_f32_16x16x32_f16 v[56:59], a[200:203], v[148:151], v[56:59]
  buffer_load_dwordx4 a[236:239], v14, s[28:31], s51 offen offset:3072 sc1
  v_mfma_f32_16x16x32_f16 v[84:87], a[204:207], v[140:143], v[84:87]
  s_waitcnt lgkmcnt(2)
  v_pk_fma_f16 v120, v160, s53, v120
  v_pk_fma_f16 v121, v161, s53, v121
  v_mfma_f32_16x16x32_f16 v[84:87], a[208:211], v[144:147], v[84:87]
  s_add_u32 s19, s51, s18
  ds_read_b128 v[128:131], v11 offset:19264
  v_pk_fma_f16 v122, v162, s53, v122
  v_mfma_f32_16x16x32_f16 v[84:87], a[212:215], v[148:151], v[84:87]
  buffer_load_dwordx4 a[240:243], v10, s[28:31], s19 offen offset:0 sc1
  v_mfma_f32_16x16x32_f16 v[52:55], a[180:183], v[144:147], v[52:55]
  s_waitcnt lgkmcnt(1)
  v_pk_fma_f16 v123, v163, s53, v123
  v_pk_fma_f16 v124, v156, s53, v124
  v_mfma_f32_16x16x32_f16 v[52:55], a[184:187], v[148:151], v[52:55]
  s_addk_i32 m0, 1024
  ds_read_b128 v[160:163], v12 offset:19264
  v_pk_fma_f16 v125, v157, s53, v125
  v_mfma_f32_16x16x32_f16 v[52:55], a[188:191], v[152:155], v[52:55]
  v_pk_fma_f16 v126, v158, s53, v126
  v_pk_fma_f16 v127, v159, s53, v127
  v_mfma_f32_16x16x32_f16 v[60:63], a[192:195], v[144:147], v[60:63]
  buffer_load_dwordx4 v8, s[28:31], s52 offen sc1 lds
  v_mfma_f32_16x16x32_f16 v[60:63], a[196:199], v[148:151], v[60:63]
  ds_read_b128 v[224:227], v11 offset:19840
  v_and_b32 v189, s23, v204
  v_mfma_f32_16x16x32_f16 v[60:63], a[200:203], v[152:155], v[60:63]
  s_waitcnt vmcnt(12)
  ds_add_u32 v210, v209 offset:0
  ds_read_b128 v[156:159], v12 offset:19840
  v_mfma_f32_16x16x32_f16 v[104:107], a[204:207], v[144:147], v[104:107]
  s_waitcnt lgkmcnt(3)
  v_pk_fma_f16 v128, v160, s53, v128
  v_pk_fma_f16 v129, v161, s53, v129
  v_mfma_f32_16x16x32_f16 v[104:107], a[208:211], v[148:151], v[104:107]
  buffer_load_dwordx4 a[244:247], v13, s[28:31], s19 offen offset:0 sc1
  v_mfma_f32_16x16x32_f16 v[104:107], a[212:215], v[152:155], v[104:107]
  ds_read_b128 v[228:231], v11 offset:20416
  v_pk_fma_f16 v130, v162, s53, v130
  v_mfma_f32_16x16x32_f16 v[68:71], a[180:183], v[148:151], v[68:71]
  ds_read_b32 v211, v210 offset:0
  v_pk_fma_f16 v131, v163, s53, v131
  v_mfma_f32_16x16x32_f16 v[68:71], a[184:187], v[152:155], v[68:71]
  s_waitcnt lgkmcnt(2)
  ds_read_b128 v[160:163], v12 offset:20416
  v_pk_fma_f16 v224, v156, s53, v224
  v_mfma_f32_16x16x32_f16 v[68:71], a[188:191], v[240:243], v[68:71]
  buffer_load_dwordx4 a[248:251], v14, s[28:31], s19 offen offset:0 sc1
  v_mfma_f32_16x16x32_f16 v[76:79], a[192:195], v[148:151], v[76:79]
  s_addk_i32 m0, 1024
  v_pk_fma_f16 v225, v157, s53, v225
  v_pk_fma_f16 v226, v158, s53, v226
  v_mfma_f32_16x16x32_f16 v[76:79], a[196:199], v[152:155], v[76:79]
  ds_read_b128 v[232:235], v11 offset:20992
  v_pk_fma_f16 v227, v159, s53, v227
  v_mfma_f32_16x16x32_f16 v[76:79], a[200:203], v[240:243], v[76:79]
  buffer_load_dwordx4 v9, s[28:31], s52 offen sc1 lds
  v_mfma_f32_16x16x32_f16 v[72:75], a[180:183], v[152:155], v[72:75]
  s_waitcnt lgkmcnt(1)
  ds_read_b128 v[156:159], v12 offset:20992
  v_pk_fma_f16 v228, v160, s53, v228
  v_mfma_f32_16x16x32_f16 v[72:75], a[184:187], v[240:243], v[72:75]
  s_add_u32 m0, s50, 34816
  v_pk_fma_f16 v229, v161, s53, v229
  v_cmp_le_u32 vcc, 28, v211
  v_mfma_f32_16x16x32_f16 v[72:75], a[188:191], v[244:247], v[72:75]
  s_add_u32 s52, s8, 589824
  v_pk_fma_f16 v230, v162, s53, v230
  v_pk_fma_f16 v231, v163, s53, v231
  v_mfma_f32_16x16x32_f16 v[80:83], a[192:195], v[152:155], v[80:83]
  buffer_load_dwordx4 v4, s[28:31], s52 offen sc1 lds
  v_mfma_f32_16x16x32_f16 v[80:83], a[196:199], v[240:243], v[80:83]
  s_addk_i32 m0, 1024
  s_cbranch_vccz L_sfail40
L_sok41:
  ds_read_b128 v[236:239], v11 offset:21568
  v_mfma_f32_16x16x32_f16 v[80:83], a[200:203], v[244:247], v[80:83]
  s_waitcnt lgkmcnt(1)
  ds_read_b128 v[160:163], v12 offset:21568
  v_pk_fma_f16 v232, v156, s53, v232
  v_mfma_f32_16x16x32_f16 v[88:91], a[180:183], v[240:243], v[88:91]
  v_pk_fma_f16 v233, v157, s53, v233
  v_pk_fma_f16 v234, v158, s53, v234
  v_mfma_f32_16x16x32_f16 v[88:91], a[184:187], v[244:247], v[88:91]
  buffer_load_dwordx4 v5, s[28:31], s52 offen sc1 lds
  v_mfma_f32_16x16x32_f16 v[88:91], a[188:191], v[248:251], v[88:91]
  s_addk_i32 m0, 1024
  ds_read_b128 v[132:135], v11 offset:22528
  v_pk_fma_f16 v235, v159, s53, v235
  v_mfma_f32_16x16x32_f16 v[96:99], a[192:195], v[240:243], v[96:99]
  ds_read_b128 v[156:159], v12 offset:22528
  v_mul_f32 v188, s56, v188
  v_mfma_f32_16x16x32_f16 v[96:99], a[196:199], v[244:247], v[96:99]
  s_waitcnt lgkmcnt(2)
  v_pk_fma_f16 v236, v160, s53, v236
  v_pk_fma_f16 v237, v161, s53, v237
  v_mfma_f32_16x16x32_f16 v[96:99], a[200:203], v[248:251], v[96:99]
  buffer_load_dwordx4 v6, s[28:31], s52 offen sc1 lds
  v_mfma_f32_16x16x32_f16 v[92:95], a[180:183], v[244:247], v[92:95]
  s_addk_i32 m0, 1024
  v_pk_fma_f16 v238, v162, s53, v238
  v_pk_fma_f16 v239, v163, s53, v239
  v_mfma_f32_16x16x32_f16 v[92:95], a[184:187], v[248:251], v[92:95]
  ds_read_b128 v[136:139], v11 offset:23104
  v_mul_f32 v189, s56, v189
  v_mfma_f32_16x16x32_f16 v[92:95], a[188:191], v[252:255], v[92:95]
  buffer_load_dwordx4 v7, s[28:31], s52 offen sc1 lds
  v_mfma_f32_16x16x32_f16 v[100:103], a[192:195], v[244:247], v[100:103]
  s_waitcnt lgkmcnt(1)
  ds_read_b128 v[160:163], v12 offset:23104
  v_pk_fma_f16 v132, v156, s53, v132
  v_mfma_f32_16x16x32_f16 v[100:103], a[196:199], v[248:251], v[100:103]
  s_addk_i32 m0, 1024
  v_pk_fma_f16 v133, v157, s53, v133
  v_pk_fma_f16 v134, v158, s53, v134
  v_mfma_f32_16x16x32_f16 v[100:103], a[200:203], v[252:255], v[100:103]
  s_waitcnt vmcnt(12)
  v_pk_fma_f16 v135, v159, s53, v135
  v_lshlrev_b32 v190, 16, v205
  v_mfma_f32_16x16x32_f16 v[28:31], a[216:219], v[108:111], v[28:31]
  buffer_load_dwordx4 v8, s[28:31], s52 offen sc1 lds
  v_mfma_f32_16x16x32_f16 v[28:31], a[220:223], v[112:115], v[28:31]
  s_addk_i32 m0, 1024
  ds_read_b128 v[140:143], v11 offset:23680
  v_and_b32 v191, s23, v205
  v_mfma_f32_16x16x32_f16 v[28:31], a[224:227], v[116:119], v[28:31]
  s_waitcnt vmcnt(10) lgkmcnt(1)
  ds_read_b128 v[156:159], v12 offset:23680
  v_pk_fma_f16 v136, v160, s53, v136
  v_mfma_f32_16x16x32_f16 v[36:39], a[228:231], v[108:111], v[36:39]
L_pg2:
  s_cbranch_execz L_pgback
  v_pk_fma_f16 v137, v161, s53, v137
  v_pk_fma_f16 v138, v162, s53, v138
  v_mfma_f32_16x16x32_f16 v[36:39], a[232:235], v[112:115], v[36:39]
  buffer_load_dwordx4 v9, s[28:31], s52 offen sc1 lds
  v_mfma_f32_16x16x32_f16 v[36:39], a[236:239], v[116:119], v[36:39]
  s_waitcnt vmcnt(7)
  ds_read_b128 v[144:147], v11 offset:24256
  v_pk_fma_f16 v139, v163, s53, v139
  v_mfma_f32_16x16x32_f16 v[44:47], a[240:243], v[108:111], v[44:47]
  s_addk_i32 s51, 15360
  ds_read_b128 v[160:163], v12 offset:24256
  v_mul_f32 v190, s56, v190
  v_mfma_f32_16x16x32_f16 v[44:47], a[244:247], v[112:115], v[44:47]
  s_waitcnt lgkmcnt(2)
  v_pk_fma_f16 v140, v156, s53, v140
  v_pk_fma_f16 v141, v157, s53, v141
  v_mfma_f32_16x16x32_f16 v[44:47], a[248:251], v[116:119], v[44:47]
  buffer_load_dwordx4 a[252:255], v10, s[28:31], s51 offen offset:0 sc1
  v_mfma_f32_16x16x32_f16 v[32:35], a[216:219], v[112:115], v[32:35]
  v_pk_fma_f16 v142, v158, s53, v142
  v_pk_fma_f16 v143, v159, s53, v143
  v_mfma_f32_16x16x32_f16 v[32:35], a[220:223], v[116:119], v[32:35]
  ds_read_b128 v[148:151], v11 offset:24832
  v_mul_f32 v191, s56, v191
  v_mfma_f32_16x16x32_f16 v[32:35], a[224:227], v[120:123], v[32:35]
  buffer_load_dwordx4 a[0:3], v13, s[28:31], s51 offen offset:0 sc1
  v_mfma_f32_16x16x32_f16 v[40:43], a[228:231], v[112:115], v[40:43]
  buffer_load_dword v21, v164, s[28:31], s66 offen sc1
  v_mfma_f32_16x16x32_f16 v[40:43], a[232:235], v[116:119], v[40:43]
  s_waitcnt lgkmcnt(1)
  ds_read_b128 v[156:159], v12 offset:24832
  v_pk_fma_f16 v144, v160, s53, v144
  v_mfma_f32_16x16x32_f16 v[40:43], a[236:239], v[120:123], v[40:43]
  ds_read_b128 v[152:155], v11 offset:25408
  v_pk_fma_f16 v145, v161, s53, v145
  v_mfma_f32_16x16x32_f16 v[64:67], a[240:243], v[112:115], v[64:67]
  buffer_load_dwordx4 a[4:7], v14, s[28:31], s51 offen offset:0 sc1
  v_mfma_f32_16x16x32_f16 v[64:67], a[244:247], v[116:119], v[64:67]
  v_pk_fma_f16 v146, v162, s53, v146
  v_pk_fma_f16 v147, v163, s53, v147
  v_mfma_f32_16x16x32_f16 v[64:67], a[248:251], v[120:123], v[64:67]
  s_waitcnt lgkmcnt(1)
  ds_read_b128 v[160:163], v12 offset:25408
  v_pk_fma_f16 v148, v156, s53, v148
  v_mfma_f32_16x16x32_f16 v[48:51], a[216:219], v[116:119], v[48:51]
  v_pk_fma_f16 v149, v157, s53, v149
  v_pk_fma_f16 v150, v158, s53, v150
  v_mfma_f32_16x16x32_f16 v[48:51], a[220:223], v[120:123], v[48:51]
  buffer_load_dwordx4 a[8:11], v10, s[28:31], s51 offen offset:3072 sc1
  v_mfma_f32_16x16x32_f16 v[48:51], a[224:227], v[124:127], v[48:51]
  s_waitcnt vmcnt(11)
  ds_add_u32 v210, v209 offset:0
  ds_read_b128 v[240:243], v11 offset:25984
  v_mfma_f32_16x16x32_f16 v[56:59], a[228:231], v[116:119], v[56:59]
  s_waitcnt lgkmcnt(2)
  v_pk_fma_f16 v151, v159, s53, v151
  v_pk_fma_f16 v152, v160, s53, v152
  v_mfma_f32_16x16x32_f16 v[56:59], a[232:235], v[120:123], v[56:59]
  ds_read_b128 v[156:159], v12 offset:25984
  v_pk_fma_f16 v153, v161, s53, v153
  v_mfma_f32_16x16x32_f16 v[56:59], a[236:239], v[124:127], v[56:59]
  buffer_load_dwordx4 a[12:15], v13, s[28:31], s51 offen offset:3072 sc1
  v_mfma_f32_16x16x32_f16 v[84:87], a[240:243], v[116:119], v[84:87]
  ds_read_b32 v211, v210 offset:0
  ds_read_b128 v[244:247], v11 offset:26560
  v_mfma_f32_16x16x32_f16 v[84:87], a[244:247], v[120:123], v[84:87]
  v_pk_fma_f16 v154, v162, s53, v154
  v_pk_fma_f16 v155, v163, s53, v155
  v_mfma_f32_16x16x32_f16 v[84:87], a[248:251], v[124:127], v[84:87]
  buffer_load_dwordx4 a[16:19], v14, s[28:31], s51 offen offset:3072 sc1
  v_mfma_f32_16x16x32_f16 v[52:55], a[216:219], v[120:123], v[52:55]
  s_waitcnt lgkmcnt(2)
  ds_read_b128 v[160:163], v12 offset:26560
  v_pk_fma_f16 v240, v156, s53, v240
  v_mfma_f32_16x16x32_f16 v[52:55], a[220:223], v[124:127], v[52:55]
  s_add_u32 s19, s51, s18
  v_pk_fma_f16 v241, v157, s53, v241
  v_pk_fma_f16 v242, v158, s53, v242
  v_mfma_f32_16x16x32_f16 v[52:55], a[224:227], v[128:131], v[52:55]
  ds_read_b128 v[248:251], v11 offset:27136
  v_pk_fma_f16 v243, v159, s53, v243
  v_mfma_f32_16x16x32_f16 v[60:63], a[228:231], v[120:123], v[60:63]
  buffer_load_dwordx4 a[20:23], v10, s[28:31], s19 offen offset:0 sc1
  v_mfma_f32_16x16x32_f16 v[60:63], a[232:235], v[124:127], v[60:63]
  s_waitcnt lgkmcnt(3)
  ds_read_b128 v[156:159], v12 offset:27136
  v_cmp_le_u32 vcc, 32, v211
  v_mfma_f32_16x16x32_f16 v[60:63], a[236:239], v[128:131], v[60:63]
  s_waitcnt lgkmcnt(2)
  v_pk_fma_f16 v244, v160, s53, v244
  v_pk_fma_f16 v245, v161, s53, v245
  v_mfma_f32_16x16x32_f16 v[104:107], a[240:243], v[120:123], v[104:107]
  s_cbranch_vccz L_sfail43
L_sok44:
  v_pk_fma_f16 v246, v162, s53, v246
  v_mfma_f32_16x16x32_f16 v[104:107], a[244:247], v[124:127], v[104:107]
  buffer_load_dwordx4 a[24:27], v13, s[28:31], s19 offen offset:0 sc1
  v_mfma_f32_16x16x32_f16 v[104:107], a[248:251], v[128:131], v[104:107]
  ds_read_b128 v[252:255], v11 offset:27712
  v_pk_fma_f16 v247, v163, s53, v247
  v_mfma_f32_16x16x32_f16 v[68:71], a[216:219], v[124:127], v[68:71]
  s_waitcnt lgkmcnt(1)
  ds_read_b128 v[160:163], v12 offset:27712
  v_pk_fma_f16 v248, v156, s53, v248
  v_mfma_f32_16x16x32_f16 v[68:71], a[220:223], v[128:131], v[68:71]
  v_pk_fma_f16 v249, v157, s53, v249
  v_pk_fma_f16 v250, v158, s53, v250
  v_mfma_f32_16x16x32_f16 v[68:71], a[224:227], v[224:227], v[68:71]
  buffer_load_dwordx4 a[28:31], v14, s[28:31], s19 offen offset:0 sc1
  v_mfma_f32_16x16x32_f16 v[76:79], a[228:231], v[124:127], v[76:79]
  s_addk_i32 s51, 15360
  ds_read_b128 v[108:111], v11 offset:28672
  v_pk_fma_f16 v251, v159, s53, v251
  v_mfma_f32_16x16x32_f16 v[76:79], a[232:235], v[128:131], v[76:79]
  s_waitcnt vmcnt(7)
  ds_read_b128 v[156:159], v12 offset:28672
  v_subrev_u32 v21, s49, v21
  v_mfma_f32_16x16x32_f16 v[76:79], a[236:239], v[224:227], v[76:79]
  s_waitcnt lgkmcnt(2)
  v_pk_fma_f16 v252, v160, s53, v252
  v_pk_fma_f16 v253, v161, s53, v253
  v_mfma_f32_16x16x32_f16 v[72:75], a[216:219], v[128:131], v[72:75]
  v_pk_fma_f16 v254, v162, s53, v254
  v_pk_fma_f16 v255, v163, s53, v255
  v_mfma_f32_16x16x32_f16 v[72:75], a[220:223], v[224:227], v[72:75]
  buffer_load_dwordx4 a[32:35], v10, s[28:31], s51 offen offset:0 sc1
  v_mfma_f32_16x16x32_f16 v[72:75], a[224:227], v[228:231], v[72:75]
  ds_read_b128 v[112:115], v11 offset:29248
  v_cmp_lt_u32 vcc, 1, v21
  v_mfma_f32_16x16x32_f16 v[80:83], a[228:231], v[128:131], v[80:83]
  ds_read_b128 v[160:163], v12 offset:29248
  v_mfma_f32_16x16x32_f16 v[80:83], a[232:235], v[224:227], v[80:83]
  s_waitcnt lgkmcnt(2)
  v_pk_fma_f16 v108, v156, s53, v108
  v_pk_fma_f16 v109, v157, s53, v109
  v_mfma_f32_16x16x32_f16 v[80:83], a[236:239], v[228:231], v[80:83]
  s_cbranch_vccnz L_pfail21
L_pdone19:
  v_pk_fma_f16 v110, v158, s53, v110
  v_pk_fma_f16 v111, v159, s53, v111
  v_mfma_f32_16x16x32_f16 v[88:91], a[216:219], v[224:227], v[88:91]
  buffer_load_dwordx4 a[36:39], v13, s[28:31], s51 offen offset:0 sc1
  v_mfma_f32_16x16x32_f16 v[88:91], a[220:223], v[228:231], v[88:91]
  ds_read_b128 v[116:119], v11 offset:29824
  v_cmp_eq_u32 vcc, 1, v21
  v_mfma_f32_16x16x32_f16 v[88:91], a[224:227], v[232:235], v[88:91]
  ds_read_b128 v[156:159], v12 offset:29824
  v_mfma_f32_16x16x32_f16 v[96:99], a[228:231], v[224:227], v[96:99]
  s_waitcnt lgkmcnt(2)
  v_pk_fma_f16 v112, v160, s53, v112
  v_pk_fma_f16 v113, v161, s53, v113
  v_mfma_f32_16x16x32_f16 v[96:99], a[232:235], v[228:231], v[96:99]
  s_cbranch_vccnz L_wfix
L_wok:
  v_pk_fma_f16 v114, v162, s53, v114
  v_pk_fma_f16 v115, v163, s53, v115
  v_mfma_f32_16x16x32_f16 v[96:99], a[236:239], v[232:235], v[96:99]
  buffer_load_dwordx4 a[40:43], v14, s[28:31], s51 offen offset:0 sc1
  v_mfma_f32_16x16x32_f16 v[92:95], a[216:219], v[228:231], v[92:95]
  s_add_u32 s99, s51, 15360
  s_min_u32 s65, s2, 1
  ds_read_b128 v[120:123], v11 offset:30400
  v_mfma_f32_16x16x32_f16 v[92:95], a[220:223], v[232:235], v[92:95]
  ds_read_b128 v[160:163], v12 offset:30400
  v_lshl_or_b32 v22, s65, 31, v166
  v_mfma_f32_16x16x32_f16 v[92:95], a[224:227], v[236:239], v[92:95]
  s_waitcnt lgkmcnt(2)
  v_pk_fma_f16 v116, v156, s53, v116
  v_pk_fma_f16 v117, v157, s53, v117
  v_mfma_f32_16x16x32_f16 v[100:103], a[228:231], v[228:231], v[100:103]
  s_mov_b32 s65, 16531456
  v_pk_fma_f16 v118, v158, s53, v118
  v_pk_fma_f16 v119, v159, s53, v119
  v_mfma_f32_16x16x32_f16 v[100:103], a[232:235], v[232:235], v[100:103]
  buffer_load_dwordx4 a[44:47], v10, s[28:31], s99 offen offset:0 sc1
  v_mfma_f32_16x16x32_f16 v[100:103], a[236:239], v[236:239], v[100:103]
  buffer_store_dword v0, v22, s[28:31], s65 offen sc1
  v_mfma_f32_16x16x32_f16 v[28:31], a[252:255], v[132:135], v[28:31]
  ds_read_b128 v[124:127], v11 offset:30976
  v_mfma_f32_16x16x32_f16 v[28:31], a[0:3], v[136:139], v[28:31]
  s_waitcnt vmcnt(9) lgkmcnt(1)
  ds_read_b128 v[156:159], v12 offset:30976
  v_pk_fma_f16 v120, v160, s53, v120
  v_mfma_f32_16x16x32_f16 v[28:31], a[4:7], v[140:143], v[28:31]
  v_pk_fma_f16 v121, v161, s53, v121
  v_pk_fma_f16 v122, v162, s53, v122
  v_mfma_f32_16x16x32_f16 v[36:39], a[8:11], v[132:135], v[36:39]
  buffer_load_dwordx4 a[48:51], v13, s[28:31], s99 offen offset:0 sc1
  v_mfma_f32_16x16x32_f16 v[36:39], a[12:15], v[136:139], v[36:39]
  s_waitcnt vmcnt(7)
  ds_add_u32 v210, v209 offset:0
  ds_read_b128 v[128:131], v11 offset:31552
  v_mfma_f32_16x16x32_f16 v[36:39], a[16:19], v[140:143], v[36:39]
  v_pk_fma_f16 v123, v163, s53, v123
  v_mfma_f32_16x16x32_f16 v[44:47], a[20:23], v[132:135], v[44:47]
  buffer_load_dwordx4 v[212:215], v165, s[28:31], s67 offen offset:64 sc1
  v_mfma_f32_16x16x32_f16 v[44:47], a[24:27], v[136:139], v[44:47]
  s_waitcnt vmcnt(7) lgkmcnt(2)
  ds_read_b128 v[160:163], v12 offset:31552
  v_pk_fma_f16 v124, v156, s53, v124
  v_mfma_f32_16x16x32_f16 v[44:47], a[28:31], v[140:143], v[44:47]
  buffer_load_dwordx4 a[52:55], v14, s[28:31], s99 offen offset:0 sc1
  v_mfma_f32_16x16x32_f16 v[32:35], a[252:255], v[136:139], v[32:35]
  ds_read_b32 v211, v210 offset:0
  ds_read_b128 v[224:227], v11 offset:32128
  v_mfma_f32_16x16x32_f16 v[32:35], a[0:3], v[140:143], v[32:35]
  v_pk_fma_f16 v125, v157, s53, v125
  v_pk_fma_f16 v126, v158, s53, v126
  v_mfma_f32_16x16x32_f16 v[32:35], a[4:7], v[144:147], v[32:35]
  s_waitcnt lgkmcnt(2)
  v_pk_fma_f16 v127, v159, s53, v127
  v_pk_fma_f16 v128, v160, s53, v128
  v_mfma_f32_16x16x32_f16 v[40:43], a[8:11], v[136:139], v[40:43]
  ds_read_b128 v[156:159], v12 offset:32128
  v_pk_fma_f16 v129, v161, s53, v129
  v_mfma_f32_16x16x32_f16 v[40:43], a[12:15], v[140:143], v[40:43]
  buffer_load_dwordx4 a[56:59], v10, s[28:31], s51 offen offset:3072 sc1
  v_mfma_f32_16x16x32_f16 v[40:43], a[16:19], v[144:147], v[40:43]
  buffer_load_dwordx4 v[216:219], v165, s[28:31], s67 offen offset:80 sc1
  v_mfma_f32_16x16x32_f16 v[64:67], a[20:23], v[136:139], v[64:67]
  s_waitcnt lgkmcnt(2)
  ds_read_b128 v[228:231], v11 offset:32704
  v_cmp_le_u32 vcc, 36, v211
  v_mfma_f32_16x16x32_f16 v[64:67], a[24:27], v[140:143], v[64:67]
  v_pk_fma_f16 v130, v162, s53, v130
  v_pk_fma_f16 v131, v163, s53, v131
  v_mfma_f32_16x16x32_f16 v[64:67], a[28:31], v[144:147], v[64:67]
  s_cbranch_vccz L_sfail46
L_sok47:
  ds_read_b128 v[160:163], v12 offset:32704
  v_mfma_f32_16x16x32_f16 v[48:51], a[252:255], v[140:143], v[48:51]
  buffer_load_dwordx4 a[60:63], v13, s[28:31], s51 offen offset:3072 sc1
  v_mfma_f32_16x16x32_f16 v[48:51], a[0:3], v[144:147], v[48:51]
  s_waitcnt lgkmcnt(2)
  ds_read_b128 v[232:235], v11 offset:33280
  v_pk_fma_f16 v224, v156, s53, v224
  v_mfma_f32_16x16x32_f16 v[48:51], a[4:7], v[148:151], v[48:51]
  v_pk_fma_f16 v225, v157, s53, v225
  v_pk_fma_f16 v226, v158, s53, v226
  v_mfma_f32_16x16x32_f16 v[56:59], a[8:11], v[140:143], v[56:59]
  s_waitcnt lgkmcnt(1)
  v_pk_fma_f16 v227, v159, s53, v227
  v_pk_fma_f16 v228, v160, s53, v228
  v_mfma_f32_16x16x32_f16 v[56:59], a[12:15], v[144:147], v[56:59]
  ds_read_b128 v[156:159], v12 offset:33280
  v_pk_fma_f16 v229, v161, s53, v229
  v_mfma_f32_16x16x32_f16 v[56:59], a[16:19], v[148:151], v[56:59]
  buffer_load_dwordx4 a[64:67], v14, s[28:31], s51 offen offset:3072 sc1
  v_mfma_f32_16x16x32_f16 v[84:87], a[20:23], v[140:143], v[84:87]
  ds_read_b128 v[236:239], v11 offset:33856
  v_pk_fma_f16 v230, v162, s53, v230
  v_mfma_f32_16x16x32_f16 v[84:87], a[24:27], v[144:147], v[84:87]
  s_waitcnt lgkmcnt(1)
  v_pk_fma_f16 v231, v163, s53, v231
  v_pk_fma_f16 v232, v156, s53, v232
  v_mfma_f32_16x16x32_f16 v[84:87], a[28:31], v[148:151], v[84:87]
  ds_read_b128 v[160:163], v12 offset:33856
  v_pk_fma_f16 v233, v157, s53, v233
  v_mfma_f32_16x16x32_f16 v[52:55], a[252:255], v[144:147], v[52:55]
  buffer_load_dwordx4 v[220:223], v19, s[28:31], s67 offen offset:0 sc1
  v_mfma_f32_16x16x32_f16 v[52:55], a[0:3], v[148:151], v[52:55]
  buffer_load_dwordx4 a[68:71], v10, s[28:31], s99 offen offset:3072 sc1
  v_mfma_f32_16x16x32_f16 v[52:55], a[4:7], v[152:155], v[52:55]
  s_lshl_b32 s58, s54, 12
  ds_read_b128 v[132:135], v11 offset:34816
  v_pk_fma_f16 v234, v158, s53, v234
  v_mfma_f32_16x16x32_f16 v[60:63], a[8:11], v[144:147], v[60:63]
  s_waitcnt lgkmcnt(1)
  v_pk_fma_f16 v235, v159, s53, v235
  v_pk_fma_f16 v236, v160, s53, v236
  v_mfma_f32_16x16x32_f16 v[60:63], a[12:15], v[148:151], v[60:63]
  s_add_u32 s58, s58, 15794176
  ds_read_b128 v[156:159], v12 offset:34816
  v_pk_fma_f16 v237, v161, s53, v237
  v_mfma_f32_16x16x32_f16 v[60:63], a[16:19], v[152:155], v[60:63]
  s_lshr_b32 s68, s3, 1
  v_pk_fma_f16 v238, v162, s53, v238
  v_pk_fma_f16 v239, v163, s53, v239
  v_mfma_f32_16x16x32_f16 v[104:107], a[20:23], v[144:147], v[104:107]
  buffer_load_dwordx4 a[72:75], v13, s[28:31], s99 offen offset:3072 sc1
  v_mfma_f32_16x16x32_f16 v[104:107], a[24:27], v[148:151], v[104:107]
  s_lshl2_add_u32 s68, s68, s44
  ds_read_b128 v[136:139], v11 offset:35392
  v_mfma_f32_16x16x32_f16 v[104:107], a[28:31], v[152:155], v[104:107]
  s_waitcnt lgkmcnt(1)
  ds_read_b128 v[160:163], v12 offset:35392
  v_pk_fma_f16 v132, v156, s53, v132
  v_mfma_f32_16x16x32_f16 v[68:71], a[252:255], v[148:151], v[68:71]
  s_lshl4_add_u32 s69, s68, s58
  v_pk_fma_f16 v133, v157, s53, v133
  v_pk_fma_f16 v134, v158, s53, v134
  v_mfma_f32_16x16x32_f16 v[68:71], a[0:3], v[152:155], v[68:71]
  s_add_u32 s95, s69, 32768
  v_pk_fma_f16 v135, v159, s53, v135
  v_mfma_f32_16x16x32_f16 v[68:71], a[4:7], v[240:243], v[68:71]
  buffer_load_dwordx4 a[76:79], v14, s[28:31], s99 offen offset:3072 sc1
  v_mfma_f32_16x16x32_f16 v[76:79], a[8:11], v[148:151], v[76:79]
  s_add_u32 s19, s51, s18
  s_mov_b32 s93, s94
  ds_read_b128 v[140:143], v11 offset:35968
  v_mfma_f32_16x16x32_f16 v[76:79], a[12:15], v[152:155], v[76:79]
  s_waitcnt lgkmcnt(1)
  ds_read_b128 v[156:159], v12 offset:35968
  v_pk_fma_f16 v136, v160, s53, v136
  v_mfma_f32_16x16x32_f16 v[76:79], a[16:19], v[240:243], v[76:79]
  s_mul_i32 s27, s16, 7
  v_pk_fma_f16 v137, v161, s53, v137
  v_pk_fma_f16 v138, v162, s53, v138
  v_mfma_f32_16x16x32_f16 v[72:75], a[252:255], v[152:155], v[72:75]
  s_add_u32 s27, s27, s47
  v_pk_fma_f16 v139, v163, s53, v139
  v_mfma_f32_16x16x32_f16 v[72:75], a[0:3], v[240:243], v[72:75]
  buffer_load_dwordx4 a[80:83], v10, s[28:31], s19 offen offset:0 sc1
  v_mfma_f32_16x16x32_f16 v[72:75], a[4:7], v[244:247], v[72:75]
  s_mul_i32 s65, s17, s44
  ds_read_b128 v[144:147], v11 offset:36544
  v_mfma_f32_16x16x32_f16 v[80:83], a[8:11], v[152:155], v[80:83]
  s_waitcnt lgkmcnt(1)
  ds_read_b128 v[160:163], v12 offset:36544
  v_pk_fma_f16 v140, v156, s53, v140
  v_mfma_f32_16x16x32_f16 v[80:83], a[12:15], v[240:243], v[80:83]
  s_add_u32 s27, s27, s65
  v_pk_fma_f16 v141, v157, s53, v141
  v_pk_fma_f16 v142, v158, s53, v142
  v_mfma_f32_16x16x32_f16 v[80:83], a[16:19], v[244:247], v[80:83]
  s_add_u32 s63, s27, s65
  v_pk_fma_f16 v143, v159, s53, v143
  v_mfma_f32_16x16x32_f16 v[88:91], a[252:255], v[240:243], v[88:91]
  buffer_load_dwordx4 a[84:87], v13, s[28:31], s19 offen offset:0 sc1
  v_mfma_f32_16x16x32_f16 v[88:91], a[0:3], v[244:247], v[88:91]
  s_mul_i32 s65, s54, 657408
  ds_read_b128 v[148:151], v11 offset:37120
  v_mfma_f32_16x16x32_f16 v[88:91], a[4:7], v[248:251], v[88:91]
  s_waitcnt lgkmcnt(1)
  ds_read_b128 v[156:159], v12 offset:37120
  v_pk_fma_f16 v144, v160, s53, v144
  v_mfma_f32_16x16x32_f16 v[96:99], a[8:11], v[240:243], v[96:99]
  s_lshl_b32 s26, s48, 11
  v_pk_fma_f16 v145, v161, s53, v145
  v_pk_fma_f16 v146, v162, s53, v146
  v_mfma_f32_16x16x32_f16 v[96:99], a[12:15], v[244:247], v[96:99]
  s_add_u32 s65, s65, s26
  v_pk_fma_f16 v147, v163, s53, v147
  v_mfma_f32_16x16x32_f16 v[96:99], a[16:19], v[248:251], v[96:99]
  buffer_load_dwordx4 a[88:91], v14, s[28:31], s19 offen offset:0 sc1
  v_mfma_f32_16x16x32_f16 v[92:95], a[252:255], v[244:247], v[92:95]
  s_add_u32 s19, s99, s18
  s_add_u32 s65, s65, 25169920
  ds_read_b128 v[152:155], v11 offset:37696
  v_mfma_f32_16x16x32_f16 v[92:95], a[0:3], v[248:251], v[92:95]
  s_waitcnt lgkmcnt(1)
  ds_read_b128 v[160:163], v12 offset:37696
  v_pk_fma_f16 v148, v156, s53, v148
  v_mfma_f32_16x16x32_f16 v[92:95], a[4:7], v[252:255], v[92:95]
  s_lshl_b32 s26, s27, 9
  v_pk_fma_f16 v149, v157, s53, v149
  v_pk_fma_f16 v150, v158, s53, v150
  v_mfma_f32_16x16x32_f16 v[100:103], a[8:11], v[244:247], v[100:103]
  s_add_u32 s26, s26, s65
  v_pk_fma_f16 v151, v159, s53, v151
  v_mfma_f32_16x16x32_f16 v[100:103], a[12:15], v[248:251], v[100:103]
  buffer_load_dwordx4 a[92:95], v10, s[28:31], s19 offen offset:0 sc1
  v_mfma_f32_16x16x32_f16 v[100:103], a[16:19], v[252:255], v[100:103]
  s_waitcnt vmcnt(17)
  s_mul_i32 s96, s16, 512
  ds_read_b128 v[240:243], v11 offset:38272
  v_mfma_f32_16x16x32_f16 v[28:31], a[32:35], v[108:111], v[28:31]
  s_waitcnt lgkmcnt(1)
  ds_read_b128 v[156:159], v12 offset:38272
  v_pk_fma_f16 v152, v160, s53, v152
  v_mfma_f32_16x16x32_f16 v[28:31], a[36:39], v[112:115], v[28:31]
  s_add_u32 s96, s96, s63
  v_pk_fma_f16 v153, v161, s53, v153
  v_pk_fma_f16 v154, v162, s53, v154
  v_mfma_f32_16x16x32_f16 v[28:31], a[40:43], v[116:119], v[28:31]
  s_waitcnt vmcnt(12)
  s_lshl_b32 s96, s96, 9
  v_pk_fma_f16 v155, v163, s53, v155
  v_mfma_f32_16x16x32_f16 v[28:31], a[44:47], v[132:135], v[28:31]
  buffer_load_dwordx4 a[96:99], v13, s[28:31], s19 offen offset:0 sc1
  v_mfma_f32_16x16x32_f16 v[28:31], a[48:51], v[136:139], v[28:31]
  s_add_u32 s96, s96, 131072
  ds_read_b128 v[244:247], v11 offset:38848
  v_mfma_f32_16x16x32_f16 v[28:31], a[52:55], v[140:143], v[28:31]
  s_waitcnt lgkmcnt(1)
  ds_read_b128 v[160:163], v12 offset:38848
  v_pk_fma_f16 v240, v156, s53, v240
  v_mfma_f32_16x16x32_f16 v[48:51], a[32:35], v[116:119], v[48:51]
  s_add_u32 s96, s96, s65
  v_pk_fma_f16 v241, v157, s53, v241
  v_pk_fma_f16 v242, v158, s53, v242
  v_mfma_f32_16x16x32_f16 v[48:51], a[36:39], v[120:123], v[48:51]
  s_lshr_b32 s11, s63, 1
  v_pk_fma_f16 v243, v159, s53, v243
  v_mfma_f32_16x16x32_f16 v[48:51], a[40:43], v[124:127], v[48:51]
  buffer_load_dwordx4 a[100:103], v14, s[28:31], s19 offen offset:0 sc1
  v_mfma_f32_16x16x32_f16 v[48:51], a[44:47], v[140:143], v[48:51]
  s_add_u32 s51, s61, 13074432
  s_lshl_b32 s65, s54, 5
  v_mfma_f32_16x16x32_f16 v[48:51], a[48:51], v[144:147], v[48:51]
  s_waitcnt lgkmcnt(0)
  v_pk_fma_f16 v244, v160, s53, v244
  v_pk_fma_f16 v245, v161, s53, v245
  v_mfma_f32_16x16x32_f16 v[48:51], a[52:55], v[148:151], v[48:51]
  s_add_u32 s11, s11, s65
  ds_read_b128 v[248:251], v11 offset:39424
  v_pk_fma_f16 v246, v162, s53, v246
  v_mfma_f32_16x16x32_f16 v[68:71], a[32:35], v[124:127], v[68:71]
  s_bfe_u32 s65, s2, 0x20003
  ds_read_b128 v[156:159], v12 offset:39424
  v_pk_fma_f16 v247, v163, s53, v247
  v_mfma_f32_16x16x32_f16 v[68:71], a[36:39], v[128:131], v[68:71]
  buffer_load_dwordx4 a[104:107], v10, s[28:31], s51 offen offset:0 sc1
  v_mfma_f32_16x16x32_f16 v[68:71], a[40:43], v[224:227], v[68:71]
  s_lshl2_add_u32 s11, s11, s65
  ds_write_b128 v167, v[28:31] offset:1536
  v_mfma_f32_16x16x32_f16 v[68:71], a[44:47], v[148:151], v[68:71]
  s_waitcnt lgkmcnt(1)
  v_pk_fma_f16 v248, v156, s53, v248
  v_pk_fma_f16 v249, v157, s53, v249
  v_mfma_f32_16x16x32_f16 v[68:71], a[48:51], v[152:155], v[68:71]
  s_lshl_b32 s11, s11, 7
  v_pk_fma_f16 v250, v158, s53, v250
  v_pk_fma_f16 v251, v159, s53, v251
  v_mfma_f32_16x16x32_f16 v[68:71], a[52:55], v[240:243], v[68:71]
  s_add_u32 s11, s11, 16252928
  ds_read_b128 v[252:255], v11 offset:40000
  v_mfma_f32_16x16x32_f16 v[88:91], a[32:35], v[224:227], v[88:91]
  s_sub_u32 s65, 2130706432, s22
  ds_read_b128 v[160:163], v12 offset:40000
  v_mfma_f32_16x16x32_f16 v[88:91], a[36:39], v[228:231], v[88:91]
  buffer_load_dwordx4 a[108:111], v13, s[28:31], s51 offen offset:0 sc1
  v_mfma_f32_16x16x32_f16 v[88:91], a[40:43], v[232:235], v[88:91]
  ds_write_b128 v167, v[48:51] offset:6656
  v_mov_b32 v208, s65
  v_mfma_f32_16x16x32_f16 v[88:91], a[44:47], v[240:243], v[88:91]
  s_waitcnt lgkmcnt(1)
  v_pk_fma_f16 v252, v160, s53, v252
  v_pk_fma_f16 v253, v161, s53, v253
  v_mfma_f32_16x16x32_f16 v[88:91], a[48:51], v[244:247], v[88:91]
  v_pk_fma_f16 v254, v162, s53, v254
  v_pk_fma_f16 v255, v163, s53, v255
  v_mfma_f32_16x16x32_f16 v[88:91], a[52:55], v[248:251], v[88:91]
  buffer_load_dwordx4 a[112:115], v14, s[28:31], s51 offen offset:0 sc1
  v_mfma_f32_16x16x32_f16 v[32:35], a[32:35], v[112:115], v[32:35]
  v_mfma_f32_16x16x32_f16 v[32:35], a[36:39], v[116:119], v[32:35]
  ds_write_b128 v167, v[68:71] offset:11776
  v_mfma_f32_16x16x32_f16 v[32:35], a[40:43], v[120:123], v[32:35]
  v_mfma_f32_16x16x32_f16 v[32:35], a[44:47], v[136:139], v[32:35]
  v_mfma_f32_16x16x32_f16 v[32:35], a[48:51], v[140:143], v[32:35]
  buffer_load_dwordx4 a[116:119], v10, s[28:31], s51 offen offset:3072 sc1
  v_mfma_f32_16x16x32_f16 v[32:35], a[52:55], v[144:147], v[32:35]
  v_mfma_f32_16x16x32_f16 v[52:55], a[32:35], v[120:123], v[52:55]
  v_mfma_f32_16x16x32_f16 v[52:55], a[36:39], v[124:127], v[52:55]
  ds_write_b128 v167, v[88:91] offset:16896
  v_mfma_f32_16x16x32_f16 v[52:55], a[40:43], v[128:131], v[52:55]
  ds_add_u32 v210, v209 offset:256
  v_mfma_f32_16x16x32_f16 v[52:55], a[44:47], v[144:147], v[52:55]
  buffer_load_dwordx4 a[120:123], v13, s[28:31], s51 offen offset:3072 sc1
  v_mfma_f32_16x16x32_f16 v[52:55], a[48:51], v[148:151], v[52:55]
  v_mfma_f32_16x16x32_f16 v[52:55], a[52:55], v[152:155], v[52:55]
  v_mfma_f32_16x16x32_f16 v[72:75], a[32:35], v[128:131], v[72:75]
  v_mfma_f32_16x16x32_f16 v[72:75], a[36:39], v[224:227], v[72:75]
  ds_write_b128 v167, v[32:35] offset:2560
  v_mfma_f32_16x16x32_f16 v[72:75], a[40:43], v[228:231], v[72:75]
  buffer_load_dwordx4 a[124:127], v14, s[28:31], s51 offen offset:3072 sc1
  v_mfma_f32_16x16x32_f16 v[72:75], a[44:47], v[152:155], v[72:75]
  s_add_u32 s19, s51, s18
  v_mfma_f32_16x16x32_f16 v[72:75], a[48:51], v[240:243], v[72:75]
  v_mfma_f32_16x16x32_f16 v[72:75], a[52:55], v[244:247], v[72:75]
  v_mfma_f32_16x16x32_f16 v[92:95], a[32:35], v[228:231], v[92:95]
  v_mfma_f32_16x16x32_f16 v[92:95], a[36:39], v[232:235], v[92:95]
  buffer_load_dwordx4 a[128:131], v10, s[28:31], s19 offen offset:0 sc1
  v_mfma_f32_16x16x32_f16 v[92:95], a[40:43], v[236:239], v[92:95]
  ds_read_b32 v211, v210 offset:256
  ds_write_b128 v167, v[52:55] offset:7680
  v_mfma_f32_16x16x32_f16 v[92:95], a[44:47], v[244:247], v[92:95]
  ds_read_b128 v[28:31], v3 offset:1536
  v_mfma_f32_16x16x32_f16 v[92:95], a[48:51], v[248:251], v[92:95]
  ds_read_b128 v[48:51], v3 offset:42496
  v_mfma_f32_16x16x32_f16 v[92:95], a[52:55], v[252:255], v[92:95]
  s_waitcnt vmcnt(17)
  ds_read_b128 v[68:71], v27 offset:1536
  v_mfma_f32_16x16x32_f16 v[36:39], a[56:59], v[108:111], v[36:39]
  buffer_load_dwordx4 a[132:135], v13, s[28:31], s19 offen offset:0 sc1
  v_mfma_f32_16x16x32_f16 v[36:39], a[60:63], v[112:115], v[36:39]
  ds_read_b128 v[88:91], v27 offset:42496
  ds_write_b128 v167, v[72:75] offset:12800
  v_mfma_f32_16x16x32_f16 v[36:39], a[64:67], v[116:119], v[36:39]
  s_waitcnt vmcnt(14)
  v_mfma_f32_16x16x32_f16 v[36:39], a[68:71], v[132:135], v[36:39]
  v_mfma_f32_16x16x32_f16 v[36:39], a[72:75], v[136:139], v[36:39]
  s_waitcnt lgkmcnt(6)
  v_cmp_le_u32 vcc, 4, v211
  v_mfma_f32_16x16x32_f16 v[36:39], a[76:79], v[140:143], v[36:39]
  buffer_load_dwordx4 a[136:139], v14, s[28:31], s19 offen offset:0 sc1
  v_mfma_f32_16x16x32_f16 v[56:59], a[56:59], v[116:119], v[56:59]
  s_addk_i32 s51, 15360
  v_mfma_f32_16x16x32_f16 v[56:59], a[60:63], v[120:123], v[56:59]
  s_waitcnt lgkmcnt(1)
  s_cbranch_vccz L_sfail49
L_sok50:
  ds_write_b128 v167, v[92:95] offset:17920
  v_mfma_f32_16x16x32_f16 v[56:59], a[64:67], v[124:127], v[56:59]
  ds_add_u32 v210, v209 offset:512
  v_fma_f32 v26, v212, v208, v28
  v_mfma_f32_16x16x32_f16 v[56:59], a[68:71], v[140:143], v[56:59]
  v_add_f32 v25, v48, v68
  v_add_f32 v26, v26, v25
  v_mfma_f32_16x16x32_f16 v[56:59], a[72:75], v[144:147], v[56:59]
  buffer_load_dwordx4 a[140:143], v10, s[28:31], s51 offen offset:0 sc1
  v_mfma_f32_16x16x32_f16 v[56:59], a[76:79], v[148:151], v[56:59]
  v_readfirstlane_b32 s64, v26
  v_mfma_f32_16x16x32_f16 v[76:79], a[56:59], v[124:127], v[76:79]
  v_mfma_f32_16x16x32_f16 v[76:79], a[60:63], v[128:131], v[76:79]
  ds_write_b128 v167, v[36:39] offset:3584
  v_mfma_f32_16x16x32_f16 v[76:79], a[64:67], v[224:227], v[76:79]
  v_fma_f32 v212, v212, v208, -s64
  v_fma_f32 v213, v213, v208, -s64
  v_mfma_f32_16x16x32_f16 v[76:79], a[68:71], v[148:151], v[76:79]
  buffer_load_dwordx4 a[144:147], v13, s[28:31], s51 offen offset:0 sc1
  v_mfma_f32_16x16x32_f16 v[76:79], a[72:75], v[152:155], v[76:79]
  v_fma_f32 v214, v214, v208, -s64
  v_fma_f32 v215, v215, v208, -s64
  v_mfma_f32_16x16x32_f16 v[76:79], a[76:79], v[240:243], v[76:79]
  v_add_f32 v48, v48, v212
  v_add_f32 v49, v49, v213
  v_mfma_f32_16x16x32_f16 v[96:99], a[56:59], v[224:227], v[96:99]
  v_add_f32 v50, v50, v214
  v_add_f32 v51, v51, v215
  v_mfma_f32_16x16x32_f16 v[96:99], a[60:63], v[228:231], v[96:99]
  ds_write_b128 v167, v[56:59] offset:8704
  v_mfma_f32_16x16x32_f16 v[96:99], a[64:67], v[232:235], v[96:99]
  buffer_load_dwordx4 a[148:151], v14, s[28:31], s51 offen offset:0 sc1
  v_mfma_f32_16x16x32_f16 v[96:99], a[68:71], v[240:243], v[96:99]
  ds_read_b32 v211, v210 offset:512
  v_add_f32 v28, v28, v48
  v_mfma_f32_16x16x32_f16 v[96:99], a[72:75], v[244:247], v[96:99]
  ds_read_b128 v[32:35], v3 offset:2560
  v_sub_f32 v88, v48, v88
  v_mfma_f32_16x16x32_f16 v[96:99], a[76:79], v[248:251], v[96:99]
  ds_read_b128 v[52:55], v3 offset:43520
  v_add_f32 v29, v29, v49
  v_mfma_f32_16x16x32_f16 v[40:43], a[56:59], v[112:115], v[40:43]
  ds_read_b128 v[72:75], v27 offset:2560
  v_sub_f32 v89, v49, v89
  v_mfma_f32_16x16x32_f16 v[40:43], a[60:63], v[116:119], v[40:43]
  ds_read_b128 v[92:95], v27 offset:43520
  ds_write_b128 v167, v[76:79] offset:13824
  v_mfma_f32_16x16x32_f16 v[40:43], a[64:67], v[120:123], v[40:43]
  buffer_load_dwordx4 a[152:155], v10, s[28:31], s51 offen offset:3072 sc1
  v_mfma_f32_16x16x32_f16 v[40:43], a[68:71], v[136:139], v[40:43]
  v_add_f32 v30, v30, v50
  v_sub_f32 v90, v50, v90
  v_mfma_f32_16x16x32_f16 v[40:43], a[72:75], v[140:143], v[40:43]
  s_waitcnt lgkmcnt(5)
  v_cmp_le_u32 vcc, 4, v211
  v_add_f32 v31, v31, v51
  v_mfma_f32_16x16x32_f16 v[40:43], a[76:79], v[144:147], v[40:43]
  v_sub_f32 v91, v51, v91
  v_add_f32 v28, v28, v68
  v_mfma_f32_16x16x32_f16 v[60:63], a[56:59], v[120:123], v[60:63]
  buffer_load_dwordx4 a[156:159], v13, s[28:31], s51 offen offset:3072 sc1
  v_mfma_f32_16x16x32_f16 v[60:63], a[60:63], v[124:127], v[60:63]
  s_waitcnt lgkmcnt(1)
  s_cbranch_vccz L_sfail52
L_sok53:
  ds_write_b128 v167, v[96:99] offset:18944
  v_mfma_f32_16x16x32_f16 v[60:63], a[64:67], v[128:131], v[60:63]
L_pg3:
  s_cbranch_execz L_pgback
  ds_add_u32 v210, v209 offset:768
  v_sub_f32 v88, v88, v68
  v_mfma_f32_16x16x32_f16 v[60:63], a[68:71], v[144:147], v[60:63]
  v_add_f32 v29, v29, v69
  v_sub_f32 v89, v89, v69
  v_mfma_f32_16x16x32_f16 v[60:63], a[72:75], v[148:151], v[60:63]
  v_add_f32 v30, v30, v70
  v_sub_f32 v90, v90, v70
  v_mfma_f32_16x16x32_f16 v[60:63], a[76:79], v[152:155], v[60:63]
  buffer_load_dwordx4 a[160:163], v14, s[28:31], s51 offen offset:3072 sc1
  v_mfma_f32_16x16x32_f16 v[80:83], a[56:59], v[128:131], v[80:83]
  s_add_u32 s19, s51, s18
  v_add_f32 v31, v31, v71
  v_sub_f32 v91, v91, v71
  v_mfma_f32_16x16x32_f16 v[80:83], a[60:63], v[224:227], v[80:83]
  ds_write_b128 v167, v[40:43] offset:4608
  v_mfma_f32_16x16x32_f16 v[80:83], a[64:67], v[228:231], v[80:83]
  v_add_f32 v52, v52, v212
  v_add_f32 v53, v53, v213
  v_mfma_f32_16x16x32_f16 v[80:83], a[68:71], v[152:155], v[80:83]
  v_add_f32 v54, v54, v214
  v_add_f32 v55, v55, v215
  v_mfma_f32_16x16x32_f16 v[80:83], a[72:75], v[240:243], v[80:83]
  buffer_load_dwordx4 a[164:167], v10, s[28:31], s19 offen offset:0 sc1
  v_mfma_f32_16x16x32_f16 v[80:83], a[76:79], v[244:247], v[80:83]
  v_add_f32 v32, v32, v52
  v_sub_f32 v92, v52, v92
  v_mfma_f32_16x16x32_f16 v[100:103], a[56:59], v[228:231], v[100:103]
  v_add_f32 v33, v33, v53
  v_sub_f32 v93, v53, v93
  v_mfma_f32_16x16x32_f16 v[100:103], a[60:63], v[232:235], v[100:103]
  ds_write_b128 v167, v[60:63] offset:9728
  v_mfma_f32_16x16x32_f16 v[100:103], a[64:67], v[236:239], v[100:103]
  ds_read_b32 v211, v210 offset:768
  v_add_f32 v34, v34, v54
  v_mfma_f32_16x16x32_f16 v[100:103], a[68:71], v[244:247], v[100:103]
  buffer_load_dwordx4 a[168:171], v13, s[28:31], s19 offen offset:0 sc1
  v_mfma_f32_16x16x32_f16 v[100:103], a[72:75], v[248:251], v[100:103]
  ds_read_b128 v[36:39], v3 offset:3584
  v_sub_f32 v94, v54, v94
  v_mfma_f32_16x16x32_f16 v[100:103], a[76:79], v[252:255], v[100:103]
  s_waitcnt vmcnt(20)
  ds_read_b128 v[56:59], v3 offset:44544
  v_add_f32 v35, v35, v55
  v_mfma_f32_16x16x32_f16 v[44:47], a[80:83], v[108:111], v[44:47]
  ds_read_b128 v[76:79], v27 offset:3584
  v_sub_f32 v95, v55, v95
  v_mfma_f32_16x16x32_f16 v[44:47], a[84:87], v[112:115], v[44:47]
  ds_read_b128 v[96:99], v27 offset:44544
  ds_write_b128 v167, v[80:83] offset:14848
  v_mfma_f32_16x16x32_f16 v[44:47], a[88:91], v[116:119], v[44:47]
  s_waitcnt vmcnt(17)
  buffer_load_dwordx4 a[172:175], v14, s[28:31], s19 offen offset:0 sc1
  v_mfma_f32_16x16x32_f16 v[44:47], a[92:95], v[132:135], v[44:47]
  s_addk_i32 s51, 15360
  v_add_f32 v32, v32, v72
  v_sub_f32 v92, v92, v72
  v_mfma_f32_16x16x32_f16 v[44:47], a[96:99], v[136:139], v[44:47]
  s_waitcnt lgkmcnt(5)
  v_cmp_le_u32 vcc, 4, v211
  v_add_f32 v33, v33, v73
  v_mfma_f32_16x16x32_f16 v[44:47], a[100:103], v[140:143], v[44:47]
  v_sub_f32 v93, v93, v73
  v_add_f32 v34, v34, v74
  v_mfma_f32_16x16x32_f16 v[64:67], a[80:83], v[112:115], v[64:67]
  v_sub_f32 v94, v94, v74
  v_add_f32 v35, v35, v75
  v_mfma_f32_16x16x32_f16 v[64:67], a[84:87], v[116:119], v[64:67]
  buffer_load_dwordx4 a[176:179], v10, s[28:31], s51 offen offset:0 sc1
  v_mfma_f32_16x16x32_f16 v[64:67], a[88:91], v[120:123], v[64:67]
  s_waitcnt lgkmcnt(1)
  s_cbranch_vccz L_sfail55
L_sok56:
  ds_write_b128 v167, v[100:103] offset:19968
  v_mfma_f32_16x16x32_f16 v[64:67], a[92:95], v[136:139], v[64:67]
  ds_add_u32 v210, v209 offset:1024
  v_sub_f32 v95, v95, v75
  v_mfma_f32_16x16x32_f16 v[64:67], a[96:99], v[140:143], v[64:67]
  v_mfma_f32_16x16x32_f16 v[64:67], a[100:103], v[144:147], v[64:67]
  v_fma_f32 v216, v216, v208, -s64
  v_fma_f32 v217, v217, v208, -s64
  v_mfma_f32_16x16x32_f16 v[84:87], a[80:83], v[116:119], v[84:87]
  buffer_load_dwordx4 a[180:183], v13, s[28:31], s51 offen offset:0 sc1
  v_mfma_f32_16x16x32_f16 v[84:87], a[84:87], v[120:123], v[84:87]
  ds_write_b128 v167, v[44:47] offset:5632
  v_mfma_f32_16x16x32_f16 v[84:87], a[88:91], v[124:127], v[84:87]
  v_fma_f32 v218, v218, v208, -s64
  v_fma_f32 v219, v219, v208, -s64
  v_mfma_f32_16x16x32_f16 v[84:87], a[92:95], v[140:143], v[84:87]
  v_add_f32 v56, v56, v216
  v_add_f32 v57, v57, v217
  v_mfma_f32_16x16x32_f16 v[84:87], a[96:99], v[144:147], v[84:87]
  v_add_f32 v58, v58, v218
  v_add_f32 v59, v59, v219
  v_mfma_f32_16x16x32_f16 v[84:87], a[100:103], v[148:151], v[84:87]
  buffer_load_dwordx4 a[184:187], v14, s[28:31], s51 offen offset:0 sc1
  v_mfma_f32_16x16x32_f16 v[104:107], a[80:83], v[120:123], v[104:107]
  v_add_f32 v36, v36, v56
  v_sub_f32 v96, v56, v96
  v_mfma_f32_16x16x32_f16 v[104:107], a[84:87], v[124:127], v[104:107]
  ds_write_b128 v167, v[64:67] offset:10752
  v_mfma_f32_16x16x32_f16 v[104:107], a[88:91], v[128:131], v[104:107]
  v_add_f32 v37, v37, v57
  v_sub_f32 v97, v57, v97
  v_mfma_f32_16x16x32_f16 v[104:107], a[92:95], v[144:147], v[104:107]
  v_add_f32 v38, v38, v58
  v_sub_f32 v98, v58, v98
  v_mfma_f32_16x16x32_f16 v[104:107], a[96:99], v[148:151], v[104:107]
  buffer_load_dwordx4 a[188:191], v10, s[28:31], s51 offen offset:3072 sc1
  v_mfma_f32_16x16x32_f16 v[104:107], a[100:103], v[152:155], v[104:107]
  v_add_f32 v39, v39, v59
  v_sub_f32 v99, v59, v99
  buffer_load_dwordx4 a[192:195], v13, s[28:31], s51 offen offset:3072 sc1
  s_nop 1
  ds_write_b128 v167, v[84:87] offset:15872
  ds_read_b32 v211, v210 offset:1024
  ds_read_b128 v[40:43], v3 offset:4608
  ds_read_b128 v[60:63], v3 offset:45568
  ds_read_b128 v[80:83], v27 offset:4608
  ds_read_b128 v[100:103], v27 offset:45568
  ds_write_b128 v167, v[104:107] offset:20992
  ds_add_u32 v210, v209 offset:1280
  v_add_f32 v36, v36, v76
  v_sub_f32 v96, v96, v76
  v_add_f32 v37, v37, v77
  v_sub_f32 v97, v97, v77
  v_add_f32 v38, v38, v78
  v_sub_f32 v98, v98, v78
  v_add_f32 v39, v39, v79
  v_sub_f32 v99, v99, v79
  v_mov_b32 v129, s49
  v_mov_b32 v131, s94
  v_pk_add_f32 v[20:21], v[28:29], 0 op_sel_hi:[1,0]
  v_pk_mul_f32 v[22:23], v[28:29], v[28:29]
  v_pk_add_f32 v[20:21], v[20:21], v[30:31]
  v_pk_fma_f32 v[22:23], v[30:31], v[30:31], v[22:23]
  v_pk_add_f32 v[20:21], v[20:21], v[88:89]
  v_pk_fma_f32 v[22:23], v[88:89], v[88:89], v[22:23]
  v_pk_add_f32 v[20:21], v[20:21], v[90:91]
  v_pk_fma_f32 v[22:23], v[90:91], v[90:91], v[22:23]
  buffer_load_dwordx4 a[196:199], v14, s[28:31], s51 offen offset:3072 sc1
  s_waitcnt lgkmcnt(6)
  v_cmp_le_u32 vcc, 4, v211
  v_pk_add_f32 v[20:21], v[20:21], v[32:33]
  v_pk_fma_f32 v[22:23], v[32:33], v[32:33], v[22:23]
  v_pk_add_f32 v[20:21], v[20:21], v[34:35]
  v_pk_fma_f32 v[22:23], v[34:35], v[34:35], v[22:23]
  v_pk_add_f32 v[20:21], v[20:21], v[92:93]
  v_pk_fma_f32 v[22:23], v[92:93], v[92:93], v[22:23]
  v_pk_add_f32 v[20:21], v[20:21], v[94:95]
  v_pk_fma_f32 v[22:23], v[94:95], v[94:95], v[22:23]
  s_add_u32 s19, s51, s18
  buffer_load_dwordx4 a[200:203], v10, s[28:31], s19 offen offset:0 sc1
  s_cbranch_vccz L_sfail58
L_sok59:
  v_pk_add_f32 v[20:21], v[20:21], v[36:37]
  v_pk_fma_f32 v[22:23], v[36:37], v[36:37], v[22:23]
  v_pk_add_f32 v[20:21], v[20:21], v[38:39]
  v_pk_fma_f32 v[22:23], v[38:39], v[38:39], v[22:23]
  v_pk_add_f32 v[20:21], v[20:21], v[96:97]
  v_pk_fma_f32 v[22:23], v[96:97], v[96:97], v[22:23]
  v_pk_add_f32 v[20:21], v[20:21], v[98:99]
  v_pk_fma_f32 v[22:23], v[98:99], v[98:99], v[22:23]
  buffer_load_dwordx4 a[204:207], v13, s[28:31], s19 offen offset:0 sc1
  ds_read_b32 v211, v210 offset:1280
  ds_read_b128 v[44:47], v3 offset:5632
  ds_read_b128 v[64:67], v3 offset:46592
  ds_read_b128 v[84:87], v27 offset:5632
  ds_read_b128 v[104:107], v27 offset:46592
  s_waitcnt lgkmcnt(7)
  v_pk_add_f32 v[60:61], v[60:61], v[216:217]
  v_pk_add_f32 v[62:63], v[62:63], v[218:219]
  v_pk_add_f32 v[40:41], v[40:41], v[60:61]
  v_pk_add_f32 v[100:101], v[60:61], v[100:101] neg_lo:[0,1] neg_hi:[0,1]
  v_pk_add_f32 v[40:41], v[40:41], v[80:81]
  v_pk_add_f32 v[100:101], v[100:101], v[80:81] neg_lo:[0,1] neg_hi:[0,1]
  v_pk_add_f32 v[42:43], v[42:43], v[62:63]
  v_pk_add_f32 v[102:103], v[62:63], v[102:103] neg_lo:[0,1] neg_hi:[0,1]
  v_pk_add_f32 v[42:43], v[42:43], v[82:83]
  v_pk_add_f32 v[102:103], v[102:103], v[82:83] neg_lo:[0,1] neg_hi:[0,1]
  v_pk_add_f32 v[20:21], v[20:21], v[40:41]
  v_pk_fma_f32 v[22:23], v[40:41], v[40:41], v[22:23]
  v_pk_add_f32 v[20:21], v[20:21], v[42:43]
  v_pk_fma_f32 v[22:23], v[42:43], v[42:43], v[22:23]
  v_pk_add_f32 v[20:21], v[20:21], v[100:101]
  v_pk_fma_f32 v[22:23], v[100:101], v[100:101], v[22:23]
  v_pk_add_f32 v[20:21], v[20:21], v[102:103]
  v_pk_fma_f32 v[22:23], v[102:103], v[102:103], v[22:23]
  buffer_load_dwordx4 a[208:211], v14, s[28:31], s19 offen offset:0 sc1
  s_waitcnt lgkmcnt(4)
  v_cmp_le_u32 vcc, 4, v211
  s_cbranch_vccz L_sfail61
L_sok62:
  s_waitcnt lgkmcnt(0)
  v_pk_fma_f32 v[220:221], v[220:221], v[208:209], s[64:65] op_sel_hi:[1,0,0] neg_lo:[0,0,1] neg_hi:[0,0,1]
  v_pk_fma_f32 v[222:223], v[222:223], v[208:209], s[64:65] op_sel_hi:[1,0,0] neg_lo:[0,0,1] neg_hi:[0,0,1]
  v_pk_add_f32 v[64:65], v[64:65], v[220:221]
  v_pk_add_f32 v[66:67], v[66:67], v[222:223]
  v_pk_add_f32 v[44:45], v[44:45], v[64:65]
  v_pk_add_f32 v[104:105], v[64:65], v[104:105] neg_lo:[0,1] neg_hi:[0,1]
  v_pk_add_f32 v[44:45], v[44:45], v[84:85]
  v_pk_add_f32 v[104:105], v[104:105], v[84:85] neg_lo:[0,1] neg_hi:[0,1]
  v_pk_add_f32 v[46:47], v[46:47], v[66:67]
  v_pk_add_f32 v[106:107], v[66:67], v[106:107] neg_lo:[0,1] neg_hi:[0,1]
  v_pk_add_f32 v[46:47], v[46:47], v[86:87]
  v_pk_add_f32 v[106:107], v[106:107], v[86:87] neg_lo:[0,1] neg_hi:[0,1]
  v_pk_add_f32 v[20:21], v[20:21], v[44:45]
  v_pk_fma_f32 v[22:23], v[44:45], v[44:45], v[22:23]
  v_pk_add_f32 v[20:21], v[20:21], v[46:47]
  v_pk_fma_f32 v[22:23], v[46:47], v[46:47], v[22:23]
  v_pk_add_f32 v[20:21], v[20:21], v[104:105]
  v_pk_fma_f32 v[22:23], v[104:105], v[104:105], v[22:23]
  v_pk_add_f32 v[20:21], v[20:21], v[106:107]
  v_pk_fma_f32 v[22:23], v[106:107], v[106:107], v[22:23]
  s_addk_i32 s51, 15360
  buffer_load_dwordx4 a[212:215], v10, s[28:31], s51 offen offset:0 sc1
  v_add_f32 v20, v20, v21
  v_add_f32 v22, v22, v23
  s_nop 1
  v_add_f32_dpp v20, v20, v20 quad_perm:[1,0,3,2] row_mask:0xf bank_mask:0xf
  v_add_f32_dpp v22, v22, v22 quad_perm:[1,0,3,2] row_mask:0xf bank_mask:0xf
  s_nop 0
  v_add_f32_dpp v20, v20, v20 quad_perm:[2,3,0,1] row_mask:0xf bank_mask:0xf
  v_add_f32_dpp v22, v22, v22 quad_perm:[2,3,0,1] row_mask:0xf bank_mask:0xf
  s_nop 0
  v_add_f32_dpp v20, v20, v20 row_half_mirror row_mask:0xf bank_mask:0xf
  v_add_f32_dpp v22, v22, v22 row_half_mirror row_mask:0xf bank_mask:0xf
  s_nop 0
  v_add_f32_dpp v20, v20, v20 row_mirror row_mask:0xf bank_mask:0xf
  v_add_f32_dpp v22, v22, v22 row_mirror row_mask:0xf bank_mask:0xf
  s_nop 0
  v_add_f32_dpp v20, v20, v20 row_bcast:15 row_mask:0xa bank_mask:0xf
  v_add_f32_dpp v22, v22, v22 row_bcast:15 row_mask:0xa bank_mask:0xf
  s_nop 0
  v_add_f32_dpp v20, v20, v20 row_bcast:31 row_mask:0xc bank_mask:0xf
  v_add_f32_dpp v22, v22, v22 row_bcast:31 row_mask:0xc bank_mask:0xf
  s_nop 0
  v_mul_f32 v20, 0x39cccccd, v20
  v_mul_f32 v22, 0x39cccccd, v22
  v_add_f32 v128, s64, v20
  v_fma_f32 v130, -v20, v20, v22
  v_mul_f32 v130, s22, v130
  v_mul_f32 v128, s22, v128
  v_mul_f32 v130, s22, v130
  s_mov_b32 exec_lo, 0
  s_brev_b32 exec_hi, 1
  buffer_store_dwordx4 v[128:131], off, s[28:31], s69
  s_mov_b64 exec, -1
  v_mul_f32 v24, s22, v20
  v_readlane_b32 s67, v128, 63
  v_pk_mul_f32 v[28:29], v[28:29], v[168:169]
  v_pk_mul_f32 v[30:31], v[30:31], v[170:171]
  v_pk_mul_f32 v[88:89], v[88:89], v[168:169]
  v_pk_mul_f32 v[90:91], v[90:91], v[170:171]
  v_pk_mul_f32 v[32:33], v[32:33], v[168:169]
  v_pk_mul_f32 v[34:35], v[34:35], v[170:171]
  v_pk_mul_f32 v[92:93], v[92:93], v[168:169]
  v_pk_mul_f32 v[94:95], v[94:95], v[170:171]
  v_pk_mul_f32 v[36:37], v[36:37], v[172:173]
  v_pk_mul_f32 v[38:39], v[38:39], v[174:175]
  v_pk_mul_f32 v[96:97], v[96:97], v[172:173]
  v_pk_mul_f32 v[98:99], v[98:99], v[174:175]
  v_pk_mul_f32 v[40:41], v[40:41], v[172:173]
  v_pk_mul_f32 v[42:43], v[42:43], v[174:175]
  v_pk_mul_f32 v[100:101], v[100:101], v[172:173]
  v_pk_mul_f32 v[102:103], v[102:103], v[174:175]
  v_pk_mul_f32 v[44:45], v[44:45], v[176:177]
  v_pk_mul_f32 v[46:47], v[46:47], v[178:179]
  v_pk_mul_f32 v[104:105], v[104:105], v[176:177]
  v_pk_mul_f32 v[106:107], v[106:107], v[178:179]
  s_lshr_b32 s65, s47, 1
  v_min_u32 v25, 23, v1
  v_lshrrev_b32 v26, 2, v25
  v_add3_u32 v26, v26, s65, -1
  v_med3_i32 v26, v26, 0, 31
  v_and_b32 v25, 3, v25
  v_lshl_add_u32 v26, v26, 2, v25
  s_lshl2_add_u32 s65, s45, s44
  s_lshl_b32 s65, s65, 14
  v_lshl_add_u32 v18, v26, 7, s65
  buffer_load_dwordx4 v[156:159], v2, s[28:31], s58 offen sc1
  buffer_load_dwordx4 v[160:163], v2, s[28:31], s58 offen offset:1024 sc1
  s_waitcnt vmcnt(0)
  v_bitop3_b32 v20, v157, v161, s49 bitop3:0x7e
  v_bitop3_b32 v21, v159, v163, s93 bitop3:0x7e
  v_or_b32 v20, v20, v21
  v_cmp_ne_u32 vcc, 0, v20
  s_cbranch_vccz L_pdone65
  s_mov_b64 exec, vcc
  s_mov_b32 s55, 65536
L_poll64:
  s_mov_b32 s93, s94
  s_bitset0_b32 s58, 15
  s_and_b32 s66, s55, 15
  s_cmp_lg_u32 s66, 1
  s_cbranch_scc1 L_gl68
  s_mov_b32 s93, s49
  s_bitset1_b32 s58, 15
  s_mov_b64 vcc, exec
  s_mov_b32 exec_lo, 0
  s_brev_b32 exec_hi, 1
  v_mov_b32 v131, s49
  buffer_store_dwordx4 v[128:131], off, s[28:31], s95 sc1
  s_mov_b64 exec, -1
  s_mov_b64 exec, vcc
L_gl68:
  buffer_load_dwordx4 v[156:159], v2, s[28:31], s58 offen sc1
  buffer_load_dwordx4 v[160:163], v2, s[28:31], s58 offen offset:1024 sc1
  s_waitcnt vmcnt(0)
  v_bitop3_b32 v20, v157, v161, s49 bitop3:0x7e
  v_bitop3_b32 v21, v159, v163, s93 bitop3:0x7e
  v_or_b32 v20, v20, v21
  v_cmp_ne_u32 vcc, 0, v20
  s_cbranch_vccz L_prest66
  s_mov_b64 exec, vcc
  s_sub_u32 s55, s55, 1
  s_cbranch_scc0 L_poll64
L_prest66:
  s_mov_b64 exec, -1
L_pdone65:
  v_subrev_f32 v156, s67, v156
  v_subrev_f32 v160, s67, v160
  v_add_f32 v22, v158, v162
  v_add_f32 v20, v156, v160
  v_fmac_f32 v22, v156, v156
  v_fmac_f32 v22, v160, v160
  v_mov_b32 v156, 0x3727c5ac
  s_nop 1
  v_add_f32_dpp v20, v20, v20 quad_perm:[1,0,3,2] row_mask:0xf bank_mask:0xf
  v_add_f32_dpp v22, v22, v22 quad_perm:[1,0,3,2] row_mask:0xf bank_mask:0xf
  s_nop 0
  v_add_f32_dpp v20, v20, v20 quad_perm:[2,3,0,1] row_mask:0xf bank_mask:0xf
  v_add_f32_dpp v22, v22, v22 quad_perm:[2,3,0,1] row_mask:0xf bank_mask:0xf
  s_nop 0
  v_add_f32_dpp v20, v20, v20 row_half_mirror row_mask:0xf bank_mask:0xf
  v_add_f32_dpp v22, v22, v22 row_half_mirror row_mask:0xf bank_mask:0xf
  s_nop 0
  v_add_f32_dpp v20, v20, v20 row_mirror row_mask:0xf bank_mask:0xf
  v_add_f32_dpp v22, v22, v22 row_mirror row_mask:0xf bank_mask:0xf
  s_nop 0
  v_add_f32_dpp v20, v20, v20 row_bcast:15 row_mask:0xa bank_mask:0xf
  v_add_f32_dpp v22, v22, v22 row_bcast:15 row_mask:0xa bank_mask:0xf
  s_nop 0
  v_add_f32_dpp v20, v20, v20 row_bcast:31 row_mask:0xc bank_mask:0xf
  v_add_f32_dpp v22, v22, v22 row_bcast:31 row_mask:0xc bank_mask:0xf
  s_nop 0
  v_mul_f32 v20, 0x3c000000, v20
  v_fmamk_f32 v22, v22, 0x3c000000, v156
  v_fma_f32 v22, -v20, v20, v22
  v_max_f32 v22, v22, v156
  v_rsq_f32 v22, v22
  v_add_f32 v20, v20, v24
  v_mul_f32 v22, 0xbfb8aa3b, v22
  v_mul_f32 v20, v20, v22
  v_mul_f32 v22, s22, v22
  v_readlane_b32 s72, v20, 63
  v_readlane_b32 s70, v22, 63
  s_mov_b32 s98, 16252928
  s_mov_b32 s97, 16384000
  s_mov_b32 s66, s96
  v_pk_fma_f32 v[188:189], v[176:177], s[72:73], v[188:189] op_sel_hi:[1,0,1] neg_lo:[1,0,0] neg_hi:[1,0,0]
  v_pk_fma_f32 v[190:191], v[178:179], s[72:73], v[190:191] op_sel_hi:[1,0,1] neg_lo:[1,0,0] neg_hi:[1,0,0]
  v_pk_fma_f32 v[44:45], v[44:45], s[70:71], v[188:189] op_sel_hi:[1,0,1]
  v_pk_fma_f32 v[46:47], v[46:47], s[70:71], v[190:191] op_sel_hi:[1,0,1]
  v_pk_fma_f32 v[104:105], v[104:105], s[70:71], v[188:189] op_sel_hi:[1,0,1]
  v_pk_fma_f32 v[106:107], v[106:107], s[70:71], v[190:191] op_sel_hi:[1,0,1]
  v_exp_f32 v132, v44
  v_exp_f32 v133, v45
  v_exp_f32 v134, v46
  v_exp_f32 v135, v47
  v_exp_f32 v136, v104
  v_exp_f32 v137, v105
  v_exp_f32 v138, v106
  v_exp_f32 v139, v107
  v_pk_fma_f32 v[132:133], v[132:133], s[62:63], s[62:63] op_sel_hi:[1,0,0]
  v_pk_fma_f32 v[134:135], v[134:135], s[62:63], s[62:63] op_sel_hi:[1,0,0]
  v_pk_fma_f32 v[136:137], v[136:137], s[62:63], s[62:63] op_sel_hi:[1,0,0]
  v_pk_fma_f32 v[138:139], v[138:139], s[62:63], s[62:63] op_sel_hi:[1,0,0]
  v_rcp_f32 v132, v132
  v_rcp_f32 v133, v133
  v_rcp_f32 v134, v134
  v_rcp_f32 v135, v135
  v_rcp_f32 v136, v136
  v_rcp_f32 v137, v137
  v_rcp_f32 v138, v138
  v_rcp_f32 v139, v139
  v_pk_mul_f32 v[44:45], v[44:45], v[132:133]
  v_pk_mul_f32 v[46:47], v[46:47], v[134:135]
  v_pk_mul_f32 v[104:105], v[104:105], v[136:137]
  v_pk_mul_f32 v[106:107], v[106:107], v[138:139]
  v_cvt_pk_f16_f32 v108, v44, v45
  v_cvt_pk_f16_f32 v109, v46, v47
  v_cvt_pk_f16_f32 v110, v104, v105
  v_cvt_pk_f16_f32 v111, v106, v107
  s_nop 1
  v_permlane16_swap_b32 v108, v110
  v_permlane16_swap_b32 v109, v111
  buffer_store_dwordx4 v[108:111], v16, s[28:31], s26 offen sc1
  v_pk_fma_f32 v[180:181], v[168:169], s[72:73], v[180:181] op_sel_hi:[1,0,1] neg_lo:[1,0,0] neg_hi:[1,0,0]
  v_pk_fma_f32 v[182:183], v[170:171], s[72:73], v[182:183] op_sel_hi:[1,0,1] neg_lo:[1,0,0] neg_hi:[1,0,0]
  v_pk_fma_f32 v[184:185], v[172:173], s[72:73], v[184:185] op_sel_hi:[1,0,1] neg_lo:[1,0,0] neg_hi:[1,0,0]
  v_pk_fma_f32 v[186:187], v[174:175], s[72:73], v[186:187] op_sel_hi:[1,0,1] neg_lo:[1,0,0] neg_hi:[1,0,0]
  v_pk_fma_f32 v[28:29], v[28:29], s[70:71], v[180:181] op_sel_hi:[1,0,1]
  v_pk_fma_f32 v[30:31], v[30:31], s[70:71], v[182:183] op_sel_hi:[1,0,1]
  v_pk_fma_f32 v[36:37], v[36:37], s[70:71], v[184:185] op_sel_hi:[1,0,1]
  v_pk_fma_f32 v[38:39], v[38:39], s[70:71], v[186:187] op_sel_hi:[1,0,1]
  v_exp_f32 v132, v28
  v_exp_f32 v133, v29
  v_exp_f32 v134, v30
  v_exp_f32 v135, v31
  v_exp_f32 v136, v36
  v_exp_f32 v137, v37
  v_exp_f32 v138, v38
  v_exp_f32 v139, v39
  v_pk_fma_f32 v[132:133], v[132:133], s[62:63], s[62:63] op_sel_hi:[1,0,0]
  v_pk_fma_f32 v[134:135], v[134:135], s[62:63], s[62:63] op_sel_hi:[1,0,0]
  v_pk_fma_f32 v[136:137], v[136:137], s[62:63], s[62:63] op_sel_hi:[1,0,0]
  v_pk_fma_f32 v[138:139], v[138:139], s[62:63], s[62:63] op_sel_hi:[1,0,0]
  v_rcp_f32 v132, v132
  v_rcp_f32 v133, v133
  v_rcp_f32 v134, v134
  v_rcp_f32 v135, v135
  v_rcp_f32 v136, v136
  v_rcp_f32 v137, v137
  v_rcp_f32 v138, v138
  v_rcp_f32 v139, v139
  v_pk_mul_f32 v[28:29], v[28:29], v[132:133]
  v_pk_mul_f32 v[30:31], v[30:31], v[134:135]
  v_pk_mul_f32 v[36:37], v[36:37], v[136:137]
  v_pk_mul_f32 v[38:39], v[38:39], v[138:139]
  v_cvt_pk_f16_f32 v112, v28, v29
  v_cvt_pk_f16_f32 v113, v30, v31
  v_cvt_pk_f16_f32 v114, v36, v37
  v_cvt_pk_f16_f32 v115, v38, v39
  buffer_store_dwordx4 v[112:115], v15, s[28:31], s66 offen offset:0 sc1
  v_pk_fma_f32 v[88:89], v[88:89], s[70:71], v[180:181] op_sel_hi:[1,0,1]
  v_pk_fma_f32 v[90:91], v[90:91], s[70:71], v[182:183] op_sel_hi:[1,0,1]
  v_pk_fma_f32 v[96:97], v[96:97], s[70:71], v[184:185] op_sel_hi:[1,0,1]
  v_pk_fma_f32 v[98:99], v[98:99], s[70:71], v[186:187] op_sel_hi:[1,0,1]
  v_exp_f32 v132, v88
  v_exp_f32 v133, v89
  v_exp_f32 v134, v90
  v_exp_f32 v135, v91
  v_exp_f32 v136, v96
  v_exp_f32 v137, v97
  v_exp_f32 v138, v98
  v_exp_f32 v139, v99
  v_pk_fma_f32 v[132:133], v[132:133], s[62:63], s[62:63] op_sel_hi:[1,0,0]
  v_pk_fma_f32 v[134:135], v[134:135], s[62:63], s[62:63] op_sel_hi:[1,0,0]
  v_pk_fma_f32 v[136:137], v[136:137], s[62:63], s[62:63] op_sel_hi:[1,0,0]
  v_pk_fma_f32 v[138:139], v[138:139], s[62:63], s[62:63] op_sel_hi:[1,0,0]
  v_rcp_f32 v132, v132
  v_rcp_f32 v133, v133
  v_rcp_f32 v134, v134
  v_rcp_f32 v135, v135
  v_rcp_f32 v136, v136
  v_rcp_f32 v137, v137
  v_rcp_f32 v138, v138
  v_rcp_f32 v139, v139
  v_pk_mul_f32 v[88:89], v[88:89], v[132:133]
  v_pk_mul_f32 v[90:91], v[90:91], v[134:135]
  v_pk_mul_f32 v[96:97], v[96:97], v[136:137]
  v_pk_mul_f32 v[98:99], v[98:99], v[138:139]
  v_cvt_pk_f16_f32 v116, v88, v89
  v_cvt_pk_f16_f32 v117, v90, v91
  v_cvt_pk_f16_f32 v118, v96, v97
  v_cvt_pk_f16_f32 v119, v98, v99
  buffer_store_dwordx4 v[116:119], v15, s[28:31], s66 offen offset:256 sc1
  s_lshl_b32 s65, s17, 9
  s_add_u32 s66, s66, s65
  s_waitcnt vmcnt(2)
  s_mov_b64 exec, 1
  buffer_store_dword v0, off, s[28:31], s11 sc1
  s_mov_b64 exec, -1
  v_pk_fma_f32 v[32:33], v[32:33], s[70:71], v[180:181] op_sel_hi:[1,0,1]
  v_pk_fma_f32 v[34:35], v[34:35], s[70:71], v[182:183] op_sel_hi:[1,0,1]
  v_pk_fma_f32 v[40:41], v[40:41], s[70:71], v[184:185] op_sel_hi:[1,0,1]
  v_pk_fma_f32 v[42:43], v[42:43], s[70:71], v[186:187] op_sel_hi:[1,0,1]
  v_exp_f32 v132, v32
  v_exp_f32 v133, v33
  v_exp_f32 v134, v34
  v_exp_f32 v135, v35
  v_exp_f32 v136, v40
  v_exp_f32 v137, v41
  v_exp_f32 v138, v42
  v_exp_f32 v139, v43
  v_pk_fma_f32 v[132:133], v[132:133], s[62:63], s[62:63] op_sel_hi:[1,0,0]
  v_pk_fma_f32 v[134:135], v[134:135], s[62:63], s[62:63] op_sel_hi:[1,0,0]
  v_pk_fma_f32 v[136:137], v[136:137], s[62:63], s[62:63] op_sel_hi:[1,0,0]
  v_pk_fma_f32 v[138:139], v[138:139], s[62:63], s[62:63] op_sel_hi:[1,0,0]
  v_rcp_f32 v132, v132
  v_rcp_f32 v133, v133
  v_rcp_f32 v134, v134
  v_rcp_f32 v135, v135
  v_rcp_f32 v136, v136
  v_rcp_f32 v137, v137
  v_rcp_f32 v138, v138
  v_rcp_f32 v139, v139
  v_pk_mul_f32 v[32:33], v[32:33], v[132:133]
  v_pk_mul_f32 v[34:35], v[34:35], v[134:135]
  v_pk_mul_f32 v[40:41], v[40:41], v[136:137]
  v_pk_mul_f32 v[42:43], v[42:43], v[138:139]
  v_cvt_pk_f16_f32 v120, v32, v33
  v_cvt_pk_f16_f32 v121, v34, v35
  v_cvt_pk_f16_f32 v122, v40, v41
  v_cvt_pk_f16_f32 v123, v42, v43
  buffer_store_dwordx4 v[120:123], v15, s[28:31], s66 offen offset:0 sc1
  v_pk_fma_f32 v[92:93], v[92:93], s[70:71], v[180:181] op_sel_hi:[1,0,1]
  v_pk_fma_f32 v[94:95], v[94:95], s[70:71], v[182:183] op_sel_hi:[1,0,1]
  v_pk_fma_f32 v[100:101], v[100:101], s[70:71], v[184:185] op_sel_hi:[1,0,1]
  v_pk_fma_f32 v[102:103], v[102:103], s[70:71], v[186:187] op_sel_hi:[1,0,1]
  v_exp_f32 v132, v92
  v_exp_f32 v133, v93
  v_exp_f32 v134, v94
  v_exp_f32 v135, v95
  v_exp_f32 v136, v100
  v_exp_f32 v137, v101
  v_exp_f32 v138, v102
  v_exp_f32 v139, v103
  v_pk_fma_f32 v[132:133], v[132:133], s[62:63], s[62:63] op_sel_hi:[1,0,0]
  v_pk_fma_f32 v[134:135], v[134:135], s[62:63], s[62:63] op_sel_hi:[1,0,0]
  v_pk_fma_f32 v[136:137], v[136:137], s[62:63], s[62:63] op_sel_hi:[1,0,0]
  v_pk_fma_f32 v[138:139], v[138:139], s[62:63], s[62:63] op_sel_hi:[1,0,0]
  v_rcp_f32 v132, v132
  v_rcp_f32 v133, v133
  v_rcp_f32 v134, v134
  v_rcp_f32 v135, v135
  v_rcp_f32 v136, v136
  v_rcp_f32 v137, v137
  v_rcp_f32 v138, v138
  v_rcp_f32 v139, v139
  v_pk_mul_f32 v[92:93], v[92:93], v[132:133]
  v_pk_mul_f32 v[94:95], v[94:95], v[134:135]
  v_pk_mul_f32 v[100:101], v[100:101], v[136:137]
  v_pk_mul_f32 v[102:103], v[102:103], v[138:139]
  v_cvt_pk_f16_f32 v124, v92, v93
  v_cvt_pk_f16_f32 v125, v94, v95
  v_cvt_pk_f16_f32 v126, v100, v101
  v_cvt_pk_f16_f32 v127, v102, v103
  buffer_store_dwordx4 v[124:127], v15, s[28:31], s66 offen offset:256 sc1
  s_lshl2_add_u32 s8, s45, s44
  s_mul_i32 s8, s8, 657408
  s_lshl_b32 s52, s47, 9
  s_add_u32 s8, s8, s52
  s_add_u32 s8, s8, 25169408
  s_add_u32 s11, s11, 131072
  buffer_load_dwordx4 a[216:219], v13, s[28:31], s51 offen offset:0 sc1
  buffer_load_dwordx4 a[220:223], v14, s[28:31], s51 offen offset:0 sc1
  buffer_load_dwordx4 a[224:227], v10, s[28:31], s51 offen offset:3072 sc1
  buffer_load_dwordx4 a[228:231], v13, s[28:31], s51 offen offset:3072 sc1
  s_mov_b64 exec, 0
  s_cmp_eq_u32 s44, 0
  s_cbranch_scc1 L_qg0
  s_cmp_eq_u32 s44, 1
  s_cbranch_scc1 L_qg1
  s_cmp_eq_u32 s44, 2
  s_cbranch_scc1 L_qg2
  s_branch L_qg3
L_qgback:
  s_mov_b64 exec, -1
  s_waitcnt vmcnt(6)
  buffer_load_dword v25, v18, s[28:31], s98 offen sc1
  v_lshrrev_b32 v20, 2, v19
  v_xor_b32 v20, v20, v1
  v_lshl_add_u32 v167, v20, 4, s50
  v_and_b32 v20, 3, v1
  v_lshrrev_b32 v22, 2, v1
  v_lshlrev_b32 v23, 4, v20
  v_lshl_add_u32 v17, v22, 13, v23
  v_lshlrev_b32 v20, 2, v20
  v_xor_b32 v20, v20, v22
  v_add_u32 v20, v20, v23
  s_mul_i32 s66, s44, 5120
  v_lshl_add_u32 v3, v20, 4, s66
  v_add_u32 v27, 81920, v3
  s_mul_i32 s65, s54, 655360
  s_lshl2_add_u32 s65, s48, s65
  s_addk_i32 s27, 4096
  s_lshl_b32 s27, s27, 7
  s_add_u32 s26, s27, s65
  s_lshl_b32 s66, s16, 11
  s_add_u32 s66, s66, s63
  s_lshl_b32 s66, s66, 7
  s_add_u32 s66, s66, s65
  s_lshl_b32 s65, s17, 7
  s_add_u32 s67, s66, s65
  s_add_u32 s68, s66, 131072
  s_add_u32 s69, s67, 131072
  buffer_load_dwordx4 a[232:235], v14, s[28:31], s51 offen offset:3072 sc1
  s_add_u32 s19, s51, s18
  buffer_load_dwordx4 a[236:239], v10, s[28:31], s19 offen offset:0 sc1
  buffer_load_dwordx4 a[240:243], v13, s[28:31], s19 offen offset:0 sc1
  buffer_load_dwordx4 a[244:247], v14, s[28:31], s19 offen offset:0 sc1
  s_waitcnt vmcnt(9)
  s_mov_b64 exec, 1
  buffer_store_dword v0, off, s[28:31], s11 sc1
  s_mov_b64 exec, -1
  s_waitcnt vmcnt(5)
  v_cmp_ne_u32 vcc, s49, v25
  s_cbranch_vccz L_pdone70
  s_mov_b64 exec, vcc
  s_mov_b32 s55, 65536
L_poll69:
  buffer_load_dword v25, v18, s[28:31], s98 offen sc1
  s_waitcnt vmcnt(0)
  v_cmp_ne_u32 vcc, s49, v25
  s_cbranch_vccz L_prest71
  s_mov_b64 exec, vcc
  s_sub_u32 s55, s55, 1
  s_cbranch_scc0 L_poll69
L_prest71:
  s_mov_b64 exec, -1
L_pdone70:
  s_add_u32 m0, s50, 16384
  s_add_u32 s52, s8, 0
  buffer_load_dwordx4 v4, s[28:31], s52 offen sc1 lds
  s_addk_i32 m0, 1024
  s_nop 0
  buffer_load_dwordx4 v5, s[28:31], s52 offen sc1 lds
  s_addk_i32 m0, 1024
  s_nop 0
  buffer_load_dwordx4 v6, s[28:31], s52 offen sc1 lds
  s_addk_i32 m0, 1024
  s_nop 0
  buffer_load_dwordx4 v7, s[28:31], s52 offen sc1 lds
  s_addk_i32 m0, 1024
  s_nop 0
  buffer_load_dwordx4 v8, s[28:31], s52 offen sc1 lds
  s_addk_i32 m0, 1024
  s_nop 0
  buffer_load_dwordx4 v9, s[28:31], s52 offen sc1 lds
  s_add_u32 m0, s50, 22528
  s_add_u32 s52, s8, 65536
  buffer_load_dwordx4 v4, s[28:31], s52 offen sc1 lds
  s_addk_i32 m0, 1024
  s_nop 0
  buffer_load_dwordx4 v5, s[28:31], s52 offen sc1 lds
  s_addk_i32 m0, 1024
  s_nop 0
  buffer_load_dwordx4 v6, s[28:31], s52 offen sc1 lds
  s_addk_i32 m0, 1024
  s_nop 0
  buffer_load_dwordx4 v7, s[28:31], s52 offen sc1 lds
  s_addk_i32 m0, 1024
  s_nop 0
  buffer_load_dwordx4 v8, s[28:31], s52 offen sc1 lds
  s_addk_i32 m0, 1024
  s_nop 0
  buffer_load_dwordx4 v9, s[28:31], s52 offen sc1 lds
  s_waitcnt vmcnt(6)
  buffer_load_dword v26, v18, s[28:31], s97 offen sc1
  s_barrier
  ds_read_b128 v[108:111], v11 offset:16384
  ds_read_b128 v[132:135], v12 offset:16384
  ds_read_b128 v[112:115], v11 offset:16960
  ds_read_b128 v[136:139], v12 offset:16960
  ds_read_b128 v[116:119], v11 offset:17536
  ds_read_b128 v[140:143], v12 offset:17536
  s_waitcnt lgkmcnt(4)
  v_pk_fma_f16 v108, v132, s53, v108
  v_pk_fma_f16 v109, v133, s53, v109
  v_pk_fma_f16 v110, v134, s53, v110
  v_pk_fma_f16 v111, v135, s53, v111
  s_waitcnt lgkmcnt(2)
  v_pk_fma_f16 v112, v136, s53, v112
  v_pk_fma_f16 v113, v137, s53, v113
  v_pk_fma_f16 v114, v138, s53, v114
  v_pk_fma_f16 v115, v139, s53, v115
  v_mfma_f32_16x16x32_f16 v[28:31], v[108:111], a[104:107], 0
  s_addk_i32 s51, 15360
  ds_read_b128 v[120:123], v11 offset:18112
  v_mfma_f32_16x16x32_f16 v[36:39], v[108:111], a[116:119], 0
L_qg0:
  s_cbranch_execz L_qgback
  ds_read_b128 v[144:147], v12 offset:18112
  v_mfma_f32_16x16x32_f16 v[44:47], v[108:111], a[128:131], 0
  s_waitcnt lgkmcnt(2)
  v_pk_fma_f16 v116, v140, s53, v116
  v_pk_fma_f16 v117, v141, s53, v117
  v_mfma_f32_16x16x32_f16 v[32:35], v[112:115], a[104:107], 0
  ds_read_b128 v[124:127], v11 offset:18688
  v_pk_fma_f16 v118, v142, s53, v118
  v_mfma_f32_16x16x32_f16 v[40:43], v[112:115], a[116:119], 0
  buffer_load_dwordx4 a[248:251], v10, s[28:31], s51 offen offset:0 sc1
  v_mfma_f32_16x16x32_f16 v[64:67], v[112:115], a[128:131], 0
  ds_read_b128 v[148:151], v12 offset:18688
  v_pk_fma_f16 v119, v143, s53, v119
  v_mfma_f32_16x16x32_f16 v[28:31], v[112:115], a[108:111], v[28:31]
  s_waitcnt lgkmcnt(2)
  ds_read_b128 v[128:131], v11 offset:19264
  v_pk_fma_f16 v120, v144, s53, v120
  v_mfma_f32_16x16x32_f16 v[36:39], v[112:115], a[120:123], v[36:39]
  ds_read_b128 v[152:155], v12 offset:19264
  v_pk_fma_f16 v121, v145, s53, v121
  v_mfma_f32_16x16x32_f16 v[44:47], v[112:115], a[132:135], v[44:47]
  v_pk_fma_f16 v122, v146, s53, v122
  v_pk_fma_f16 v123, v147, s53, v123
  v_mfma_f32_16x16x32_f16 v[48:51], v[116:119], a[104:107], 0
  buffer_load_dwordx4 a[252:255], v13, s[28:31], s51 offen offset:0 sc1
  v_mfma_f32_16x16x32_f16 v[56:59], v[116:119], a[116:119], 0
  s_waitcnt lgkmcnt(2)
  ds_read_b128 v[224:227], v11 offset:19840
  v_pk_fma_f16 v124, v148, s53, v124
  v_mfma_f32_16x16x32_f16 v[84:87], v[116:119], a[128:131], 0
  ds_read_b128 v[240:243], v12 offset:19840
  v_pk_fma_f16 v125, v149, s53, v125
  v_mfma_f32_16x16x32_f16 v[32:35], v[116:119], a[108:111], v[32:35]
  ds_read_b128 v[228:231], v11 offset:20416
  v_pk_fma_f16 v126, v150, s53, v126
  v_mfma_f32_16x16x32_f16 v[40:43], v[116:119], a[120:123], v[40:43]
  buffer_load_dwordx4 a[0:3], v14, s[28:31], s51 offen offset:0 sc1
  v_mfma_f32_16x16x32_f16 v[64:67], v[116:119], a[132:135], v[64:67]
  ds_read_b128 v[244:247], v12 offset:20416
  v_pk_fma_f16 v127, v151, s53, v127
  v_mfma_f32_16x16x32_f16 v[28:31], v[116:119], a[112:115], v[28:31]
  s_waitcnt lgkmcnt(4)
  ds_read_b128 v[232:235], v11 offset:20992
  v_pk_fma_f16 v128, v152, s53, v128
  v_mfma_f32_16x16x32_f16 v[36:39], v[116:119], a[124:127], v[36:39]
  ds_read_b128 v[248:251], v12 offset:20992
  v_pk_fma_f16 v129, v153, s53, v129
  v_mfma_f32_16x16x32_f16 v[44:47], v[116:119], a[136:139], v[44:47]
  v_pk_fma_f16 v130, v154, s53, v130
  v_pk_fma_f16 v131, v155, s53, v131
  v_mfma_f32_16x16x32_f16 v[52:55], v[120:123], a[104:107], 0
  buffer_load_dwordx4 a[4:7], v10, s[28:31], s51 offen offset:3072 sc1
  v_mfma_f32_16x16x32_f16 v[60:63], v[120:123], a[116:119], 0
  s_waitcnt lgkmcnt(4)
  ds_read_b128 v[236:239], v11 offset:21568
  v_pk_fma_f16 v224, v240, s53, v224
  v_mfma_f32_16x16x32_f16 v[104:107], v[120:123], a[128:131], 0
  s_waitcnt vmcnt(4)
  ds_read_b128 v[252:255], v12 offset:21568
  v_cmp_ne_u32 vcc, s49, v26
  v_mfma_f32_16x16x32_f16 v[48:51], v[120:123], a[108:111], v[48:51]
  v_pk_fma_f16 v225, v241, s53, v225
  v_pk_fma_f16 v226, v242, s53, v226
  v_mfma_f32_16x16x32_f16 v[56:59], v[120:123], a[120:123], v[56:59]
  s_cbranch_vccnz L_pfail76
L_pdone74:
  v_pk_fma_f16 v227, v243, s53, v227
  v_mfma_f32_16x16x32_f16 v[84:87], v[120:123], a[132:135], v[84:87]
  buffer_load_dwordx4 a[8:11], v13, s[28:31], s51 offen offset:3072 sc1
  v_mfma_f32_16x16x32_f16 v[32:35], v[120:123], a[112:115], v[32:35]
  s_waitcnt lgkmcnt(4)
  ds_add_u32 v210, v209 offset:0
  v_pk_fma_f16 v228, v244, s53, v228
  v_mfma_f32_16x16x32_f16 v[40:43], v[120:123], a[124:127], v[40:43]
  s_add_u32 m0, s50, 28672
  v_pk_fma_f16 v229, v245, s53, v229
  v_pk_fma_f16 v230, v246, s53, v230
  v_mfma_f32_16x16x32_f16 v[64:67], v[120:123], a[136:139], v[64:67]
  s_waitcnt lgkmcnt(3)
  v_pk_fma_f16 v231, v247, s53, v231
  v_pk_fma_f16 v232, v248, s53, v232
  v_mfma_f32_16x16x32_f16 v[68:71], v[124:127], a[104:107], 0
  s_add_u32 s52, s8, 131072
  v_pk_fma_f16 v233, v249, s53, v233
  v_pk_fma_f16 v234, v250, s53, v234
  v_mfma_f32_16x16x32_f16 v[76:79], v[124:127], a[116:119], 0
  buffer_load_dwordx4 v4, s[28:31], s52 offen sc1 lds
  v_mfma_f32_16x16x32_f16 v[52:55], v[124:127], a[108:111], v[52:55]
  s_addk_i32 m0, 1024
  ds_read_b32 v211, v210 offset:0
  v_pk_fma_f16 v235, v251, s53, v235
  v_mfma_f32_16x16x32_f16 v[60:63], v[124:127], a[120:123], v[60:63]
  s_waitcnt lgkmcnt(2)
  v_pk_fma_f16 v236, v252, s53, v236
  v_pk_fma_f16 v237, v253, s53, v237
  v_mfma_f32_16x16x32_f16 v[104:107], v[124:127], a[132:135], v[104:107]
  buffer_load_dwordx4 v5, s[28:31], s52 offen sc1 lds
  v_mfma_f32_16x16x32_f16 v[48:51], v[124:127], a[112:115], v[48:51]
  s_addk_i32 m0, 1024
  v_pk_fma_f16 v238, v254, s53, v238
  v_pk_fma_f16 v239, v255, s53, v239
  v_mfma_f32_16x16x32_f16 v[56:59], v[124:127], a[124:127], v[56:59]
  v_mfma_f32_16x16x32_f16 v[84:87], v[124:127], a[136:139], v[84:87]
  v_mfma_f32_16x16x32_f16 v[72:75], v[128:131], a[104:107], 0
  buffer_load_dwordx4 v6, s[28:31], s52 offen sc1 lds
  v_mfma_f32_16x16x32_f16 v[80:83], v[128:131], a[116:119], 0
  s_waitcnt lgkmcnt(0)
  s_addk_i32 m0, 1024
  v_cmp_le_u32 vcc, 40, v211
  v_mfma_f32_16x16x32_f16 v[68:71], v[128:131], a[108:111], v[68:71]
  v_mfma_f32_16x16x32_f16 v[76:79], v[128:131], a[120:123], v[76:79]
  s_cbranch_vccz L_sfail77
L_sok78:
  v_mfma_f32_16x16x32_f16 v[52:55], v[128:131], a[112:115], v[52:55]
  v_mfma_f32_16x16x32_f16 v[60:63], v[128:131], a[124:127], v[60:63]
  buffer_load_dwordx4 v7, s[28:31], s52 offen sc1 lds
  v_mfma_f32_16x16x32_f16 v[104:107], v[128:131], a[136:139], v[104:107]
  s_addk_i32 m0, 1024
  ds_read_b128 v[132:135], v11 offset:22528
  v_mfma_f32_16x16x32_f16 v[88:91], v[224:227], a[104:107], 0
  ds_read_b128 v[156:159], v12 offset:22528
  v_mfma_f32_16x16x32_f16 v[96:99], v[224:227], a[116:119], 0
  ds_read_b128 v[136:139], v11 offset:23104
  v_mfma_f32_16x16x32_f16 v[72:75], v[224:227], a[108:111], v[72:75]
  buffer_load_dwordx4 v8, s[28:31], s52 offen sc1 lds
  v_mfma_f32_16x16x32_f16 v[80:83], v[224:227], a[120:123], v[80:83]
  s_addk_i32 m0, 1024
  ds_read_b128 v[160:163], v12 offset:23104
  v_mfma_f32_16x16x32_f16 v[68:71], v[224:227], a[112:115], v[68:71]
  v_mfma_f32_16x16x32_f16 v[76:79], v[224:227], a[124:127], v[76:79]
  s_waitcnt lgkmcnt(2)
  ds_read_b128 v[140:143], v11 offset:23680
  v_pk_fma_f16 v132, v156, s53, v132
  v_mfma_f32_16x16x32_f16 v[92:95], v[228:231], a[104:107], 0
  v_pk_fma_f16 v133, v157, s53, v133
  v_pk_fma_f16 v134, v158, s53, v134
  v_mfma_f32_16x16x32_f16 v[100:103], v[228:231], a[116:119], 0
  buffer_load_dwordx4 v9, s[28:31], s52 offen sc1 lds
  v_mfma_f32_16x16x32_f16 v[88:91], v[228:231], a[108:111], v[88:91]
  s_waitcnt lgkmcnt(1)
  v_pk_fma_f16 v135, v159, s53, v135
  v_pk_fma_f16 v136, v160, s53, v136
  v_mfma_f32_16x16x32_f16 v[96:99], v[228:231], a[120:123], v[96:99]
  s_add_u32 m0, s50, 34816
  ds_read_b128 v[156:159], v12 offset:23680
  v_pk_fma_f16 v137, v161, s53, v137
  v_mfma_f32_16x16x32_f16 v[72:75], v[228:231], a[112:115], v[72:75]
  s_add_u32 s52, s8, 196608
  ds_read_b128 v[144:147], v11 offset:24256
  v_pk_fma_f16 v138, v162, s53, v138
  v_mfma_f32_16x16x32_f16 v[80:83], v[228:231], a[124:127], v[80:83]
  buffer_load_dwordx4 v4, s[28:31], s52 offen sc1 lds
  v_mfma_f32_16x16x32_f16 v[92:95], v[232:235], a[108:111], v[92:95]
  s_waitcnt lgkmcnt(1)
  v_pk_fma_f16 v139, v163, s53, v139
  v_pk_fma_f16 v140, v156, s53, v140
  v_mfma_f32_16x16x32_f16 v[100:103], v[232:235], a[120:123], v[100:103]
  s_addk_i32 m0, 1024
  ds_read_b128 v[160:163], v12 offset:24256
  v_pk_fma_f16 v141, v157, s53, v141
  v_mfma_f32_16x16x32_f16 v[88:91], v[232:235], a[112:115], v[88:91]
  v_pk_fma_f16 v142, v158, s53, v142
  v_pk_fma_f16 v143, v159, s53, v143
  v_mfma_f32_16x16x32_f16 v[96:99], v[232:235], a[124:127], v[96:99]
  ds_read_b128 v[148:151], v11 offset:24832
  v_mfma_f32_16x16x32_f16 v[92:95], v[236:239], a[112:115], v[92:95]
  buffer_load_dwordx4 v5, s[28:31], s52 offen sc1 lds
  v_mfma_f32_16x16x32_f16 v[100:103], v[236:239], a[124:127], v[100:103]
  s_waitcnt lgkmcnt(1)
  ds_read_b128 v[156:159], v12 offset:24832
  v_pk_fma_f16 v144, v160, s53, v144
  v_mfma_f32_16x16x32_f16 v[28:31], v[132:135], a[140:143], v[28:31]
  s_addk_i32 m0, 1024
  v_pk_fma_f16 v145, v161, s53, v145
  v_pk_fma_f16 v146, v162, s53, v146
  v_mfma_f32_16x16x32_f16 v[28:31], v[136:139], a[144:147], v[28:31]
  v_pk_fma_f16 v147, v163, s53, v147
  v_mfma_f32_16x16x32_f16 v[28:31], v[140:143], a[148:151], v[28:31]
  buffer_load_dwordx4 v6, s[28:31], s52 offen sc1 lds
  v_mfma_f32_16x16x32_f16 v[36:39], v[132:135], a[152:155], v[36:39]
  s_addk_i32 m0, 1024
  ds_read_b128 v[152:155], v11 offset:25408
  v_mfma_f32_16x16x32_f16 v[36:39], v[136:139], a[156:159], v[36:39]
  s_waitcnt lgkmcnt(1)
  ds_read_b128 v[160:163], v12 offset:25408
  v_pk_fma_f16 v148, v156, s53, v148
  v_mfma_f32_16x16x32_f16 v[36:39], v[140:143], a[160:163], v[36:39]
  v_pk_fma_f16 v149, v157, s53, v149
  v_pk_fma_f16 v150, v158, s53, v150
  v_mfma_f32_16x16x32_f16 v[44:47], v[132:135], a[164:167], v[44:47]
  v_pk_fma_f16 v151, v159, s53, v151
  v_mfma_f32_16x16x32_f16 v[44:47], v[136:139], a[168:171], v[44:47]
  buffer_load_dwordx4 v7, s[28:31], s52 offen sc1 lds
  v_mfma_f32_16x16x32_f16 v[44:47], v[140:143], a[172:175], v[44:47]
  s_addk_i32 m0, 1024
  ds_read_b128 v[240:243], v11 offset:25984
  v_mfma_f32_16x16x32_f16 v[32:35], v[136:139], a[140:143], v[32:35]
  s_waitcnt lgkmcnt(1)
  ds_read_b128 v[156:159], v12 offset:25984
  v_pk_fma_f16 v152, v160, s53, v152
  v_mfma_f32_16x16x32_f16 v[32:35], v[140:143], a[144:147], v[32:35]
  v_pk_fma_f16 v153, v161, s53, v153
  v_pk_fma_f16 v154, v162, s53, v154
  v_mfma_f32_16x16x32_f16 v[32:35], v[144:147], a[148:151], v[32:35]
  buffer_load_dwordx4 v8, s[28:31], s52 offen sc1 lds
  v_mfma_f32_16x16x32_f16 v[40:43], v[136:139], a[152:155], v[40:43]
  s_addk_i32 m0, 1024
  ds_read_b128 v[244:247], v11 offset:26560
  v_pk_fma_f16 v155, v163, s53, v155
  v_mfma_f32_16x16x32_f16 v[40:43], v[140:143], a[156:159], v[40:43]
  ds_read_b128 v[160:163], v12 offset:26560
  v_mfma_f32_16x16x32_f16 v[40:43], v[144:147], a[160:163], v[40:43]
  s_waitcnt lgkmcnt(2)
  v_pk_fma_f16 v240, v156, s53, v240
  v_pk_fma_f16 v241, v157, s53, v241
  v_mfma_f32_16x16x32_f16 v[64:67], v[136:139], a[164:167], v[64:67]
  v_pk_fma_f16 v242, v158, s53, v242
  v_pk_fma_f16 v243, v159, s53, v243
  v_mfma_f32_16x16x32_f16 v[64:67], v[140:143], a[168:171], v[64:67]
  buffer_load_dwordx4 v9, s[28:31], s52 offen sc1 lds
  v_mfma_f32_16x16x32_f16 v[64:67], v[144:147], a[172:175], v[64:67]
  s_add_u32 m0, s50, 4096
  s_add_u32 s52, s8, 262144
  ds_read_b128 v[248:251], v11 offset:27136
  v_mfma_f32_16x16x32_f16 v[48:51], v[140:143], a[140:143], v[48:51]
  ds_read_b128 v[156:159], v12 offset:27136
  v_mfma_f32_16x16x32_f16 v[48:51], v[144:147], a[144:147], v[48:51]
  s_waitcnt lgkmcnt(2)
  v_pk_fma_f16 v244, v160, s53, v244
  v_pk_fma_f16 v245, v161, s53, v245
  v_mfma_f32_16x16x32_f16 v[48:51], v[148:151], a[148:151], v[48:51]
  buffer_load_dwordx4 v4, s[28:31], s52 offen sc1 lds
  v_mfma_f32_16x16x32_f16 v[56:59], v[140:143], a[152:155], v[56:59]
  s_addk_i32 m0, 1024
  v_pk_fma_f16 v246, v162, s53, v246
  v_pk_fma_f16 v247, v163, s53, v247
  v_mfma_f32_16x16x32_f16 v[56:59], v[144:147], a[156:159], v[56:59]
  ds_read_b128 v[252:255], v11 offset:27712
  v_mfma_f32_16x16x32_f16 v[56:59], v[148:151], a[160:163], v[56:59]
  ds_read_b128 v[160:163], v12 offset:27712
  v_mfma_f32_16x16x32_f16 v[84:87], v[140:143], a[164:167], v[84:87]
  s_waitcnt vmcnt(7) lgkmcnt(2)
  ds_add_u32 v210, v209 offset:0
  v_pk_fma_f16 v248, v156, s53, v248
  v_mfma_f32_16x16x32_f16 v[84:87], v[144:147], a[168:171], v[84:87]
  buffer_load_dwordx4 v5, s[28:31], s52 offen sc1 lds
  v_mfma_f32_16x16x32_f16 v[84:87], v[148:151], a[172:175], v[84:87]
  s_addk_i32 m0, 1024
  v_pk_fma_f16 v249, v157, s53, v249
  v_pk_fma_f16 v250, v158, s53, v250
  v_mfma_f32_16x16x32_f16 v[52:55], v[144:147], a[140:143], v[52:55]
  v_pk_fma_f16 v251, v159, s53, v251
  v_mfma_f32_16x16x32_f16 v[52:55], v[148:151], a[144:147], v[52:55]
  ds_read_b32 v211, v210 offset:0
  v_mfma_f32_16x16x32_f16 v[52:55], v[152:155], a[148:151], v[52:55]
  buffer_load_dwordx4 v6, s[28:31], s52 offen sc1 lds
  v_mfma_f32_16x16x32_f16 v[60:63], v[144:147], a[152:155], v[60:63]
  s_waitcnt lgkmcnt(2)
  v_pk_fma_f16 v252, v160, s53, v252
  v_pk_fma_f16 v253, v161, s53, v253
  v_mfma_f32_16x16x32_f16 v[60:63], v[148:151], a[156:159], v[60:63]
  s_addk_i32 m0, 1024
  v_pk_fma_f16 v254, v162, s53, v254
  v_pk_fma_f16 v255, v163, s53, v255
  v_mfma_f32_16x16x32_f16 v[60:63], v[152:155], a[160:163], v[60:63]
  v_mfma_f32_16x16x32_f16 v[104:107], v[144:147], a[164:167], v[104:107]
  v_mfma_f32_16x16x32_f16 v[104:107], v[148:151], a[168:171], v[104:107]
  buffer_load_dwordx4 v7, s[28:31], s52 offen sc1 lds
  v_mfma_f32_16x16x32_f16 v[104:107], v[152:155], a[172:175], v[104:107]
  s_waitcnt lgkmcnt(0)
  s_addk_i32 m0, 1024
  v_cmp_le_u32 vcc, 44, v211
  v_mfma_f32_16x16x32_f16 v[68:71], v[148:151], a[140:143], v[68:71]
  v_mfma_f32_16x16x32_f16 v[68:71], v[152:155], a[144:147], v[68:71]
  s_cbranch_vccz L_sfail80
L_sok81:
  v_mfma_f32_16x16x32_f16 v[68:71], v[240:243], a[148:151], v[68:71]
  buffer_load_dwordx4 v8, s[28:31], s52 offen sc1 lds
  v_mfma_f32_16x16x32_f16 v[76:79], v[148:151], a[152:155], v[76:79]
  s_addk_i32 m0, 1024
  v_mfma_f32_16x16x32_f16 v[76:79], v[152:155], a[156:159], v[76:79]
  ds_read_b128 v[108:111], v11 offset:28672
  v_mfma_f32_16x16x32_f16 v[76:79], v[240:243], a[160:163], v[76:79]
  ds_read_b128 v[156:159], v12 offset:28672
  v_mfma_f32_16x16x32_f16 v[72:75], v[152:155], a[140:143], v[72:75]
  v_mfma_f32_16x16x32_f16 v[72:75], v[240:243], a[144:147], v[72:75]
  buffer_load_dwordx4 v9, s[28:31], s52 offen sc1 lds
  v_mfma_f32_16x16x32_f16 v[72:75], v[244:247], a[148:151], v[72:75]
  s_add_u32 m0, s50, 10240
  s_add_u32 s52, s8, 327680
  ds_read_b128 v[112:115], v11 offset:29248
  v_mfma_f32_16x16x32_f16 v[80:83], v[152:155], a[152:155], v[80:83]
  ds_read_b128 v[160:163], v12 offset:29248
  v_mfma_f32_16x16x32_f16 v[80:83], v[240:243], a[156:159], v[80:83]
  v_mfma_f32_16x16x32_f16 v[80:83], v[244:247], a[160:163], v[80:83]
  buffer_load_dwordx4 v4, s[28:31], s52 offen sc1 lds
  v_mfma_f32_16x16x32_f16 v[88:91], v[240:243], a[140:143], v[88:91]
  s_waitcnt lgkmcnt(2)
  ds_read_b128 v[116:119], v11 offset:29824
  v_pk_fma_f16 v108, v156, s53, v108
  v_mfma_f32_16x16x32_f16 v[88:91], v[244:247], a[144:147], v[88:91]
  s_addk_i32 m0, 1024
  v_pk_fma_f16 v109, v157, s53, v109
  v_pk_fma_f16 v110, v158, s53, v110
  v_mfma_f32_16x16x32_f16 v[88:91], v[248:251], a[148:151], v[88:91]
  s_waitcnt lgkmcnt(1)
  v_pk_fma_f16 v111, v159, s53, v111
  v_pk_fma_f16 v112, v160, s53, v112
  v_mfma_f32_16x16x32_f16 v[96:99], v[240:243], a[152:155], v[96:99]
  ds_read_b128 v[156:159], v12 offset:29824
  v_pk_fma_f16 v113, v161, s53, v113
  v_mfma_f32_16x16x32_f16 v[96:99], v[244:247], a[156:159], v[96:99]
  buffer_load_dwordx4 v5, s[28:31], s52 offen sc1 lds
  v_mfma_f32_16x16x32_f16 v[96:99], v[248:251], a[160:163], v[96:99]
  s_addk_i32 m0, 1024
  ds_read_b128 v[120:123], v11 offset:30400
  v_pk_fma_f16 v114, v162, s53, v114
  v_mfma_f32_16x16x32_f16 v[92:95], v[244:247], a[140:143], v[92:95]
  s_waitcnt lgkmcnt(1)
  v_pk_fma_f16 v115, v163, s53, v115
  v_pk_fma_f16 v116, v156, s53, v116
  v_mfma_f32_16x16x32_f16 v[92:95], v[248:251], a[144:147], v[92:95]
  ds_read_b128 v[160:163], v12 offset:30400
  v_pk_fma_f16 v117, v157, s53, v117
  v_mfma_f32_16x16x32_f16 v[92:95], v[252:255], a[148:151], v[92:95]
  buffer_load_dwordx4 v6, s[28:31], s52 offen sc1 lds
  v_mfma_f32_16x16x32_f16 v[100:103], v[244:247], a[152:155], v[100:103]
  ds_read_b128 v[124:127], v11 offset:30976
  v_pk_fma_f16 v118, v158, s53, v118
  v_mfma_f32_16x16x32_f16 v[100:103], v[248:251], a[156:159], v[100:103]
  v_pk_fma_f16 v119, v159, s53, v119
  v_mfma_f32_16x16x32_f16 v[100:103], v[252:255], a[160:163], v[100:103]
  s_waitcnt lgkmcnt(1)
  ds_read_b128 v[156:159], v12 offset:30976
  v_pk_fma_f16 v120, v160, s53, v120
  v_mfma_f32_16x16x32_f16 v[28:31], v[108:111], a[176:179], v[28:31]
  v_pk_fma_f16 v121, v161, s53, v121
  v_pk_fma_f16 v122, v162, s53, v122
  v_mfma_f32_16x16x32_f16 v[28:31], v[112:115], a[180:183], v[28:31]
  buffer_load_dwordx4 a[12:15], v14, s[28:31], s51 offen offset:3072 sc1
  v_mfma_f32_16x16x32_f16 v[28:31], v[116:119], a[184:187], v[28:31]
  s_add_u32 s19, s51, s18
  ds_read_b128 v[128:131], v11 offset:31552
  v_pk_fma_f16 v123, v163, s53, v123
  v_mfma_f32_16x16x32_f16 v[36:39], v[108:111], a[188:191], v[36:39]
  ds_read_b128 v[160:163], v12 offset:31552
  v_mfma_f32_16x16x32_f16 v[36:39], v[112:115], a[192:195], v[36:39]
  s_waitcnt lgkmcnt(2)
  v_pk_fma_f16 v124, v156, s53, v124
  v_pk_fma_f16 v125, v157, s53, v125
  v_mfma_f32_16x16x32_f16 v[36:39], v[116:119], a[196:199], v[36:39]
  buffer_load_dwordx4 a[16:19], v10, s[28:31], s19 offen offset:0 sc1
  v_mfma_f32_16x16x32_f16 v[44:47], v[108:111], a[200:203], v[44:47]
  v_pk_fma_f16 v126, v158, s53, v126
  v_pk_fma_f16 v127, v159, s53, v127
  v_mfma_f32_16x16x32_f16 v[44:47], v[112:115], a[204:207], v[44:47]
  ds_read_b128 v[224:227], v11 offset:32128
  v_mfma_f32_16x16x32_f16 v[44:47], v[116:119], a[208:211], v[44:47]
  ds_read_b128 v[156:159], v12 offset:32128
  v_mfma_f32_16x16x32_f16 v[32:35], v[112:115], a[176:179], v[32:35]
  s_waitcnt lgkmcnt(2)
  v_pk_fma_f16 v128, v160, s53, v128
  v_pk_fma_f16 v129, v161, s53, v129
  v_mfma_f32_16x16x32_f16 v[32:35], v[116:119], a[180:183], v[32:35]
  buffer_load_dwordx4 a[20:23], v13, s[28:31], s19 offen offset:0 sc1
  v_mfma_f32_16x16x32_f16 v[32:35], v[120:123], a[184:187], v[32:35]
  v_pk_fma_f16 v130, v162, s53, v130
  v_pk_fma_f16 v131, v163, s53, v131
  v_mfma_f32_16x16x32_f16 v[40:43], v[112:115], a[188:191], v[40:43]
  ds_read_b128 v[228:231], v11 offset:32704
  v_mfma_f32_16x16x32_f16 v[40:43], v[116:119], a[192:195], v[40:43]
  ds_read_b128 v[160:163], v12 offset:32704
  v_mfma_f32_16x16x32_f16 v[40:43], v[120:123], a[196:199], v[40:43]
  buffer_load_dwordx4 a[24:27], v14, s[28:31], s19 offen offset:0 sc1
  v_mfma_f32_16x16x32_f16 v[64:67], v[112:115], a[200:203], v[64:67]
  s_waitcnt lgkmcnt(2)
  v_pk_fma_f16 v224, v156, s53, v224
  v_pk_fma_f16 v225, v157, s53, v225
  v_mfma_f32_16x16x32_f16 v[64:67], v[116:119], a[204:207], v[64:67]
  s_addk_i32 m0, 1024
  v_pk_fma_f16 v226, v158, s53, v226
  v_pk_fma_f16 v227, v159, s53, v227
  v_mfma_f32_16x16x32_f16 v[64:67], v[120:123], a[208:211], v[64:67]
  ds_read_b128 v[232:235], v11 offset:33280
  v_mfma_f32_16x16x32_f16 v[48:51], v[116:119], a[176:179], v[48:51]
  ds_read_b128 v[156:159], v12 offset:33280
  v_mfma_f32_16x16x32_f16 v[48:51], v[120:123], a[180:183], v[48:51]
  buffer_load_dwordx4 v7, s[28:31], s52 offen sc1 lds
  v_mfma_f32_16x16x32_f16 v[48:51], v[124:127], a[184:187], v[48:51]
  s_waitcnt lgkmcnt(2)
  v_pk_fma_f16 v228, v160, s53, v228
  v_pk_fma_f16 v229, v161, s53, v229
  v_mfma_f32_16x16x32_f16 v[56:59], v[116:119], a[188:191], v[56:59]
  s_addk_i32 m0, 1024
  v_pk_fma_f16 v230, v162, s53, v230
  v_pk_fma_f16 v231, v163, s53, v231
  v_mfma_f32_16x16x32_f16 v[56:59], v[120:123], a[192:195], v[56:59]
  ds_read_b128 v[236:239], v11 offset:33856
  v_mfma_f32_16x16x32_f16 v[56:59], v[124:127], a[196:199], v[56:59]
  buffer_load_dwordx4 v8, s[28:31], s52 offen sc1 lds
  v_mfma_f32_16x16x32_f16 v[84:87], v[116:119], a[200:203], v[84:87]
  s_waitcnt vmcnt(15)
  ds_add_u32 v210, v209 offset:0
  ds_read_b128 v[160:163], v12 offset:33856
  v_mfma_f32_16x16x32_f16 v[84:87], v[120:123], a[204:207], v[84:87]
  s_waitcnt lgkmcnt(3)
  v_pk_fma_f16 v232, v156, s53, v232
  v_pk_fma_f16 v233, v157, s53, v233
  v_mfma_f32_16x16x32_f16 v[84:87], v[124:127], a[208:211], v[84:87]
  s_addk_i32 m0, 1024
  v_pk_fma_f16 v234, v158, s53, v234
  v_pk_fma_f16 v235, v159, s53, v235
  v_mfma_f32_16x16x32_f16 v[52:55], v[120:123], a[176:179], v[52:55]
  v_mfma_f32_16x16x32_f16 v[52:55], v[124:127], a[180:183], v[52:55]
  buffer_load_dwordx4 v9, s[28:31], s52 offen sc1 lds
  v_mfma_f32_16x16x32_f16 v[52:55], v[128:131], a[184:187], v[52:55]
  s_waitcnt lgkmcnt(0)
  ds_read_b32 v211, v210 offset:0
  v_pk_fma_f16 v236, v160, s53, v236
  v_mfma_f32_16x16x32_f16 v[60:63], v[120:123], a[188:191], v[60:63]
  s_add_u32 m0, s50, 16384
  v_pk_fma_f16 v237, v161, s53, v237
  v_pk_fma_f16 v238, v162, s53, v238
  v_mfma_f32_16x16x32_f16 v[60:63], v[124:127], a[192:195], v[60:63]
  s_add_u32 s52, s8, 393216
  v_pk_fma_f16 v239, v163, s53, v239
  v_mfma_f32_16x16x32_f16 v[60:63], v[128:131], a[196:199], v[60:63]
  buffer_load_dwordx4 v4, s[28:31], s52 offen sc1 lds
  v_mfma_f32_16x16x32_f16 v[104:107], v[120:123], a[200:203], v[104:107]
  s_addk_i32 m0, 1024
  v_mfma_f32_16x16x32_f16 v[104:107], v[124:127], a[204:207], v[104:107]
  v_mfma_f32_16x16x32_f16 v[104:107], v[128:131], a[208:211], v[104:107]
  s_waitcnt lgkmcnt(0)
  v_cmp_le_u32 vcc, 48, v211
  v_mfma_f32_16x16x32_f16 v[68:71], v[124:127], a[176:179], v[68:71]
  v_mfma_f32_16x16x32_f16 v[68:71], v[128:131], a[180:183], v[68:71]
  buffer_load_dwordx4 v5, s[28:31], s52 offen sc1 lds
  v_mfma_f32_16x16x32_f16 v[68:71], v[224:227], a[184:187], v[68:71]
  s_addk_i32 m0, 1024
  s_cbranch_vccz L_sfail83
L_sok84:
  v_mfma_f32_16x16x32_f16 v[76:79], v[124:127], a[188:191], v[76:79]
  v_mfma_f32_16x16x32_f16 v[76:79], v[128:131], a[192:195], v[76:79]
  ds_read_b128 v[132:135], v11 offset:34816
  v_mfma_f32_16x16x32_f16 v[76:79], v[224:227], a[196:199], v[76:79]
  buffer_load_dwordx4 v6, s[28:31], s52 offen sc1 lds
  v_mfma_f32_16x16x32_f16 v[72:75], v[128:131], a[176:179], v[72:75]
  s_addk_i32 s51, 15360
  ds_read_b128 v[156:159], v12 offset:34816
  v_mfma_f32_16x16x32_f16 v[72:75], v[224:227], a[180:183], v[72:75]
  ds_read_b128 v[136:139], v11 offset:35392
  v_mfma_f32_16x16x32_f16 v[72:75], v[228:231], a[184:187], v[72:75]
  ds_read_b128 v[160:163], v12 offset:35392
  v_mfma_f32_16x16x32_f16 v[80:83], v[128:131], a[188:191], v[80:83]
  v_mfma_f32_16x16x32_f16 v[80:83], v[224:227], a[192:195], v[80:83]
  buffer_load_dwordx4 a[28:31], v10, s[28:31], s51 offen offset:0 sc1
  v_mfma_f32_16x16x32_f16 v[80:83], v[228:231], a[196:199], v[80:83]
  s_waitcnt lgkmcnt(2)
  ds_read_b128 v[140:143], v11 offset:35968
  v_pk_fma_f16 v132, v156, s53, v132
  v_mfma_f32_16x16x32_f16 v[88:91], v[224:227], a[176:179], v[88:91]
  v_pk_fma_f16 v133, v157, s53, v133
  v_pk_fma_f16 v134, v158, s53, v134
  v_mfma_f32_16x16x32_f16 v[88:91], v[228:231], a[180:183], v[88:91]
  v_pk_fma_f16 v135, v159, s53, v135
  v_mfma_f32_16x16x32_f16 v[88:91], v[232:235], a[184:187], v[88:91]
  s_waitcnt lgkmcnt(1)
  ds_read_b128 v[156:159], v12 offset:35968
  v_pk_fma_f16 v136, v160, s53, v136
  v_mfma_f32_16x16x32_f16 v[96:99], v[224:227], a[188:191], v[96:99]
  buffer_load_dwordx4 a[32:35], v13, s[28:31], s51 offen offset:0 sc1
  v_mfma_f32_16x16x32_f16 v[96:99], v[228:231], a[192:195], v[96:99]
  ds_read_b128 v[144:147], v11 offset:36544
  v_pk_fma_f16 v137, v161, s53, v137
  v_mfma_f32_16x16x32_f16 v[96:99], v[232:235], a[196:199], v[96:99]
  v_pk_fma_f16 v138, v162, s53, v138
  v_pk_fma_f16 v139, v163, s53, v139
  v_mfma_f32_16x16x32_f16 v[92:95], v[228:231], a[176:179], v[92:95]
  s_waitcnt lgkmcnt(1)
  ds_read_b128 v[160:163], v12 offset:36544
  v_pk_fma_f16 v140, v156, s53, v140
  v_mfma_f32_16x16x32_f16 v[92:95], v[232:235], a[180:183], v[92:95]
  buffer_load_dwordx4 a[36:39], v14, s[28:31], s51 offen offset:0 sc1
  v_mfma_f32_16x16x32_f16 v[92:95], v[236:239], a[184:187], v[92:95]
  ds_read_b128 v[148:151], v11 offset:37120
  v_pk_fma_f16 v141, v157, s53, v141
  v_mfma_f32_16x16x32_f16 v[100:103], v[228:231], a[188:191], v[100:103]
  v_pk_fma_f16 v142, v158, s53, v142
  v_pk_fma_f16 v143, v159, s53, v143
  v_mfma_f32_16x16x32_f16 v[100:103], v[232:235], a[192:195], v[100:103]
  s_waitcnt lgkmcnt(1)
  ds_read_b128 v[156:159], v12 offset:37120
  v_pk_fma_f16 v144, v160, s53, v144
  v_mfma_f32_16x16x32_f16 v[100:103], v[236:239], a[196:199], v[100:103]
  buffer_load_dwordx4 a[40:43], v10, s[28:31], s51 offen offset:3072 sc1
  v_mfma_f32_16x16x32_f16 v[28:31], v[132:135], a[212:215], v[28:31]
  v_pk_fma_f16 v145, v161, s53, v145
  v_pk_fma_f16 v146, v162, s53, v146
  v_mfma_f32_16x16x32_f16 v[28:31], v[136:139], a[216:219], v[28:31]
  ds_read_b128 v[152:155], v11 offset:37696
  v_pk_fma_f16 v147, v163, s53, v147
  v_mfma_f32_16x16x32_f16 v[28:31], v[140:143], a[220:223], v[28:31]
  ds_read_b128 v[160:163], v12 offset:37696
  v_mfma_f32_16x16x32_f16 v[36:39], v[132:135], a[224:227], v[36:39]
  s_waitcnt lgkmcnt(2)
  v_pk_fma_f16 v148, v156, s53, v148
  v_pk_fma_f16 v149, v157, s53, v149
  v_mfma_f32_16x16x32_f16 v[36:39], v[136:139], a[228:231], v[36:39]
  buffer_load_dwordx4 a[44:47], v13, s[28:31], s51 offen offset:3072 sc1
  v_mfma_f32_16x16x32_f16 v[36:39], v[140:143], a[232:235], v[36:39]
  v_pk_fma_f16 v150, v158, s53, v150
  v_pk_fma_f16 v151, v159, s53, v151
  v_mfma_f32_16x16x32_f16 v[44:47], v[132:135], a[236:239], v[44:47]
  ds_read_b128 v[240:243], v11 offset:38272
  v_mfma_f32_16x16x32_f16 v[44:47], v[136:139], a[240:243], v[44:47]
  ds_read_b128 v[156:159], v12 offset:38272
  v_mfma_f32_16x16x32_f16 v[44:47], v[140:143], a[244:247], v[44:47]
  buffer_load_dwordx4 a[48:51], v14, s[28:31], s51 offen offset:3072 sc1
  v_mfma_f32_16x16x32_f16 v[32:35], v[136:139], a[212:215], v[32:35]
  s_waitcnt lgkmcnt(2)
  v_pk_fma_f16 v152, v160, s53, v152
  v_pk_fma_f16 v153, v161, s53, v153
  v_mfma_f32_16x16x32_f16 v[32:35], v[140:143], a[216:219], v[32:35]
  s_add_u32 s19, s51, s18
  v_pk_fma_f16 v154, v162, s53, v154
  v_pk_fma_f16 v155, v163, s53, v155
  v_mfma_f32_16x16x32_f16 v[32:35], v[144:147], a[220:223], v[32:35]
  ds_read_b128 v[244:247], v11 offset:38848
  v_mfma_f32_16x16x32_f16 v[40:43], v[136:139], a[224:227], v[40:43]
  ds_read_b128 v[160:163], v12 offset:38848
  v_mfma_f32_16x16x32_f16 v[40:43], v[140:143], a[228:231], v[40:43]
  buffer_load_dwordx4 a[52:55], v10, s[28:31], s19 offen offset:0 sc1
  v_mfma_f32_16x16x32_f16 v[40:43], v[144:147], a[232:235], v[40:43]
  s_waitcnt lgkmcnt(2)
  v_pk_fma_f16 v240, v156, s53, v240
  v_pk_fma_f16 v241, v157, s53, v241
  v_mfma_f32_16x16x32_f16 v[64:67], v[136:139], a[236:239], v[64:67]
  s_addk_i32 m0, 1024
  v_pk_fma_f16 v242, v158, s53, v242
  v_pk_fma_f16 v243, v159, s53, v243
  v_mfma_f32_16x16x32_f16 v[64:67], v[140:143], a[240:243], v[64:67]
  ds_read_b128 v[248:251], v11 offset:39424
  v_mfma_f32_16x16x32_f16 v[64:67], v[144:147], a[244:247], v[64:67]
  buffer_load_dwordx4 v7, s[28:31], s52 offen sc1 lds
  v_mfma_f32_16x16x32_f16 v[48:51], v[140:143], a[212:215], v[48:51]
  s_waitcnt lgkmcnt(1)
  ds_read_b128 v[156:159], v12 offset:39424
  v_pk_fma_f16 v244, v160, s53, v244
  v_mfma_f32_16x16x32_f16 v[48:51], v[144:147], a[216:219], v[48:51]
  v_pk_fma_f16 v245, v161, s53, v245
  v_pk_fma_f16 v246, v162, s53, v246
  v_mfma_f32_16x16x32_f16 v[48:51], v[148:151], a[220:223], v[48:51]
L_qg1:
  s_cbranch_execz L_qgback
  v_pk_fma_f16 v247, v163, s53, v247
  v_mfma_f32_16x16x32_f16 v[56:59], v[140:143], a[224:227], v[56:59]
  ds_read_b128 v[252:255], v11 offset:40000
  v_mfma_f32_16x16x32_f16 v[56:59], v[144:147], a[228:231], v[56:59]
  buffer_load_dwordx4 a[56:59], v13, s[28:31], s19 offen offset:0 sc1
  v_mfma_f32_16x16x32_f16 v[56:59], v[148:151], a[232:235], v[56:59]
  s_waitcnt lgkmcnt(1)
  ds_read_b128 v[160:163], v12 offset:40000
  v_pk_fma_f16 v248, v156, s53, v248
  v_mfma_f32_16x16x32_f16 v[84:87], v[140:143], a[236:239], v[84:87]
  s_waitcnt vmcnt(22)
  ds_add_u32 v210, v209 offset:0
  v_pk_fma_f16 v249, v157, s53, v249
  v_mfma_f32_16x16x32_f16 v[84:87], v[144:147], a[240:243], v[84:87]
  v_pk_fma_f16 v250, v158, s53, v250
  v_pk_fma_f16 v251, v159, s53, v251
  v_mfma_f32_16x16x32_f16 v[84:87], v[148:151], a[244:247], v[84:87]
  buffer_load_dwordx4 a[60:63], v14, s[28:31], s19 offen offset:0 sc1
  v_mfma_f32_16x16x32_f16 v[52:55], v[144:147], a[212:215], v[52:55]
  s_addk_i32 m0, 1024
  v_mfma_f32_16x16x32_f16 v[52:55], v[148:151], a[216:219], v[52:55]
  s_waitcnt lgkmcnt(1)
  ds_read_b32 v211, v210 offset:0
  v_pk_fma_f16 v252, v160, s53, v252
  v_mfma_f32_16x16x32_f16 v[52:55], v[152:155], a[220:223], v[52:55]
  v_pk_fma_f16 v253, v161, s53, v253
  v_pk_fma_f16 v254, v162, s53, v254
  v_mfma_f32_16x16x32_f16 v[60:63], v[144:147], a[224:227], v[60:63]
  v_pk_fma_f16 v255, v163, s53, v255
  v_mfma_f32_16x16x32_f16 v[60:63], v[148:151], a[228:231], v[60:63]
  buffer_load_dwordx4 v8, s[28:31], s52 offen sc1 lds
  v_mfma_f32_16x16x32_f16 v[60:63], v[152:155], a[232:235], v[60:63]
  s_addk_i32 m0, 1024
  v_mfma_f32_16x16x32_f16 v[104:107], v[144:147], a[236:239], v[104:107]
  v_mfma_f32_16x16x32_f16 v[104:107], v[148:151], a[240:243], v[104:107]
  v_mfma_f32_16x16x32_f16 v[104:107], v[152:155], a[244:247], v[104:107]
  buffer_load_dwordx4 v9, s[28:31], s52 offen sc1 lds
  v_mfma_f32_16x16x32_f16 v[68:71], v[148:151], a[212:215], v[68:71]
  s_waitcnt lgkmcnt(0)
  s_add_u32 m0, s50, 22528
  v_cmp_le_u32 vcc, 52, v211
  v_mfma_f32_16x16x32_f16 v[68:71], v[152:155], a[216:219], v[68:71]
  s_add_u32 s52, s8, 458752
  v_mfma_f32_16x16x32_f16 v[68:71], v[240:243], a[220:223], v[68:71]
  s_cbranch_vccz L_sfail86
L_sok87:
  v_mfma_f32_16x16x32_f16 v[76:79], v[148:151], a[224:227], v[76:79]
  v_mfma_f32_16x16x32_f16 v[76:79], v[152:155], a[228:231], v[76:79]
  buffer_load_dwordx4 v4, s[28:31], s52 offen sc1 lds
  v_mfma_f32_16x16x32_f16 v[76:79], v[240:243], a[232:235], v[76:79]
  s_addk_i32 m0, 1024
  ds_read_b128 v[108:111], v11 offset:4096
  v_mfma_f32_16x16x32_f16 v[72:75], v[152:155], a[212:215], v[72:75]
  ds_read_b128 v[156:159], v12 offset:4096
  v_mfma_f32_16x16x32_f16 v[72:75], v[240:243], a[216:219], v[72:75]
  ds_read_b128 v[112:115], v11 offset:4672
  v_mfma_f32_16x16x32_f16 v[72:75], v[244:247], a[220:223], v[72:75]
  buffer_load_dwordx4 v5, s[28:31], s52 offen sc1 lds
  v_mfma_f32_16x16x32_f16 v[80:83], v[152:155], a[224:227], v[80:83]
  s_addk_i32 m0, 1024
  ds_read_b128 v[160:163], v12 offset:4672
  v_mfma_f32_16x16x32_f16 v[80:83], v[240:243], a[228:231], v[80:83]
  v_mfma_f32_16x16x32_f16 v[80:83], v[244:247], a[232:235], v[80:83]
  s_waitcnt lgkmcnt(2)
  ds_read_b128 v[116:119], v11 offset:5248
  v_pk_fma_f16 v108, v156, s53, v108
  v_mfma_f32_16x16x32_f16 v[88:91], v[240:243], a[212:215], v[88:91]
  v_pk_fma_f16 v109, v157, s53, v109
  v_pk_fma_f16 v110, v158, s53, v110
  v_mfma_f32_16x16x32_f16 v[88:91], v[244:247], a[216:219], v[88:91]
  buffer_load_dwordx4 v6, s[28:31], s52 offen sc1 lds
  v_mfma_f32_16x16x32_f16 v[88:91], v[248:251], a[220:223], v[88:91]
  s_waitcnt lgkmcnt(1)
  v_pk_fma_f16 v111, v159, s53, v111
  v_pk_fma_f16 v112, v160, s53, v112
  v_mfma_f32_16x16x32_f16 v[96:99], v[240:243], a[224:227], v[96:99]
  s_addk_i32 m0, 1024
  ds_read_b128 v[156:159], v12 offset:5248
  v_pk_fma_f16 v113, v161, s53, v113
  v_mfma_f32_16x16x32_f16 v[96:99], v[244:247], a[228:231], v[96:99]
  ds_read_b128 v[120:123], v11 offset:5824
  v_pk_fma_f16 v114, v162, s53, v114
  v_mfma_f32_16x16x32_f16 v[96:99], v[248:251], a[232:235], v[96:99]
  buffer_load_dwordx4 v7, s[28:31], s52 offen sc1 lds
  v_mfma_f32_16x16x32_f16 v[92:95], v[244:247], a[212:215], v[92:95]
  s_waitcnt lgkmcnt(1)
  v_pk_fma_f16 v115, v163, s53, v115
  v_pk_fma_f16 v116, v156, s53, v116
  v_mfma_f32_16x16x32_f16 v[92:95], v[248:251], a[216:219], v[92:95]
  s_addk_i32 s51, 15360
  ds_read_b128 v[160:163], v12 offset:5824
  v_pk_fma_f16 v117, v157, s53, v117
  v_mfma_f32_16x16x32_f16 v[92:95], v[252:255], a[220:223], v[92:95]
  ds_read_b128 v[124:127], v11 offset:6400
  v_pk_fma_f16 v118, v158, s53, v118
  v_mfma_f32_16x16x32_f16 v[100:103], v[244:247], a[224:227], v[100:103]
  v_pk_fma_f16 v119, v159, s53, v119
  v_mfma_f32_16x16x32_f16 v[100:103], v[248:251], a[228:231], v[100:103]
  buffer_load_dwordx4 a[64:67], v10, s[28:31], s51 offen offset:0 sc1
  v_mfma_f32_16x16x32_f16 v[100:103], v[252:255], a[232:235], v[100:103]
  s_waitcnt lgkmcnt(1)
  ds_read_b128 v[156:159], v12 offset:6400
  v_pk_fma_f16 v120, v160, s53, v120
  v_mfma_f32_16x16x32_f16 v[28:31], v[108:111], a[248:251], v[28:31]
  ds_read_b128 v[128:131], v11 offset:6976
  v_pk_fma_f16 v121, v161, s53, v121
  v_mfma_f32_16x16x32_f16 v[28:31], v[112:115], a[252:255], v[28:31]
  v_pk_fma_f16 v122, v162, s53, v122
  v_pk_fma_f16 v123, v163, s53, v123
  v_mfma_f32_16x16x32_f16 v[28:31], v[116:119], a[0:3], v[28:31]
  buffer_load_dwordx4 a[68:71], v13, s[28:31], s51 offen offset:0 sc1
  v_mfma_f32_16x16x32_f16 v[36:39], v[108:111], a[4:7], v[36:39]
  s_waitcnt lgkmcnt(1)
  ds_read_b128 v[160:163], v12 offset:6976
  v_pk_fma_f16 v124, v156, s53, v124
  v_mfma_f32_16x16x32_f16 v[36:39], v[112:115], a[8:11], v[36:39]
  s_waitcnt vmcnt(25)
  v_pk_fma_f16 v125, v157, s53, v125
  v_pk_fma_f16 v126, v158, s53, v126
  v_mfma_f32_16x16x32_f16 v[36:39], v[116:119], a[12:15], v[36:39]
  ds_read_b128 v[224:227], v11 offset:7552
  v_pk_fma_f16 v127, v159, s53, v127
  v_mfma_f32_16x16x32_f16 v[44:47], v[108:111], a[16:19], v[44:47]
  ds_read_b128 v[156:159], v12 offset:7552
  v_mfma_f32_16x16x32_f16 v[44:47], v[112:115], a[20:23], v[44:47]
  s_waitcnt vmcnt(24)
  buffer_load_dwordx4 a[72:75], v14, s[28:31], s51 offen offset:0 sc1
  v_mfma_f32_16x16x32_f16 v[44:47], v[116:119], a[24:27], v[44:47]
  s_waitcnt lgkmcnt(2)
  v_pk_fma_f16 v128, v160, s53, v128
  v_pk_fma_f16 v129, v161, s53, v129
  v_mfma_f32_16x16x32_f16 v[32:35], v[112:115], a[248:251], v[32:35]
  s_addk_i32 m0, 1024
  v_pk_fma_f16 v130, v162, s53, v130
  v_pk_fma_f16 v131, v163, s53, v131
  v_mfma_f32_16x16x32_f16 v[32:35], v[116:119], a[252:255], v[32:35]
  ds_read_b128 v[228:231], v11 offset:8128
  v_mfma_f32_16x16x32_f16 v[32:35], v[120:123], a[0:3], v[32:35]
  buffer_load_dwordx4 v8, s[28:31], s52 offen sc1 lds
  v_mfma_f32_16x16x32_f16 v[40:43], v[112:115], a[4:7], v[40:43]
  s_waitcnt lgkmcnt(1)
  ds_read_b128 v[160:163], v12 offset:8128
  v_pk_fma_f16 v224, v156, s53, v224
  v_mfma_f32_16x16x32_f16 v[40:43], v[116:119], a[8:11], v[40:43]
  v_pk_fma_f16 v225, v157, s53, v225
  v_pk_fma_f16 v226, v158, s53, v226
  v_mfma_f32_16x16x32_f16 v[40:43], v[120:123], a[12:15], v[40:43]
  ds_read_b128 v[232:235], v11 offset:8704
  v_pk_fma_f16 v227, v159, s53, v227
  v_mfma_f32_16x16x32_f16 v[64:67], v[112:115], a[16:19], v[64:67]
  ds_read_b128 v[156:159], v12 offset:8704
  v_mfma_f32_16x16x32_f16 v[64:67], v[116:119], a[20:23], v[64:67]
  buffer_load_dwordx4 a[76:79], v10, s[28:31], s51 offen offset:3072 sc1
  v_mfma_f32_16x16x32_f16 v[64:67], v[120:123], a[24:27], v[64:67]
  s_waitcnt lgkmcnt(2)
  v_pk_fma_f16 v228, v160, s53, v228
  v_pk_fma_f16 v229, v161, s53, v229
  v_mfma_f32_16x16x32_f16 v[48:51], v[116:119], a[248:251], v[48:51]
  v_pk_fma_f16 v230, v162, s53, v230
  v_pk_fma_f16 v231, v163, s53, v231
  v_mfma_f32_16x16x32_f16 v[48:51], v[120:123], a[252:255], v[48:51]
  ds_read_b128 v[236:239], v11 offset:9280
  v_mfma_f32_16x16x32_f16 v[48:51], v[124:127], a[0:3], v[48:51]
  buffer_load_dwordx4 a[80:83], v13, s[28:31], s51 offen offset:3072 sc1
  v_mfma_f32_16x16x32_f16 v[56:59], v[116:119], a[4:7], v[56:59]
  s_waitcnt lgkmcnt(1)
  ds_read_b128 v[160:163], v12 offset:9280
  v_pk_fma_f16 v232, v156, s53, v232
  v_mfma_f32_16x16x32_f16 v[56:59], v[120:123], a[8:11], v[56:59]
  s_waitcnt vmcnt(25)
  ds_add_u32 v210, v209 offset:0
  v_pk_fma_f16 v233, v157, s53, v233
  v_mfma_f32_16x16x32_f16 v[56:59], v[124:127], a[12:15], v[56:59]
  v_pk_fma_f16 v234, v158, s53, v234
  v_pk_fma_f16 v235, v159, s53, v235
  v_mfma_f32_16x16x32_f16 v[84:87], v[116:119], a[16:19], v[84:87]
  v_mfma_f32_16x16x32_f16 v[84:87], v[120:123], a[20:23], v[84:87]
  buffer_load_dwordx4 a[84:87], v14, s[28:31], s51 offen offset:3072 sc1
  v_mfma_f32_16x16x32_f16 v[84:87], v[124:127], a[24:27], v[84:87]
  s_waitcnt lgkmcnt(1)
  ds_read_b32 v211, v210 offset:0
  v_pk_fma_f16 v236, v160, s53, v236
  v_mfma_f32_16x16x32_f16 v[52:55], v[120:123], a[248:251], v[52:55]
  s_add_u32 s19, s51, s18
  v_pk_fma_f16 v237, v161, s53, v237
  v_pk_fma_f16 v238, v162, s53, v238
  v_mfma_f32_16x16x32_f16 v[52:55], v[124:127], a[252:255], v[52:55]
  v_pk_fma_f16 v239, v163, s53, v239
  v_mfma_f32_16x16x32_f16 v[52:55], v[128:131], a[0:3], v[52:55]
  v_mfma_f32_16x16x32_f16 v[60:63], v[120:123], a[4:7], v[60:63]
  buffer_load_dwordx4 a[88:91], v10, s[28:31], s19 offen offset:0 sc1
  v_mfma_f32_16x16x32_f16 v[60:63], v[124:127], a[8:11], v[60:63]
  v_mfma_f32_16x16x32_f16 v[60:63], v[128:131], a[12:15], v[60:63]
  v_mfma_f32_16x16x32_f16 v[104:107], v[120:123], a[16:19], v[104:107]
  s_waitcnt lgkmcnt(0)
  v_cmp_le_u32 vcc, 56, v211
  v_mfma_f32_16x16x32_f16 v[104:107], v[124:127], a[20:23], v[104:107]
  buffer_load_dwordx4 a[92:95], v13, s[28:31], s19 offen offset:0 sc1
  v_mfma_f32_16x16x32_f16 v[104:107], v[128:131], a[24:27], v[104:107]
  s_cbranch_vccz L_sfail89
L_sok90:
  v_mfma_f32_16x16x32_f16 v[68:71], v[124:127], a[248:251], v[68:71]
  v_mfma_f32_16x16x32_f16 v[68:71], v[128:131], a[252:255], v[68:71]
  v_mfma_f32_16x16x32_f16 v[68:71], v[224:227], a[0:3], v[68:71]
  ds_read_b128 v[132:135], v11 offset:10240
  v_mfma_f32_16x16x32_f16 v[76:79], v[124:127], a[4:7], v[76:79]
  buffer_load_dwordx4 a[96:99], v14, s[28:31], s19 offen offset:0 sc1
  v_mfma_f32_16x16x32_f16 v[76:79], v[128:131], a[8:11], v[76:79]
  s_addk_i32 m0, 1024
  ds_read_b128 v[156:159], v12 offset:10240
  v_mfma_f32_16x16x32_f16 v[76:79], v[224:227], a[12:15], v[76:79]
  v_mfma_f32_16x16x32_f16 v[72:75], v[128:131], a[248:251], v[72:75]
  ds_read_b128 v[136:139], v11 offset:10816
  v_mfma_f32_16x16x32_f16 v[72:75], v[224:227], a[252:255], v[72:75]
  buffer_load_dwordx4 v9, s[28:31], s52 offen sc1 lds
  v_mfma_f32_16x16x32_f16 v[72:75], v[228:231], a[0:3], v[72:75]
  s_add_u32 m0, s50, 28672
  s_add_u32 s52, s8, 524288
  ds_read_b128 v[160:163], v12 offset:10816
  v_mfma_f32_16x16x32_f16 v[80:83], v[128:131], a[4:7], v[80:83]
  s_waitcnt lgkmcnt(2)
  v_pk_fma_f16 v132, v156, s53, v132
  v_pk_fma_f16 v133, v157, s53, v133
  v_mfma_f32_16x16x32_f16 v[80:83], v[224:227], a[8:11], v[80:83]
  ds_read_b128 v[140:143], v11 offset:11392
  v_pk_fma_f16 v134, v158, s53, v134
  v_mfma_f32_16x16x32_f16 v[80:83], v[228:231], a[12:15], v[80:83]
  v_pk_fma_f16 v135, v159, s53, v135
  v_mfma_f32_16x16x32_f16 v[88:91], v[224:227], a[248:251], v[88:91]
  buffer_load_dwordx4 v4, s[28:31], s52 offen sc1 lds
  v_mfma_f32_16x16x32_f16 v[88:91], v[228:231], a[252:255], v[88:91]
  s_waitcnt lgkmcnt(1)
  ds_read_b128 v[156:159], v12 offset:11392
  v_pk_fma_f16 v136, v160, s53, v136
  v_mfma_f32_16x16x32_f16 v[88:91], v[232:235], a[0:3], v[88:91]
  s_addk_i32 m0, 1024
  v_pk_fma_f16 v137, v161, s53, v137
  v_pk_fma_f16 v138, v162, s53, v138
  v_mfma_f32_16x16x32_f16 v[96:99], v[224:227], a[4:7], v[96:99]
  ds_read_b128 v[144:147], v11 offset:11968
  v_pk_fma_f16 v139, v163, s53, v139
  v_mfma_f32_16x16x32_f16 v[96:99], v[228:231], a[8:11], v[96:99]
  buffer_load_dwordx4 v5, s[28:31], s52 offen sc1 lds
  v_mfma_f32_16x16x32_f16 v[96:99], v[232:235], a[12:15], v[96:99]
  s_waitcnt lgkmcnt(1)
  ds_read_b128 v[160:163], v12 offset:11968
  v_pk_fma_f16 v140, v156, s53, v140
  v_mfma_f32_16x16x32_f16 v[92:95], v[228:231], a[248:251], v[92:95]
  s_addk_i32 m0, 1024
  v_pk_fma_f16 v141, v157, s53, v141
  v_pk_fma_f16 v142, v158, s53, v142
  v_mfma_f32_16x16x32_f16 v[92:95], v[232:235], a[252:255], v[92:95]
  ds_read_b128 v[148:151], v11 offset:12544
  v_pk_fma_f16 v143, v159, s53, v143
  v_mfma_f32_16x16x32_f16 v[92:95], v[236:239], a[0:3], v[92:95]
  ds_read_b128 v[156:159], v12 offset:12544
  v_mfma_f32_16x16x32_f16 v[100:103], v[228:231], a[4:7], v[100:103]
  buffer_load_dwordx4 v6, s[28:31], s52 offen sc1 lds
  v_mfma_f32_16x16x32_f16 v[100:103], v[232:235], a[8:11], v[100:103]
  s_waitcnt lgkmcnt(2)
  v_pk_fma_f16 v144, v160, s53, v144
  v_pk_fma_f16 v145, v161, s53, v145
  v_mfma_f32_16x16x32_f16 v[100:103], v[236:239], a[12:15], v[100:103]
  s_waitcnt vmcnt(27)
  ds_read_b128 v[152:155], v11 offset:13120
  v_pk_fma_f16 v146, v162, s53, v146
  v_mfma_f32_16x16x32_f16 v[28:31], v[132:135], a[28:31], v[28:31]
  s_addk_i32 m0, 1024
  v_pk_fma_f16 v147, v163, s53, v147
  v_mfma_f32_16x16x32_f16 v[28:31], v[136:139], a[32:35], v[28:31]
  buffer_load_dwordx4 v7, s[28:31], s52 offen sc1 lds
  v_mfma_f32_16x16x32_f16 v[28:31], v[140:143], a[36:39], v[28:31]
  s_waitcnt vmcnt(25) lgkmcnt(1)
  ds_read_b128 v[160:163], v12 offset:13120
  v_pk_fma_f16 v148, v156, s53, v148
  v_mfma_f32_16x16x32_f16 v[36:39], v[132:135], a[40:43], v[36:39]
  s_addk_i32 m0, 1024
  v_pk_fma_f16 v149, v157, s53, v149
  v_pk_fma_f16 v150, v158, s53, v150
  v_mfma_f32_16x16x32_f16 v[36:39], v[136:139], a[44:47], v[36:39]
  ds_read_b128 v[240:243], v11 offset:13696
  v_pk_fma_f16 v151, v159, s53, v151
  v_mfma_f32_16x16x32_f16 v[36:39], v[140:143], a[48:51], v[36:39]
  s_waitcnt vmcnt(21)
  ds_read_b128 v[156:159], v12 offset:13696
  v_mfma_f32_16x16x32_f16 v[44:47], v[132:135], a[52:55], v[44:47]
  buffer_load_dwordx4 v8, s[28:31], s52 offen sc1 lds
  v_mfma_f32_16x16x32_f16 v[44:47], v[136:139], a[56:59], v[44:47]
  s_waitcnt lgkmcnt(2)
  v_pk_fma_f16 v152, v160, s53, v152
  v_pk_fma_f16 v153, v161, s53, v153
  v_mfma_f32_16x16x32_f16 v[44:47], v[140:143], a[60:63], v[44:47]
  s_addk_i32 m0, 1024
  ds_read_b128 v[244:247], v11 offset:14272
  v_pk_fma_f16 v154, v162, s53, v154
  v_mfma_f32_16x16x32_f16 v[32:35], v[136:139], a[28:31], v[32:35]
  v_pk_fma_f16 v155, v163, s53, v155
  v_mfma_f32_16x16x32_f16 v[32:35], v[140:143], a[32:35], v[32:35]
  buffer_load_dwordx4 v9, s[28:31], s52 offen sc1 lds
  v_mfma_f32_16x16x32_f16 v[32:35], v[144:147], a[36:39], v[32:35]
  s_waitcnt lgkmcnt(1)
  ds_read_b128 v[160:163], v12 offset:14272
  v_pk_fma_f16 v240, v156, s53, v240
  v_mfma_f32_16x16x32_f16 v[40:43], v[136:139], a[40:43], v[40:43]
  s_add_u32 m0, s50, 34816
  v_pk_fma_f16 v241, v157, s53, v241
  v_pk_fma_f16 v242, v158, s53, v242
  v_mfma_f32_16x16x32_f16 v[40:43], v[140:143], a[44:47], v[40:43]
  s_add_u32 s52, s8, 589824
  ds_read_b128 v[248:251], v11 offset:14848
  v_pk_fma_f16 v243, v159, s53, v243
  v_mfma_f32_16x16x32_f16 v[40:43], v[144:147], a[48:51], v[40:43]
  s_waitcnt vmcnt(21)
  ds_add_u32 v210, v209 offset:0
  ds_read_b128 v[156:159], v12 offset:14848
  v_mfma_f32_16x16x32_f16 v[64:67], v[136:139], a[52:55], v[64:67]
  buffer_load_dwordx4 v4, s[28:31], s52 offen sc1 lds
  v_mfma_f32_16x16x32_f16 v[64:67], v[140:143], a[56:59], v[64:67]
  s_waitcnt lgkmcnt(3)
  v_pk_fma_f16 v244, v160, s53, v244
  v_pk_fma_f16 v245, v161, s53, v245
  v_mfma_f32_16x16x32_f16 v[64:67], v[144:147], a[60:63], v[64:67]
  s_addk_i32 s51, 15360
  ds_read_b128 v[252:255], v11 offset:15424
  v_pk_fma_f16 v246, v162, s53, v246
  v_mfma_f32_16x16x32_f16 v[48:51], v[140:143], a[28:31], v[48:51]
  ds_read_b32 v211, v210 offset:0
  v_pk_fma_f16 v247, v163, s53, v247
  v_mfma_f32_16x16x32_f16 v[48:51], v[144:147], a[32:35], v[48:51]
  buffer_load_dwordx4 a[100:103], v10, s[28:31], s51 offen offset:0 sc1
  v_mfma_f32_16x16x32_f16 v[48:51], v[148:151], a[36:39], v[48:51]
  s_waitcnt lgkmcnt(2)
  ds_read_b128 v[160:163], v12 offset:15424
  v_pk_fma_f16 v248, v156, s53, v248
  v_mfma_f32_16x16x32_f16 v[56:59], v[140:143], a[40:43], v[56:59]
  v_pk_fma_f16 v249, v157, s53, v249
  v_pk_fma_f16 v250, v158, s53, v250
  v_mfma_f32_16x16x32_f16 v[56:59], v[144:147], a[44:47], v[56:59]
  v_pk_fma_f16 v251, v159, s53, v251
  v_mfma_f32_16x16x32_f16 v[56:59], v[148:151], a[48:51], v[56:59]
  v_mfma_f32_16x16x32_f16 v[84:87], v[140:143], a[52:55], v[84:87]
  buffer_load_dwordx4 a[104:107], v13, s[28:31], s51 offen offset:0 sc1
  v_mfma_f32_16x16x32_f16 v[84:87], v[144:147], a[56:59], v[84:87]
  s_waitcnt lgkmcnt(0)
  v_pk_fma_f16 v252, v160, s53, v252
  v_cmp_le_u32 vcc, 60, v211
  v_mfma_f32_16x16x32_f16 v[84:87], v[148:151], a[60:63], v[84:87]
  v_pk_fma_f16 v253, v161, s53, v253
  v_pk_fma_f16 v254, v162, s53, v254
  v_mfma_f32_16x16x32_f16 v[52:55], v[144:147], a[28:31], v[52:55]
  s_cbranch_vccz L_sfail92
L_sok93:
  v_pk_fma_f16 v255, v163, s53, v255
  v_mfma_f32_16x16x32_f16 v[52:55], v[148:151], a[32:35], v[52:55]
  buffer_load_dwordx4 a[108:111], v14, s[28:31], s51 offen offset:0 sc1
  v_mfma_f32_16x16x32_f16 v[52:55], v[152:155], a[36:39], v[52:55]
  s_addk_i32 m0, 1024
  v_mfma_f32_16x16x32_f16 v[60:63], v[144:147], a[40:43], v[60:63]
  ds_read_b128 v[108:111], v11 offset:16384
  v_mfma_f32_16x16x32_f16 v[60:63], v[148:151], a[44:47], v[60:63]
  ds_read_b128 v[156:159], v12 offset:16384
  v_mfma_f32_16x16x32_f16 v[60:63], v[152:155], a[48:51], v[60:63]
  v_mfma_f32_16x16x32_f16 v[104:107], v[144:147], a[52:55], v[104:107]
  buffer_load_dwordx4 v5, s[28:31], s52 offen sc1 lds
  v_mfma_f32_16x16x32_f16 v[104:107], v[148:151], a[56:59], v[104:107]
  ds_read_b128 v[112:115], v11 offset:16960
  v_mfma_f32_16x16x32_f16 v[104:107], v[152:155], a[60:63], v[104:107]
  ds_read_b128 v[160:163], v12 offset:16960
  v_mfma_f32_16x16x32_f16 v[68:71], v[148:151], a[28:31], v[68:71]
  v_mfma_f32_16x16x32_f16 v[68:71], v[152:155], a[32:35], v[68:71]
  buffer_load_dwordx4 a[112:115], v10, s[28:31], s51 offen offset:3072 sc1
  v_mfma_f32_16x16x32_f16 v[68:71], v[240:243], a[36:39], v[68:71]
  s_waitcnt lgkmcnt(2)
  ds_read_b128 v[116:119], v11 offset:17536
  v_pk_fma_f16 v108, v156, s53, v108
  v_mfma_f32_16x16x32_f16 v[76:79], v[148:151], a[40:43], v[76:79]
  v_pk_fma_f16 v109, v157, s53, v109
  v_pk_fma_f16 v110, v158, s53, v110
  v_mfma_f32_16x16x32_f16 v[76:79], v[152:155], a[44:47], v[76:79]
  v_pk_fma_f16 v111, v159, s53, v111
  v_mfma_f32_16x16x32_f16 v[76:79], v[240:243], a[48:51], v[76:79]
  s_waitcnt lgkmcnt(1)
  ds_read_b128 v[156:159], v12 offset:17536
  v_pk_fma_f16 v112, v160, s53, v112
  v_mfma_f32_16x16x32_f16 v[72:75], v[152:155], a[28:31], v[72:75]
  buffer_load_dwordx4 a[116:119], v13, s[28:31], s51 offen offset:3072 sc1
  v_mfma_f32_16x16x32_f16 v[72:75], v[240:243], a[32:35], v[72:75]
  ds_read_b128 v[120:123], v11 offset:18112
  v_pk_fma_f16 v113, v161, s53, v113
  v_mfma_f32_16x16x32_f16 v[72:75], v[244:247], a[36:39], v[72:75]
  v_pk_fma_f16 v114, v162, s53, v114
  v_pk_fma_f16 v115, v163, s53, v115
  v_mfma_f32_16x16x32_f16 v[80:83], v[152:155], a[40:43], v[80:83]
  s_waitcnt lgkmcnt(1)
  ds_read_b128 v[160:163], v12 offset:18112
  v_pk_fma_f16 v116, v156, s53, v116
  v_mfma_f32_16x16x32_f16 v[80:83], v[240:243], a[44:47], v[80:83]
  buffer_load_dwordx4 a[120:123], v14, s[28:31], s51 offen offset:3072 sc1
  v_mfma_f32_16x16x32_f16 v[80:83], v[244:247], a[48:51], v[80:83]
  s_add_u32 s19, s51, s18
  ds_read_b128 v[124:127], v11 offset:18688
  v_pk_fma_f16 v117, v157, s53, v117
  v_mfma_f32_16x16x32_f16 v[88:91], v[240:243], a[28:31], v[88:91]
  v_pk_fma_f16 v118, v158, s53, v118
  v_pk_fma_f16 v119, v159, s53, v119
  v_mfma_f32_16x16x32_f16 v[88:91], v[244:247], a[32:35], v[88:91]
  s_waitcnt lgkmcnt(1)
  ds_read_b128 v[156:159], v12 offset:18688
  v_pk_fma_f16 v120, v160, s53, v120
  v_mfma_f32_16x16x32_f16 v[88:91], v[248:251], a[36:39], v[88:91]
  ds_read_b128 v[128:131], v11 offset:19264
  v_pk_fma_f16 v121, v161, s53, v121
  v_mfma_f32_16x16x32_f16 v[96:99], v[240:243], a[40:43], v[96:99]
  buffer_load_dwordx4 a[124:127], v10, s[28:31], s19 offen offset:0 sc1
  v_mfma_f32_16x16x32_f16 v[96:99], v[244:247], a[44:47], v[96:99]
  v_pk_fma_f16 v122, v162, s53, v122
  v_pk_fma_f16 v123, v163, s53, v123
  v_mfma_f32_16x16x32_f16 v[96:99], v[248:251], a[48:51], v[96:99]
  s_waitcnt lgkmcnt(1)
  ds_read_b128 v[160:163], v12 offset:19264
  v_pk_fma_f16 v124, v156, s53, v124
  v_mfma_f32_16x16x32_f16 v[92:95], v[244:247], a[28:31], v[92:95]
  ds_read_b128 v[224:227], v11 offset:19840
  v_pk_fma_f16 v125, v157, s53, v125
  v_mfma_f32_16x16x32_f16 v[92:95], v[248:251], a[32:35], v[92:95]
  buffer_load_dwordx4 a[128:131], v13, s[28:31], s19 offen offset:0 sc1
  v_mfma_f32_16x16x32_f16 v[92:95], v[252:255], a[36:39], v[92:95]
  v_pk_fma_f16 v126, v158, s53, v126
  v_pk_fma_f16 v127, v159, s53, v127
  v_mfma_f32_16x16x32_f16 v[100:103], v[244:247], a[40:43], v[100:103]
  s_waitcnt lgkmcnt(1)
  ds_read_b128 v[156:159], v12 offset:19840
  v_pk_fma_f16 v128, v160, s53, v128
  v_mfma_f32_16x16x32_f16 v[100:103], v[248:251], a[44:47], v[100:103]
  v_pk_fma_f16 v129, v161, s53, v129
  v_pk_fma_f16 v130, v162, s53, v130
  v_mfma_f32_16x16x32_f16 v[100:103], v[252:255], a[48:51], v[100:103]
  s_waitcnt vmcnt(24)
  ds_read_b128 v[228:231], v11 offset:20416
  v_pk_fma_f16 v131, v163, s53, v131
  v_mfma_f32_16x16x32_f16 v[28:31], v[108:111], a[64:67], v[28:31]
  buffer_load_dwordx4 a[132:135], v14, s[28:31], s19 offen offset:0 sc1
  v_mfma_f32_16x16x32_f16 v[28:31], v[112:115], a[68:71], v[28:31]
  s_waitcnt vmcnt(17)
  ds_add_u32 v210, v209 offset:0
  ds_read_b128 v[160:163], v12 offset:20416
  v_mfma_f32_16x16x32_f16 v[28:31], v[116:119], a[72:75], v[28:31]
  s_waitcnt lgkmcnt(3)
  v_pk_fma_f16 v224, v156, s53, v224
  v_pk_fma_f16 v225, v157, s53, v225
  v_mfma_f32_16x16x32_f16 v[36:39], v[108:111], a[76:79], v[36:39]
  s_addk_i32 m0, 1024
  ds_read_b128 v[232:235], v11 offset:20992
  v_pk_fma_f16 v226, v158, s53, v226
  v_mfma_f32_16x16x32_f16 v[36:39], v[112:115], a[80:83], v[36:39]
  buffer_load_dwordx4 v6, s[28:31], s52 offen sc1 lds
  v_mfma_f32_16x16x32_f16 v[36:39], v[116:119], a[84:87], v[36:39]
  s_addk_i32 m0, 1024
  ds_read_b32 v211, v210 offset:0
  v_pk_fma_f16 v227, v159, s53, v227
  v_mfma_f32_16x16x32_f16 v[44:47], v[108:111], a[88:91], v[44:47]
  s_waitcnt lgkmcnt(2)
  ds_read_b128 v[156:159], v12 offset:20992
  v_pk_fma_f16 v228, v160, s53, v228
  v_mfma_f32_16x16x32_f16 v[44:47], v[112:115], a[92:95], v[44:47]
  ds_read_b128 v[236:239], v11 offset:21568
  v_pk_fma_f16 v229, v161, s53, v229
  v_mfma_f32_16x16x32_f16 v[44:47], v[116:119], a[96:99], v[44:47]
  v_pk_fma_f16 v230, v162, s53, v230
  v_pk_fma_f16 v231, v163, s53, v231
  v_mfma_f32_16x16x32_f16 v[32:35], v[112:115], a[64:67], v[32:35]
  buffer_load_dwordx4 v7, s[28:31], s52 offen sc1 lds
  v_mfma_f32_16x16x32_f16 v[32:35], v[116:119], a[68:71], v[32:35]
  s_waitcnt lgkmcnt(1)
  ds_read_b128 v[160:163], v12 offset:21568
  v_pk_fma_f16 v232, v156, s53, v232
  v_mfma_f32_16x16x32_f16 v[32:35], v[120:123], a[72:75], v[32:35]
  s_addk_i32 m0, 1024
  v_pk_fma_f16 v233, v157, s53, v233
  v_cmp_le_u32 vcc, 64, v211
  v_mfma_f32_16x16x32_f16 v[40:43], v[112:115], a[76:79], v[40:43]
  v_pk_fma_f16 v234, v158, s53, v234
  v_pk_fma_f16 v235, v159, s53, v235
  v_mfma_f32_16x16x32_f16 v[40:43], v[116:119], a[80:83], v[40:43]
  buffer_load_dwordx4 v8, s[28:31], s52 offen sc1 lds
  v_mfma_f32_16x16x32_f16 v[40:43], v[120:123], a[84:87], v[40:43]
  s_waitcnt lgkmcnt(0)
  s_addk_i32 m0, 1024
  v_pk_fma_f16 v236, v160, s53, v236
  v_mfma_f32_16x16x32_f16 v[64:67], v[112:115], a[88:91], v[64:67]
  s_cbranch_vccz L_sfail95
L_sok96:
  v_pk_fma_f16 v237, v161, s53, v237
  v_mfma_f32_16x16x32_f16 v[64:67], v[116:119], a[92:95], v[64:67]
  ds_read_b128 v[132:135], v11 offset:22528
  v_pk_fma_f16 v238, v162, s53, v238
  v_mfma_f32_16x16x32_f16 v[64:67], v[120:123], a[96:99], v[64:67]
  ds_read_b128 v[156:159], v12 offset:22528
  v_pk_fma_f16 v239, v163, s53, v239
  v_mfma_f32_16x16x32_f16 v[48:51], v[116:119], a[64:67], v[48:51]
  buffer_load_dwordx4 v9, s[28:31], s52 offen sc1 lds
  v_mfma_f32_16x16x32_f16 v[48:51], v[120:123], a[68:71], v[48:51]
  s_addk_i32 s51, 15360
  v_mfma_f32_16x16x32_f16 v[48:51], v[124:127], a[72:75], v[48:51]
  ds_read_b128 v[136:139], v11 offset:23104
  v_mfma_f32_16x16x32_f16 v[56:59], v[116:119], a[76:79], v[56:59]
  ds_read_b128 v[160:163], v12 offset:23104
  v_mfma_f32_16x16x32_f16 v[56:59], v[120:123], a[80:83], v[56:59]
  buffer_load_dwordx4 a[136:139], v10, s[28:31], s51 offen offset:0 sc1
  v_mfma_f32_16x16x32_f16 v[56:59], v[124:127], a[84:87], v[56:59]
  s_waitcnt lgkmcnt(2)
  v_pk_fma_f16 v132, v156, s53, v132
  v_pk_fma_f16 v133, v157, s53, v133
  v_mfma_f32_16x16x32_f16 v[84:87], v[116:119], a[88:91], v[84:87]
  ds_read_b128 v[140:143], v11 offset:23680
  v_pk_fma_f16 v134, v158, s53, v134
  v_mfma_f32_16x16x32_f16 v[84:87], v[120:123], a[92:95], v[84:87]
  v_pk_fma_f16 v135, v159, s53, v135
  v_mfma_f32_16x16x32_f16 v[84:87], v[124:127], a[96:99], v[84:87]
  ds_read_b128 v[156:159], v12 offset:23680
  v_mfma_f32_16x16x32_f16 v[52:55], v[120:123], a[64:67], v[52:55]
  buffer_load_dwordx4 a[140:143], v13, s[28:31], s51 offen offset:0 sc1
  v_mfma_f32_16x16x32_f16 v[52:55], v[124:127], a[68:71], v[52:55]
  s_waitcnt lgkmcnt(2)
  ds_read_b128 v[144:147], v11 offset:24256
  v_pk_fma_f16 v136, v160, s53, v136
  v_mfma_f32_16x16x32_f16 v[52:55], v[128:131], a[72:75], v[52:55]
  v_pk_fma_f16 v137, v161, s53, v137
  v_pk_fma_f16 v138, v162, s53, v138
  v_mfma_f32_16x16x32_f16 v[60:63], v[120:123], a[76:79], v[60:63]
  v_pk_fma_f16 v139, v163, s53, v139
  v_mfma_f32_16x16x32_f16 v[60:63], v[124:127], a[80:83], v[60:63]
  s_waitcnt lgkmcnt(1)
  ds_read_b128 v[160:163], v12 offset:24256
  v_pk_fma_f16 v140, v156, s53, v140
  v_mfma_f32_16x16x32_f16 v[60:63], v[128:131], a[84:87], v[60:63]
  buffer_load_dwordx4 a[144:147], v14, s[28:31], s51 offen offset:0 sc1
  v_mfma_f32_16x16x32_f16 v[104:107], v[120:123], a[88:91], v[104:107]
  s_add_u32 s99, s51, 15360
  ds_read_b128 v[148:151], v11 offset:24832
  v_pk_fma_f16 v141, v157, s53, v141
  v_mfma_f32_16x16x32_f16 v[104:107], v[124:127], a[92:95], v[104:107]
  v_pk_fma_f16 v142, v158, s53, v142
  v_pk_fma_f16 v143, v159, s53, v143
  v_mfma_f32_16x16x32_f16 v[104:107], v[128:131], a[96:99], v[104:107]
  s_waitcnt lgkmcnt(1)
  ds_read_b128 v[156:159], v12 offset:24832
  v_pk_fma_f16 v144, v160, s53, v144
  v_mfma_f32_16x16x32_f16 v[68:71], v[124:127], a[64:67], v[68:71]
  buffer_load_dwordx4 a[148:151], v10, s[28:31], s99 offen offset:0 sc1
  v_mfma_f32_16x16x32_f16 v[68:71], v[128:131], a[68:71], v[68:71]
  ds_read_b128 v[152:155], v11 offset:25408
  v_pk_fma_f16 v145, v161, s53, v145
  v_mfma_f32_16x16x32_f16 v[68:71], v[224:227], a[72:75], v[68:71]
L_qg2:
  s_cbranch_execz L_qgback
  v_pk_fma_f16 v146, v162, s53, v146
  v_pk_fma_f16 v147, v163, s53, v147
  v_mfma_f32_16x16x32_f16 v[76:79], v[124:127], a[76:79], v[76:79]
  s_waitcnt lgkmcnt(1)
  ds_read_b128 v[160:163], v12 offset:25408
  v_pk_fma_f16 v148, v156, s53, v148
  v_mfma_f32_16x16x32_f16 v[76:79], v[128:131], a[80:83], v[76:79]
  buffer_load_dwordx4 a[152:155], v13, s[28:31], s99 offen offset:0 sc1
  v_mfma_f32_16x16x32_f16 v[76:79], v[224:227], a[84:87], v[76:79]
  s_waitcnt vmcnt(20)
  ds_add_u32 v210, v209 offset:0
  ds_read_b128 v[240:243], v11 offset:25984
  v_mfma_f32_16x16x32_f16 v[72:75], v[128:131], a[64:67], v[72:75]
  v_pk_fma_f16 v149, v157, s53, v149
  v_pk_fma_f16 v150, v158, s53, v150
  v_mfma_f32_16x16x32_f16 v[72:75], v[224:227], a[68:71], v[72:75]
  s_waitcnt lgkmcnt(2)
  v_pk_fma_f16 v151, v159, s53, v151
  v_pk_fma_f16 v152, v160, s53, v152
  v_mfma_f32_16x16x32_f16 v[72:75], v[228:231], a[72:75], v[72:75]
  ds_read_b32 v211, v210 offset:0
  ds_read_b128 v[156:159], v12 offset:25984
  v_mfma_f32_16x16x32_f16 v[80:83], v[128:131], a[76:79], v[80:83]
  buffer_load_dwordx4 a[156:159], v14, s[28:31], s99 offen offset:0 sc1
  v_mfma_f32_16x16x32_f16 v[80:83], v[224:227], a[80:83], v[80:83]
  ds_read_b128 v[244:247], v11 offset:26560
  v_pk_fma_f16 v153, v161, s53, v153
  v_mfma_f32_16x16x32_f16 v[80:83], v[228:231], a[84:87], v[80:83]
  v_pk_fma_f16 v154, v162, s53, v154
  v_pk_fma_f16 v155, v163, s53, v155
  v_mfma_f32_16x16x32_f16 v[88:91], v[224:227], a[64:67], v[88:91]
  s_waitcnt lgkmcnt(1)
  ds_read_b128 v[160:163], v12 offset:26560
  v_pk_fma_f16 v240, v156, s53, v240
  v_mfma_f32_16x16x32_f16 v[88:91], v[228:231], a[68:71], v[88:91]
  buffer_load_dwordx4 a[160:163], v10, s[28:31], s51 offen offset:3072 sc1
  v_mfma_f32_16x16x32_f16 v[88:91], v[232:235], a[72:75], v[88:91]
  ds_read_b128 v[248:251], v11 offset:27136
  v_pk_fma_f16 v241, v157, s53, v241
  v_mfma_f32_16x16x32_f16 v[96:99], v[224:227], a[76:79], v[96:99]
  v_pk_fma_f16 v242, v158, s53, v242
  v_cmp_le_u32 vcc, 68, v211
  v_mfma_f32_16x16x32_f16 v[96:99], v[228:231], a[80:83], v[96:99]
  s_waitcnt lgkmcnt(1)
  v_pk_fma_f16 v243, v159, s53, v243
  v_pk_fma_f16 v244, v160, s53, v244
  v_mfma_f32_16x16x32_f16 v[96:99], v[232:235], a[84:87], v[96:99]
  s_cbranch_vccz L_sfail98
L_sok99:
  ds_read_b128 v[156:159], v12 offset:27136
  v_mfma_f32_16x16x32_f16 v[92:95], v[228:231], a[64:67], v[92:95]
  ds_read_b128 v[252:255], v11 offset:27712
  v_pk_fma_f16 v245, v161, s53, v245
  v_mfma_f32_16x16x32_f16 v[92:95], v[232:235], a[68:71], v[92:95]
  v_pk_fma_f16 v246, v162, s53, v246
  v_pk_fma_f16 v247, v163, s53, v247
  v_mfma_f32_16x16x32_f16 v[92:95], v[236:239], a[72:75], v[92:95]
  s_waitcnt lgkmcnt(1)
  ds_read_b128 v[160:163], v12 offset:27712
  v_pk_fma_f16 v248, v156, s53, v248
  v_mfma_f32_16x16x32_f16 v[100:103], v[228:231], a[76:79], v[100:103]
  buffer_load_dwordx4 a[164:167], v13, s[28:31], s51 offen offset:3072 sc1
  v_mfma_f32_16x16x32_f16 v[100:103], v[232:235], a[80:83], v[100:103]
  ds_read_b128 v[108:111], v11 offset:28672
  v_pk_fma_f16 v249, v157, s53, v249
  v_mfma_f32_16x16x32_f16 v[100:103], v[236:239], a[84:87], v[100:103]
  s_waitcnt vmcnt(19)
  v_pk_fma_f16 v250, v158, s53, v250
  v_pk_fma_f16 v251, v159, s53, v251
  v_mfma_f32_16x16x32_f16 v[28:31], v[132:135], a[100:103], v[28:31]
  s_waitcnt lgkmcnt(1)
  ds_read_b128 v[156:159], v12 offset:28672
  v_pk_fma_f16 v252, v160, s53, v252
  v_mfma_f32_16x16x32_f16 v[28:31], v[136:139], a[104:107], v[28:31]
  buffer_load_dwordx4 a[168:171], v14, s[28:31], s51 offen offset:3072 sc1
  v_mfma_f32_16x16x32_f16 v[28:31], v[140:143], a[108:111], v[28:31]
  s_waitcnt vmcnt(16)
  ds_read_b128 v[112:115], v11 offset:29248
  v_pk_fma_f16 v253, v161, s53, v253
  v_mfma_f32_16x16x32_f16 v[36:39], v[132:135], a[112:115], v[36:39]
  v_pk_fma_f16 v254, v162, s53, v254
  v_pk_fma_f16 v255, v163, s53, v255
  v_mfma_f32_16x16x32_f16 v[36:39], v[136:139], a[116:119], v[36:39]
  s_waitcnt lgkmcnt(1)
  ds_read_b128 v[160:163], v12 offset:29248
  v_pk_fma_f16 v108, v156, s53, v108
  v_mfma_f32_16x16x32_f16 v[36:39], v[140:143], a[120:123], v[36:39]
  s_waitcnt vmcnt(13)
  buffer_load_dwordx4 a[172:175], v10, s[28:31], s99 offen offset:3072 sc1
  v_mfma_f32_16x16x32_f16 v[44:47], v[132:135], a[124:127], v[44:47]
  ds_read_b128 v[116:119], v11 offset:29824
  v_pk_fma_f16 v109, v157, s53, v109
  v_mfma_f32_16x16x32_f16 v[44:47], v[136:139], a[128:131], v[44:47]
  v_pk_fma_f16 v110, v158, s53, v110
  v_pk_fma_f16 v111, v159, s53, v111
  v_mfma_f32_16x16x32_f16 v[44:47], v[140:143], a[132:135], v[44:47]
  s_waitcnt lgkmcnt(1)
  ds_read_b128 v[156:159], v12 offset:29824
  v_pk_fma_f16 v112, v160, s53, v112
  v_mfma_f32_16x16x32_f16 v[32:35], v[136:139], a[100:103], v[32:35]
  buffer_load_dwordx4 a[176:179], v13, s[28:31], s99 offen offset:3072 sc1
  v_mfma_f32_16x16x32_f16 v[32:35], v[140:143], a[104:107], v[32:35]
  ds_read_b128 v[120:123], v11 offset:30400
  v_pk_fma_f16 v113, v161, s53, v113
  v_mfma_f32_16x16x32_f16 v[32:35], v[144:147], a[108:111], v[32:35]
  v_pk_fma_f16 v114, v162, s53, v114
  v_pk_fma_f16 v115, v163, s53, v115
  v_mfma_f32_16x16x32_f16 v[40:43], v[136:139], a[112:115], v[40:43]
  s_waitcnt lgkmcnt(1)
  ds_read_b128 v[160:163], v12 offset:30400
  v_pk_fma_f16 v116, v156, s53, v116
  v_mfma_f32_16x16x32_f16 v[40:43], v[140:143], a[116:119], v[40:43]
  buffer_load_dwordx4 a[180:183], v14, s[28:31], s99 offen offset:3072 sc1
  v_mfma_f32_16x16x32_f16 v[40:43], v[144:147], a[120:123], v[40:43]
  s_add_u32 s19, s51, s18
  ds_read_b128 v[124:127], v11 offset:30976
  v_pk_fma_f16 v117, v157, s53, v117
  v_mfma_f32_16x16x32_f16 v[64:67], v[136:139], a[124:127], v[64:67]
  v_pk_fma_f16 v118, v158, s53, v118
  v_pk_fma_f16 v119, v159, s53, v119
  v_mfma_f32_16x16x32_f16 v[64:67], v[140:143], a[128:131], v[64:67]
  s_waitcnt vmcnt(12)
  ds_add_u32 v210, v209 offset:0
  ds_read_b128 v[156:159], v12 offset:30976
  v_mfma_f32_16x16x32_f16 v[64:67], v[144:147], a[132:135], v[64:67]
  buffer_load_dwordx4 a[184:187], v10, s[28:31], s19 offen offset:0 sc1
  v_mfma_f32_16x16x32_f16 v[48:51], v[140:143], a[100:103], v[48:51]
  s_waitcnt lgkmcnt(3)
  ds_read_b128 v[128:131], v11 offset:31552
  v_pk_fma_f16 v120, v160, s53, v120
  v_mfma_f32_16x16x32_f16 v[48:51], v[144:147], a[104:107], v[48:51]
  v_pk_fma_f16 v121, v161, s53, v121
  v_pk_fma_f16 v122, v162, s53, v122
  v_mfma_f32_16x16x32_f16 v[48:51], v[148:151], a[108:111], v[48:51]
  ds_read_b32 v211, v210 offset:0
  v_pk_fma_f16 v123, v163, s53, v123
  v_mfma_f32_16x16x32_f16 v[56:59], v[140:143], a[112:115], v[56:59]
  s_waitcnt lgkmcnt(2)
  ds_read_b128 v[160:163], v12 offset:31552
  v_pk_fma_f16 v124, v156, s53, v124
  v_mfma_f32_16x16x32_f16 v[56:59], v[144:147], a[116:119], v[56:59]
  ds_read_b128 v[224:227], v11 offset:32128
  v_pk_fma_f16 v125, v157, s53, v125
  v_mfma_f32_16x16x32_f16 v[56:59], v[148:151], a[120:123], v[56:59]
  v_pk_fma_f16 v126, v158, s53, v126
  v_pk_fma_f16 v127, v159, s53, v127
  v_mfma_f32_16x16x32_f16 v[84:87], v[140:143], a[124:127], v[84:87]
  s_waitcnt lgkmcnt(1)
  ds_read_b128 v[156:159], v12 offset:32128
  v_pk_fma_f16 v128, v160, s53, v128
  v_mfma_f32_16x16x32_f16 v[84:87], v[144:147], a[128:131], v[84:87]
  buffer_load_dwordx4 a[188:191], v13, s[28:31], s19 offen offset:0 sc1
  v_mfma_f32_16x16x32_f16 v[84:87], v[148:151], a[132:135], v[84:87]
  ds_read_b128 v[228:231], v11 offset:32704
  v_pk_fma_f16 v129, v161, s53, v129
  v_mfma_f32_16x16x32_f16 v[52:55], v[144:147], a[100:103], v[52:55]
  v_pk_fma_f16 v130, v162, s53, v130
  v_cmp_le_u32 vcc, 72, v211
  v_mfma_f32_16x16x32_f16 v[52:55], v[148:151], a[104:107], v[52:55]
  s_waitcnt lgkmcnt(1)
  v_pk_fma_f16 v131, v163, s53, v131
  v_pk_fma_f16 v224, v156, s53, v224
  v_mfma_f32_16x16x32_f16 v[52:55], v[152:155], a[108:111], v[52:55]
  s_cbranch_vccz L_sfail101
L_sok102:
  ds_read_b128 v[160:163], v12 offset:32704
  v_mfma_f32_16x16x32_f16 v[60:63], v[144:147], a[112:115], v[60:63]
  ds_read_b128 v[232:235], v11 offset:33280
  v_pk_fma_f16 v225, v157, s53, v225
  v_mfma_f32_16x16x32_f16 v[60:63], v[148:151], a[116:119], v[60:63]
  v_pk_fma_f16 v226, v158, s53, v226
  v_pk_fma_f16 v227, v159, s53, v227
  v_mfma_f32_16x16x32_f16 v[60:63], v[152:155], a[120:123], v[60:63]
  s_waitcnt lgkmcnt(1)
  ds_read_b128 v[156:159], v12 offset:33280
  v_pk_fma_f16 v228, v160, s53, v228
  v_mfma_f32_16x16x32_f16 v[104:107], v[144:147], a[124:127], v[104:107]
  buffer_load_dwordx4 a[192:195], v14, s[28:31], s19 offen offset:0 sc1
  v_mfma_f32_16x16x32_f16 v[104:107], v[148:151], a[128:131], v[104:107]
  s_add_u32 s19, s99, s18
  ds_read_b128 v[236:239], v11 offset:33856
  v_pk_fma_f16 v229, v161, s53, v229
  v_mfma_f32_16x16x32_f16 v[104:107], v[152:155], a[132:135], v[104:107]
  v_pk_fma_f16 v230, v162, s53, v230
  v_pk_fma_f16 v231, v163, s53, v231
  v_mfma_f32_16x16x32_f16 v[68:71], v[148:151], a[100:103], v[68:71]
  s_waitcnt lgkmcnt(1)
  ds_read_b128 v[160:163], v12 offset:33856
  v_pk_fma_f16 v232, v156, s53, v232
  v_mfma_f32_16x16x32_f16 v[68:71], v[152:155], a[104:107], v[68:71]
  buffer_load_dwordx4 a[196:199], v10, s[28:31], s19 offen offset:0 sc1
  v_mfma_f32_16x16x32_f16 v[68:71], v[240:243], a[108:111], v[68:71]
  ds_read_b128 v[132:135], v11 offset:34816
  v_pk_fma_f16 v233, v157, s53, v233
  v_mfma_f32_16x16x32_f16 v[76:79], v[148:151], a[112:115], v[76:79]
  v_pk_fma_f16 v234, v158, s53, v234
  v_pk_fma_f16 v235, v159, s53, v235
  v_mfma_f32_16x16x32_f16 v[76:79], v[152:155], a[116:119], v[76:79]
  s_waitcnt lgkmcnt(1)
  ds_read_b128 v[156:159], v12 offset:34816
  v_pk_fma_f16 v236, v160, s53, v236
  v_mfma_f32_16x16x32_f16 v[76:79], v[240:243], a[120:123], v[76:79]
  buffer_load_dwordx4 a[200:203], v13, s[28:31], s19 offen offset:0 sc1
  v_mfma_f32_16x16x32_f16 v[72:75], v[152:155], a[100:103], v[72:75]
  ds_read_b128 v[136:139], v11 offset:35392
  v_pk_fma_f16 v237, v161, s53, v237
  v_mfma_f32_16x16x32_f16 v[72:75], v[240:243], a[104:107], v[72:75]
  v_pk_fma_f16 v238, v162, s53, v238
  v_pk_fma_f16 v239, v163, s53, v239
  v_mfma_f32_16x16x32_f16 v[72:75], v[244:247], a[108:111], v[72:75]
  s_waitcnt lgkmcnt(1)
  ds_read_b128 v[160:163], v12 offset:35392
  v_pk_fma_f16 v132, v156, s53, v132
  v_mfma_f32_16x16x32_f16 v[80:83], v[152:155], a[112:115], v[80:83]
  buffer_load_dwordx4 a[204:207], v14, s[28:31], s19 offen offset:0 sc1
  v_mfma_f32_16x16x32_f16 v[80:83], v[240:243], a[116:119], v[80:83]
  ds_read_b128 v[140:143], v11 offset:35968
  v_pk_fma_f16 v133, v157, s53, v133
  v_mfma_f32_16x16x32_f16 v[80:83], v[244:247], a[120:123], v[80:83]
  v_pk_fma_f16 v134, v158, s53, v134
  v_pk_fma_f16 v135, v159, s53, v135
  v_mfma_f32_16x16x32_f16 v[88:91], v[240:243], a[100:103], v[88:91]
  s_waitcnt lgkmcnt(1)
  ds_read_b128 v[156:159], v12 offset:35968
  v_pk_fma_f16 v136, v160, s53, v136
  v_mfma_f32_16x16x32_f16 v[88:91], v[244:247], a[104:107], v[88:91]
  buffer_load_dwordx4 v[168:171], v17, s[32:35], s66 offen
  v_mfma_f32_16x16x32_f16 v[88:91], v[248:251], a[108:111], v[88:91]
  ds_read_b128 v[144:147], v11 offset:36544
  v_pk_fma_f16 v137, v161, s53, v137
  v_mfma_f32_16x16x32_f16 v[96:99], v[240:243], a[112:115], v[96:99]
  v_pk_fma_f16 v138, v162, s53, v138
  v_pk_fma_f16 v139, v163, s53, v139
  v_mfma_f32_16x16x32_f16 v[96:99], v[244:247], a[116:119], v[96:99]
  s_waitcnt lgkmcnt(1)
  ds_read_b128 v[160:163], v12 offset:36544
  v_pk_fma_f16 v140, v156, s53, v140
  v_mfma_f32_16x16x32_f16 v[96:99], v[248:251], a[120:123], v[96:99]
  buffer_load_dwordx4 v[172:175], v17, s[32:35], s67 offen
  v_mfma_f32_16x16x32_f16 v[92:95], v[244:247], a[100:103], v[92:95]
  ds_read_b128 v[148:151], v11 offset:37120
  v_pk_fma_f16 v141, v157, s53, v141
  v_mfma_f32_16x16x32_f16 v[92:95], v[248:251], a[104:107], v[92:95]
  v_pk_fma_f16 v142, v158, s53, v142
  v_pk_fma_f16 v143, v159, s53, v143
  v_mfma_f32_16x16x32_f16 v[92:95], v[252:255], a[108:111], v[92:95]
  s_waitcnt lgkmcnt(1)
  ds_read_b128 v[156:159], v12 offset:37120
  v_pk_fma_f16 v144, v160, s53, v144
  v_mfma_f32_16x16x32_f16 v[100:103], v[244:247], a[112:115], v[100:103]
  buffer_load_dwordx4 v[176:179], v17, s[32:35], s68 offen
  v_mfma_f32_16x16x32_f16 v[100:103], v[248:251], a[116:119], v[100:103]
  ds_read_b128 v[152:155], v11 offset:37696
  v_pk_fma_f16 v145, v161, s53, v145
  v_mfma_f32_16x16x32_f16 v[100:103], v[252:255], a[120:123], v[100:103]
  s_waitcnt vmcnt(18)
  v_pk_fma_f16 v146, v162, s53, v146
  v_pk_fma_f16 v147, v163, s53, v147
  v_mfma_f32_16x16x32_f16 v[28:31], v[108:111], a[136:139], v[28:31]
  s_waitcnt lgkmcnt(1)
  ds_read_b128 v[160:163], v12 offset:37696
  v_pk_fma_f16 v148, v156, s53, v148
  v_mfma_f32_16x16x32_f16 v[28:31], v[112:115], a[140:143], v[28:31]
  buffer_load_dwordx4 v[180:183], v17, s[32:35], s69 offen
  v_mfma_f32_16x16x32_f16 v[28:31], v[116:119], a[144:147], v[28:31]
  s_waitcnt vmcnt(16)
  ds_read_b128 v[240:243], v11 offset:38272
  v_pk_fma_f16 v149, v157, s53, v149
  v_mfma_f32_16x16x32_f16 v[28:31], v[132:135], a[148:151], v[28:31]
  v_pk_fma_f16 v150, v158, s53, v150
  v_pk_fma_f16 v151, v159, s53, v151
  v_mfma_f32_16x16x32_f16 v[28:31], v[136:139], a[152:155], v[28:31]
  s_waitcnt lgkmcnt(1)
  ds_read_b128 v[156:159], v12 offset:38272
  v_pk_fma_f16 v152, v160, s53, v152
  v_mfma_f32_16x16x32_f16 v[28:31], v[140:143], a[156:159], v[28:31]
  buffer_load_dwordx4 v[184:187], v17, s[32:35], s26 offen
  v_mfma_f32_16x16x32_f16 v[48:51], v[116:119], a[136:139], v[48:51]
  ds_read_b128 v[244:247], v11 offset:38848
  v_pk_fma_f16 v153, v161, s53, v153
  v_mfma_f32_16x16x32_f16 v[48:51], v[120:123], a[140:143], v[48:51]
  v_pk_fma_f16 v154, v162, s53, v154
  v_pk_fma_f16 v155, v163, s53, v155
  v_mfma_f32_16x16x32_f16 v[48:51], v[124:127], a[144:147], v[48:51]
  s_waitcnt lgkmcnt(1)
  ds_read_b128 v[160:163], v12 offset:38848
  v_pk_fma_f16 v240, v156, s53, v240
  v_mfma_f32_16x16x32_f16 v[48:51], v[140:143], a[148:151], v[48:51]
  v_pk_fma_f16 v241, v157, s53, v241
  v_pk_fma_f16 v242, v158, s53, v242
  v_mfma_f32_16x16x32_f16 v[48:51], v[144:147], a[152:155], v[48:51]
  v_pk_fma_f16 v243, v159, s53, v243
  v_mfma_f32_16x16x32_f16 v[48:51], v[148:151], a[156:159], v[48:51]
  s_waitcnt lgkmcnt(0)
  ds_read_b128 v[248:251], v11 offset:39424
  v_pk_fma_f16 v244, v160, s53, v244
  v_mfma_f32_16x16x32_f16 v[68:71], v[124:127], a[136:139], v[68:71]
  ds_read_b128 v[156:159], v12 offset:39424
  v_pk_fma_f16 v245, v161, s53, v245
  v_mfma_f32_16x16x32_f16 v[68:71], v[128:131], a[140:143], v[68:71]
  ds_write_b128 v167, v[28:31] offset:1536
  v_pk_fma_f16 v246, v162, s53, v246
  v_mfma_f32_16x16x32_f16 v[68:71], v[224:227], a[144:147], v[68:71]
  v_pk_fma_f16 v247, v163, s53, v247
  v_mfma_f32_16x16x32_f16 v[68:71], v[148:151], a[148:151], v[68:71]
  s_waitcnt lgkmcnt(1)
  v_pk_fma_f16 v248, v156, s53, v248
  v_pk_fma_f16 v249, v157, s53, v249
  v_mfma_f32_16x16x32_f16 v[68:71], v[152:155], a[152:155], v[68:71]
  v_pk_fma_f16 v250, v158, s53, v250
  v_pk_fma_f16 v251, v159, s53, v251
  v_mfma_f32_16x16x32_f16 v[68:71], v[240:243], a[156:159], v[68:71]
  ds_read_b128 v[252:255], v11 offset:40000
  v_mfma_f32_16x16x32_f16 v[88:91], v[224:227], a[136:139], v[88:91]
  ds_read_b128 v[160:163], v12 offset:40000
  v_mfma_f32_16x16x32_f16 v[88:91], v[228:231], a[140:143], v[88:91]
  ds_write_b128 v167, v[48:51] offset:6656
  v_mfma_f32_16x16x32_f16 v[88:91], v[232:235], a[144:147], v[88:91]
  v_mfma_f32_16x16x32_f16 v[88:91], v[240:243], a[148:151], v[88:91]
  s_waitcnt lgkmcnt(1)
  v_pk_fma_f16 v252, v160, s53, v252
  v_pk_fma_f16 v253, v161, s53, v253
  v_mfma_f32_16x16x32_f16 v[88:91], v[244:247], a[152:155], v[88:91]
  v_pk_fma_f16 v254, v162, s53, v254
  v_pk_fma_f16 v255, v163, s53, v255
  v_mfma_f32_16x16x32_f16 v[88:91], v[248:251], a[156:159], v[88:91]
  v_mfma_f32_16x16x32_f16 v[32:35], v[112:115], a[136:139], v[32:35]
  v_mfma_f32_16x16x32_f16 v[32:35], v[116:119], a[140:143], v[32:35]
  ds_write_b128 v167, v[68:71] offset:11776
  v_mfma_f32_16x16x32_f16 v[32:35], v[120:123], a[144:147], v[32:35]
  v_mfma_f32_16x16x32_f16 v[32:35], v[136:139], a[148:151], v[32:35]
  v_mfma_f32_16x16x32_f16 v[32:35], v[140:143], a[152:155], v[32:35]
  v_mfma_f32_16x16x32_f16 v[32:35], v[144:147], a[156:159], v[32:35]
  v_mfma_f32_16x16x32_f16 v[52:55], v[120:123], a[136:139], v[52:55]
  v_mfma_f32_16x16x32_f16 v[52:55], v[124:127], a[140:143], v[52:55]
  ds_write_b128 v167, v[88:91] offset:16896
  v_mfma_f32_16x16x32_f16 v[52:55], v[128:131], a[144:147], v[52:55]
  ds_add_u32 v210, v209 offset:256
  v_mfma_f32_16x16x32_f16 v[52:55], v[144:147], a[148:151], v[52:55]
  v_mfma_f32_16x16x32_f16 v[52:55], v[148:151], a[152:155], v[52:55]
  v_mfma_f32_16x16x32_f16 v[52:55], v[152:155], a[156:159], v[52:55]
  s_waitcnt vmcnt(4)
  v_lshlrev_b32 v188, 16, v168
  v_mfma_f32_16x16x32_f16 v[72:75], v[128:131], a[136:139], v[72:75]
  v_and_b32 v168, s23, v168
  v_mfma_f32_16x16x32_f16 v[72:75], v[224:227], a[140:143], v[72:75]
  ds_write_b128 v167, v[32:35] offset:2560
  v_lshlrev_b32 v189, 16, v169
  v_mfma_f32_16x16x32_f16 v[72:75], v[228:231], a[144:147], v[72:75]
  v_and_b32 v169, s23, v169
  v_mfma_f32_16x16x32_f16 v[72:75], v[152:155], a[148:151], v[72:75]
  v_lshlrev_b32 v190, 16, v170
  v_mfma_f32_16x16x32_f16 v[72:75], v[240:243], a[152:155], v[72:75]
  v_and_b32 v170, s23, v170
  v_mfma_f32_16x16x32_f16 v[72:75], v[244:247], a[156:159], v[72:75]
  v_lshlrev_b32 v191, 16, v171
  v_mfma_f32_16x16x32_f16 v[92:95], v[228:231], a[136:139], v[92:95]
  v_and_b32 v171, s23, v171
  v_mfma_f32_16x16x32_f16 v[92:95], v[232:235], a[140:143], v[92:95]
  s_waitcnt vmcnt(3)
  ds_write_b128 v167, v[52:55] offset:7680
  v_lshlrev_b32 v192, 16, v172
  v_mfma_f32_16x16x32_f16 v[92:95], v[236:239], a[144:147], v[92:95]
  ds_read_b32 v211, v210 offset:256
  v_mfma_f32_16x16x32_f16 v[92:95], v[244:247], a[148:151], v[92:95]
  ds_read_b128 v[28:31], v3 offset:1536
  v_mfma_f32_16x16x32_f16 v[92:95], v[248:251], a[152:155], v[92:95]
  ds_read_b128 v[48:51], v3 offset:42496
  v_mfma_f32_16x16x32_f16 v[92:95], v[252:255], a[156:159], v[92:95]
  ds_read_b128 v[68:71], v27 offset:1536
  v_mfma_f32_16x16x32_f16 v[36:39], v[108:111], a[160:163], v[36:39]
  ds_read_b128 v[88:91], v27 offset:42496
  v_mfma_f32_16x16x32_f16 v[36:39], v[112:115], a[164:167], v[36:39]
  ds_write_b128 v167, v[72:75] offset:12800
  v_and_b32 v172, s23, v172
  v_mfma_f32_16x16x32_f16 v[36:39], v[116:119], a[168:171], v[36:39]
  v_lshlrev_b32 v193, 16, v173
  v_mfma_f32_16x16x32_f16 v[36:39], v[132:135], a[172:175], v[36:39]
  v_and_b32 v173, s23, v173
  v_mfma_f32_16x16x32_f16 v[36:39], v[136:139], a[176:179], v[36:39]
  s_waitcnt lgkmcnt(5)
  v_cmp_le_u32 vcc, 8, v211
  v_mfma_f32_16x16x32_f16 v[36:39], v[140:143], a[180:183], v[36:39]
  v_lshlrev_b32 v194, 16, v174
  v_mfma_f32_16x16x32_f16 v[56:59], v[116:119], a[160:163], v[56:59]
  v_and_b32 v174, s23, v174
  v_mfma_f32_16x16x32_f16 v[56:59], v[120:123], a[164:167], v[56:59]
  s_waitcnt lgkmcnt(1)
  s_cbranch_vccz L_sfail104
L_sok105:
  ds_write_b128 v167, v[92:95] offset:17920
  v_mfma_f32_16x16x32_f16 v[56:59], v[124:127], a[168:171], v[56:59]
  ds_add_u32 v210, v209 offset:512
  v_lshlrev_b32 v195, 16, v175
  v_mfma_f32_16x16x32_f16 v[56:59], v[140:143], a[172:175], v[56:59]
  v_and_b32 v175, s23, v175
  v_add_f32 v28, v28, v48
  v_mfma_f32_16x16x32_f16 v[56:59], v[144:147], a[176:179], v[56:59]
  s_waitcnt vmcnt(2)
  v_lshlrev_b32 v196, 16, v176
  v_sub_f32 v88, v48, v88
  v_mfma_f32_16x16x32_f16 v[56:59], v[148:151], a[180:183], v[56:59]
  v_and_b32 v176, s23, v176
  v_add_f32 v29, v29, v49
  v_mfma_f32_16x16x32_f16 v[76:79], v[124:127], a[160:163], v[76:79]
  v_lshlrev_b32 v197, 16, v177
  v_sub_f32 v89, v49, v89
  v_mfma_f32_16x16x32_f16 v[76:79], v[128:131], a[164:167], v[76:79]
  ds_write_b128 v167, v[36:39] offset:3584
  v_and_b32 v177, s23, v177
  v_mfma_f32_16x16x32_f16 v[76:79], v[224:227], a[168:171], v[76:79]
  v_lshlrev_b32 v198, 16, v178
  v_add_f32 v30, v30, v50
  v_mfma_f32_16x16x32_f16 v[76:79], v[148:151], a[172:175], v[76:79]
  v_and_b32 v178, s23, v178
  v_sub_f32 v90, v50, v90
  v_mfma_f32_16x16x32_f16 v[76:79], v[152:155], a[176:179], v[76:79]
  v_lshlrev_b32 v199, 16, v179
  v_add_f32 v31, v31, v51
  v_mfma_f32_16x16x32_f16 v[76:79], v[240:243], a[180:183], v[76:79]
  v_and_b32 v179, s23, v179
  v_sub_f32 v91, v51, v91
  v_mfma_f32_16x16x32_f16 v[96:99], v[224:227], a[160:163], v[96:99]
  s_waitcnt vmcnt(1)
  v_lshlrev_b32 v200, 16, v180
  v_add_f32 v28, v28, v68
  v_mfma_f32_16x16x32_f16 v[96:99], v[228:231], a[164:167], v[96:99]
  ds_write_b128 v167, v[56:59] offset:8704
  v_and_b32 v180, s23, v180
  v_mfma_f32_16x16x32_f16 v[96:99], v[232:235], a[168:171], v[96:99]
  ds_read_b32 v211, v210 offset:512
  v_sub_f32 v88, v88, v68
  v_mfma_f32_16x16x32_f16 v[96:99], v[240:243], a[172:175], v[96:99]
  ds_read_b128 v[32:35], v3 offset:2560
  v_add_f32 v29, v29, v69
  v_mfma_f32_16x16x32_f16 v[96:99], v[244:247], a[176:179], v[96:99]
  ds_read_b128 v[52:55], v3 offset:43520
  v_sub_f32 v89, v89, v69
  v_mfma_f32_16x16x32_f16 v[96:99], v[248:251], a[180:183], v[96:99]
  ds_read_b128 v[72:75], v27 offset:2560
  v_add_f32 v30, v30, v70
  v_mfma_f32_16x16x32_f16 v[40:43], v[112:115], a[160:163], v[40:43]
  ds_read_b128 v[92:95], v27 offset:43520
  v_sub_f32 v90, v90, v70
  v_mfma_f32_16x16x32_f16 v[40:43], v[116:119], a[164:167], v[40:43]
  ds_write_b128 v167, v[76:79] offset:13824
  v_lshlrev_b32 v201, 16, v181
  v_mfma_f32_16x16x32_f16 v[40:43], v[120:123], a[168:171], v[40:43]
  v_and_b32 v181, s23, v181
  v_add_f32 v31, v31, v71
  v_mfma_f32_16x16x32_f16 v[40:43], v[136:139], a[172:175], v[40:43]
  v_lshlrev_b32 v202, 16, v182
  v_sub_f32 v91, v91, v71
  v_mfma_f32_16x16x32_f16 v[40:43], v[140:143], a[176:179], v[40:43]
  s_waitcnt lgkmcnt(5)
  v_cmp_le_u32 vcc, 8, v211
  v_fmac_f32 v188, s24, v28
  v_mfma_f32_16x16x32_f16 v[40:43], v[144:147], a[180:183], v[40:43]
  v_and_b32 v182, s23, v182
  v_fmac_f32 v189, s24, v29
  v_mfma_f32_16x16x32_f16 v[60:63], v[120:123], a[160:163], v[60:63]
  v_lshlrev_b32 v203, 16, v183
  v_fmac_f32 v190, s24, v30
  v_mfma_f32_16x16x32_f16 v[60:63], v[124:127], a[164:167], v[60:63]
  s_waitcnt lgkmcnt(1)
  s_cbranch_vccz L_sfail107
L_sok108:
  ds_write_b128 v167, v[96:99] offset:18944
  v_mfma_f32_16x16x32_f16 v[60:63], v[128:131], a[168:171], v[60:63]
  ds_add_u32 v210, v209 offset:768
  v_and_b32 v183, s23, v183
  v_mfma_f32_16x16x32_f16 v[60:63], v[144:147], a[172:175], v[60:63]
  s_waitcnt vmcnt(0)
  v_lshlrev_b32 v204, 16, v184
  v_fmac_f32 v191, s24, v31
  v_mfma_f32_16x16x32_f16 v[60:63], v[148:151], a[176:179], v[60:63]
  v_and_b32 v184, s23, v184
  v_fmac_f32 v168, s24, v88
  v_mfma_f32_16x16x32_f16 v[60:63], v[152:155], a[180:183], v[60:63]
  v_lshlrev_b32 v205, 16, v185
  v_fmac_f32 v169, s24, v89
  v_mfma_f32_16x16x32_f16 v[80:83], v[128:131], a[160:163], v[80:83]
  v_and_b32 v185, s23, v185
  v_fmac_f32 v170, s24, v90
  v_mfma_f32_16x16x32_f16 v[80:83], v[224:227], a[164:167], v[80:83]
  ds_write_b128 v167, v[40:43] offset:4608
  v_lshlrev_b32 v206, 16, v186
  v_mfma_f32_16x16x32_f16 v[80:83], v[228:231], a[168:171], v[80:83]
  v_and_b32 v186, s23, v186
  v_fmac_f32 v171, s24, v91
  v_mfma_f32_16x16x32_f16 v[80:83], v[152:155], a[172:175], v[80:83]
  v_lshlrev_b32 v207, 16, v187
  v_cvt_pk_bf16_f32 v188, v188, v168
  v_mfma_f32_16x16x32_f16 v[80:83], v[240:243], a[176:179], v[80:83]
  v_and_b32 v187, s23, v187
  v_cvt_pk_bf16_f32 v189, v189, v169
  v_mfma_f32_16x16x32_f16 v[80:83], v[244:247], a[180:183], v[80:83]
  v_cvt_pk_bf16_f32 v190, v190, v170
  v_cvt_pk_bf16_f32 v191, v191, v171
  v_mfma_f32_16x16x32_f16 v[100:103], v[228:231], a[160:163], v[100:103]
  buffer_store_dwordx4 v[188:191], v17, s[36:39], s66 offen sc1
  v_mfma_f32_16x16x32_f16 v[100:103], v[232:235], a[164:167], v[100:103]
  ds_write_b128 v167, v[60:63] offset:9728
  v_mfma_f32_16x16x32_f16 v[100:103], v[236:239], a[168:171], v[100:103]
  ds_read_b32 v211, v210 offset:768
  v_add_f32 v32, v32, v52
  v_mfma_f32_16x16x32_f16 v[100:103], v[244:247], a[172:175], v[100:103]
  ds_read_b128 v[36:39], v3 offset:3584
  v_sub_f32 v92, v52, v92
  v_mfma_f32_16x16x32_f16 v[100:103], v[248:251], a[176:179], v[100:103]
  ds_read_b128 v[56:59], v3 offset:44544
  v_add_f32 v33, v33, v53
  v_mfma_f32_16x16x32_f16 v[100:103], v[252:255], a[180:183], v[100:103]
  ds_read_b128 v[76:79], v27 offset:3584
  v_sub_f32 v93, v53, v93
  v_mfma_f32_16x16x32_f16 v[44:47], v[108:111], a[184:187], v[44:47]
  ds_read_b128 v[96:99], v27 offset:44544
  v_add_f32 v34, v34, v54
  v_mfma_f32_16x16x32_f16 v[44:47], v[112:115], a[188:191], v[44:47]
  ds_write_b128 v167, v[80:83] offset:14848
  v_mfma_f32_16x16x32_f16 v[44:47], v[116:119], a[192:195], v[44:47]
  v_sub_f32 v94, v54, v94
  v_add_f32 v35, v35, v55
  v_mfma_f32_16x16x32_f16 v[44:47], v[132:135], a[196:199], v[44:47]
  v_sub_f32 v95, v55, v95
  v_add_f32 v32, v32, v72
  v_mfma_f32_16x16x32_f16 v[44:47], v[136:139], a[200:203], v[44:47]
  s_waitcnt lgkmcnt(5)
  v_cmp_le_u32 vcc, 8, v211
  v_sub_f32 v92, v92, v72
  v_mfma_f32_16x16x32_f16 v[44:47], v[140:143], a[204:207], v[44:47]
  v_add_f32 v33, v33, v73
  v_sub_f32 v93, v93, v73
  v_mfma_f32_16x16x32_f16 v[64:67], v[112:115], a[184:187], v[64:67]
  v_add_f32 v34, v34, v74
  v_sub_f32 v94, v94, v74
  v_mfma_f32_16x16x32_f16 v[64:67], v[116:119], a[188:191], v[64:67]
  s_waitcnt lgkmcnt(1)
  s_cbranch_vccz L_sfail110
L_sok111:
  ds_write_b128 v167, v[100:103] offset:19968
  v_mfma_f32_16x16x32_f16 v[64:67], v[120:123], a[192:195], v[64:67]
  ds_add_u32 v210, v209 offset:1024
  v_add_f32 v35, v35, v75
  v_mfma_f32_16x16x32_f16 v[64:67], v[136:139], a[196:199], v[64:67]
  v_sub_f32 v95, v95, v75
  v_fmac_f32 v192, s24, v32
  v_mfma_f32_16x16x32_f16 v[64:67], v[140:143], a[200:203], v[64:67]
  v_fmac_f32 v193, s24, v33
  v_fmac_f32 v194, s24, v34
  v_mfma_f32_16x16x32_f16 v[64:67], v[144:147], a[204:207], v[64:67]
  v_fmac_f32 v195, s24, v35
  v_fmac_f32 v172, s24, v92
  v_mfma_f32_16x16x32_f16 v[84:87], v[116:119], a[184:187], v[84:87]
  v_fmac_f32 v173, s24, v93
  v_fmac_f32 v174, s24, v94
  v_mfma_f32_16x16x32_f16 v[84:87], v[120:123], a[188:191], v[84:87]
  ds_write_b128 v167, v[44:47] offset:5632
  v_mfma_f32_16x16x32_f16 v[84:87], v[124:127], a[192:195], v[84:87]
  v_fmac_f32 v175, s24, v95
  v_cvt_pk_bf16_f32 v192, v192, v172
  v_mfma_f32_16x16x32_f16 v[84:87], v[140:143], a[196:199], v[84:87]
  v_cvt_pk_bf16_f32 v193, v193, v173
  v_cvt_pk_bf16_f32 v194, v194, v174
  v_mfma_f32_16x16x32_f16 v[84:87], v[144:147], a[200:203], v[84:87]
  v_cvt_pk_bf16_f32 v195, v195, v175
  v_mfma_f32_16x16x32_f16 v[84:87], v[148:151], a[204:207], v[84:87]
  buffer_store_dwordx4 v[192:195], v17, s[36:39], s67 offen sc1
  v_mfma_f32_16x16x32_f16 v[104:107], v[120:123], a[184:187], v[104:107]
  v_mfma_f32_16x16x32_f16 v[104:107], v[124:127], a[188:191], v[104:107]
  ds_write_b128 v167, v[64:67] offset:10752
  v_mfma_f32_16x16x32_f16 v[104:107], v[128:131], a[192:195], v[104:107]
  v_mfma_f32_16x16x32_f16 v[104:107], v[144:147], a[196:199], v[104:107]
  v_mfma_f32_16x16x32_f16 v[104:107], v[148:151], a[200:203], v[104:107]
  v_mfma_f32_16x16x32_f16 v[104:107], v[152:155], a[204:207], v[104:107]
  s_nop 1
  ds_write_b128 v167, v[84:87] offset:15872
  ds_read_b32 v211, v210 offset:1024
  ds_read_b128 v[40:43], v3 offset:4608
  ds_read_b128 v[60:63], v3 offset:45568
  ds_read_b128 v[80:83], v27 offset:4608
  ds_read_b128 v[100:103], v27 offset:45568
  ds_write_b128 v167, v[104:107] offset:20992
  ds_add_u32 v210, v209 offset:1280
  s_waitcnt lgkmcnt(6)
  v_cmp_le_u32 vcc, 8, v211
  s_cbranch_vccz L_sfail113
L_sok114:
L_qg3:
  s_cbranch_execz L_qgback
  v_pk_add_f32 v[36:37], v[36:37], v[56:57]
  v_pk_add_f32 v[96:97], v[56:57], v[96:97] neg_lo:[0,1] neg_hi:[0,1]
  v_pk_add_f32 v[36:37], v[36:37], v[76:77]
  v_pk_add_f32 v[96:97], v[96:97], v[76:77] neg_lo:[0,1] neg_hi:[0,1]
  v_pk_add_f32 v[38:39], v[38:39], v[58:59]
  v_pk_add_f32 v[98:99], v[58:59], v[98:99] neg_lo:[0,1] neg_hi:[0,1]
  v_pk_add_f32 v[38:39], v[38:39], v[78:79]
  v_pk_add_f32 v[98:99], v[98:99], v[78:79] neg_lo:[0,1] neg_hi:[0,1]
  v_pk_fma_f32 v[196:197], v[36:37], s[24:25], v[196:197] op_sel_hi:[1,0,1]
  v_pk_fma_f32 v[176:177], v[96:97], s[24:25], v[176:177] op_sel_hi:[1,0,1]
  v_pk_fma_f32 v[198:199], v[38:39], s[24:25], v[198:199] op_sel_hi:[1,0,1]
  v_pk_fma_f32 v[178:179], v[98:99], s[24:25], v[178:179] op_sel_hi:[1,0,1]
  v_cvt_pk_bf16_f32 v196, v196, v176
  v_cvt_pk_bf16_f32 v197, v197, v177
  v_cvt_pk_bf16_f32 v198, v198, v178
  v_cvt_pk_bf16_f32 v199, v199, v179
  buffer_store_dwordx4 v[196:199], v17, s[36:39], s68 offen sc1
  ds_read_b32 v211, v210 offset:1280
  ds_read_b128 v[44:47], v3 offset:5632
  ds_read_b128 v[64:67], v3 offset:46592
  ds_read_b128 v[84:87], v27 offset:5632
  ds_read_b128 v[104:107], v27 offset:46592
  s_waitcnt lgkmcnt(7)
  v_pk_add_f32 v[40:41], v[40:41], v[60:61]
  v_pk_add_f32 v[100:101], v[60:61], v[100:101] neg_lo:[0,1] neg_hi:[0,1]
  v_pk_add_f32 v[40:41], v[40:41], v[80:81]
  v_pk_add_f32 v[100:101], v[100:101], v[80:81] neg_lo:[0,1] neg_hi:[0,1]
  v_pk_add_f32 v[42:43], v[42:43], v[62:63]
  v_pk_add_f32 v[102:103], v[62:63], v[102:103] neg_lo:[0,1] neg_hi:[0,1]
  v_pk_add_f32 v[42:43], v[42:43], v[82:83]
  v_pk_add_f32 v[102:103], v[102:103], v[82:83] neg_lo:[0,1] neg_hi:[0,1]
  v_pk_fma_f32 v[200:201], v[40:41], s[24:25], v[200:201] op_sel_hi:[1,0,1]
  v_pk_fma_f32 v[180:181], v[100:101], s[24:25], v[180:181] op_sel_hi:[1,0,1]
  v_pk_fma_f32 v[202:203], v[42:43], s[24:25], v[202:203] op_sel_hi:[1,0,1]
  v_pk_fma_f32 v[182:183], v[102:103], s[24:25], v[182:183] op_sel_hi:[1,0,1]
  v_cvt_pk_bf16_f32 v200, v200, v180
  v_cvt_pk_bf16_f32 v201, v201, v181
  v_cvt_pk_bf16_f32 v202, v202, v182
  v_cvt_pk_bf16_f32 v203, v203, v183
  buffer_store_dwordx4 v[200:203], v17, s[36:39], s69 offen sc1
  s_waitcnt lgkmcnt(4)
  v_cmp_le_u32 vcc, 8, v211
  s_cbranch_vccz L_sfail116
L_sok117:
  s_waitcnt lgkmcnt(0)
  v_pk_add_f32 v[44:45], v[44:45], v[64:65]
  v_pk_add_f32 v[104:105], v[64:65], v[104:105] neg_lo:[0,1] neg_hi:[0,1]
  v_pk_add_f32 v[44:45], v[44:45], v[84:85]
  v_pk_add_f32 v[104:105], v[104:105], v[84:85] neg_lo:[0,1] neg_hi:[0,1]
  v_pk_add_f32 v[46:47], v[46:47], v[66:67]
  v_pk_add_f32 v[106:107], v[66:67], v[106:107] neg_lo:[0,1] neg_hi:[0,1]
  v_pk_add_f32 v[46:47], v[46:47], v[86:87]
  v_pk_add_f32 v[106:107], v[106:107], v[86:87] neg_lo:[0,1] neg_hi:[0,1]
  v_pk_fma_f32 v[204:205], v[44:45], s[24:25], v[204:205] op_sel_hi:[1,0,1]
  v_pk_fma_f32 v[184:185], v[104:105], s[24:25], v[184:185] op_sel_hi:[1,0,1]
  v_pk_fma_f32 v[206:207], v[46:47], s[24:25], v[206:207] op_sel_hi:[1,0,1]
  v_pk_fma_f32 v[186:187], v[106:107], s[24:25], v[186:187] op_sel_hi:[1,0,1]
  v_cvt_pk_bf16_f32 v204, v204, v184
  v_cvt_pk_bf16_f32 v205, v205, v185
  v_cvt_pk_bf16_f32 v206, v206, v186
  v_cvt_pk_bf16_f32 v207, v207, v187
  buffer_store_dwordx4 v[204:207], v17, s[36:39], s26 offen
L_fin:
L_exit:
  s_endpgm
L_tl_emb:
  s_lshl1_add_u32 s65, s46, s45
  s_mul_i32 s65, s65, 5
  s_lshr_b32 s66, s3, 1
  s_add_u32 s65, s65, s66
  s_sub_u32 s5, s65, 25
  s_mul_i32 s66, s44, 61440
  s_lshl4_add_u32 s66, s5, s66
  s_cmp_lt_u32 s3, 60
  s_cselect_b32 s67, 48, 0
  v_cmp_gt_u32 vcc, s67, v1
  v_mul_u32_u24 v246, 1280, v1
  v_add_u32 v246, s66, v246
  v_bfrev_b32 v247, 1
  v_cndmask_b32 v213, v247, v246, vcc
  s_mul_i32 s66, s44, 192
  v_min_u32 v246, 47, v1
  v_lshl_add_u32 v246, v246, 2, s66
  s_mov_b64 s[40:41], s[6:7]
  s_mov_b32 s42, 1536
  buffer_load_dword v208, v246, s[40:43], 0 offen offset:0
  buffer_load_dword v209, v246, s[40:43], 0 offen offset:768
  s_mov_b64 s[40:41], s[14:15]
  s_mov_b32 s42, 245760
  s_bitcmp1_b32 s3, 1
  s_cselect_b32 s9, 640, 0
  buffer_load_dwordx4 v[200:203], v213, s[40:43], s9 offen
  s_branch L_tl_done
L_emb0:
  s_cmp_lt_u32 s3, 60
  s_cbranch_scc1 L_emb1
  s_branch L_noemb0
L_emb1:
  s_lshr_b32 s68, s9, 5
  s_and_b32 s68, s68, 16
  v_alignbit_b32 v208, v208, v208, s68
  v_alignbit_b32 v209, v209, v209, s68
  v_lshlrev_b32 v28, 16, v208
  v_and_b32 v29, s23, v208
  v_lshlrev_b32 v30, 16, v209
  v_and_b32 v31, s23, v209
  v_mul_f32 v32, 0xbfb8aa3b, v28
  v_mul_f32 v33, 0xbfb8aa3b, v29
  v_mul_f32 v34, 0xbfb8aa3b, v30
  v_mul_f32 v35, 0xbfb8aa3b, v31
  v_exp_f32 v32, v32
  v_exp_f32 v33, v33
  v_exp_f32 v34, v34
  v_exp_f32 v35, v35
  v_add_f32 v32, 1.0, v32
  v_add_f32 v33, 1.0, v33
  v_add_f32 v34, 1.0, v34
  v_add_f32 v35, 1.0, v35
  v_rcp_f32 v32, v32
  v_rcp_f32 v33, v33
  v_rcp_f32 v34, v34
  v_rcp_f32 v35, v35
  v_lshlrev_b32 v36, 16, v200
  v_and_b32 v37, s23, v200
  v_lshlrev_b32 v38, 16, v201
  v_and_b32 v39, s23, v201
  v_lshlrev_b32 v40, 16, v202
  v_and_b32 v41, s23, v202
  v_lshlrev_b32 v42, 16, v203
  v_and_b32 v43, s23, v203
  v_lshlrev_b32 v44, 16, v204
  v_and_b32 v45, s23, v204
  v_lshlrev_b32 v46, 16, v205
  v_and_b32 v47, s23, v205
  v_lshlrev_b32 v48, 16, v206
  v_and_b32 v49, s23, v206
  v_lshlrev_b32 v50, 16, v207
  v_and_b32 v51, s23, v207
  v_mul_f32 v28, v28, v32
  v_mul_f32 v29, v29, v33
  v_mul_f32 v30, v30, v34
  v_mul_f32 v31, v31, v35
  v_pk_mul_f32 v[52:53], v[36:37], v[28:29] op_sel_hi:[1,0]
  v_pk_fma_f32 v[52:53], v[44:45], v[28:29], v[52:53] op_sel:[0,1,0] op_sel_hi:[1,1,1]
  v_pk_mul_f32 v[54:55], v[38:39], v[28:29] op_sel_hi:[1,0]
  v_pk_fma_f32 v[54:55], v[46:47], v[28:29], v[54:55] op_sel:[0,1,0] op_sel_hi:[1,1,1]
  v_pk_mul_f32 v[56:57], v[40:41], v[28:29] op_sel_hi:[1,0]
  v_pk_fma_f32 v[56:57], v[48:49], v[28:29], v[56:57] op_sel:[0,1,0] op_sel_hi:[1,1,1]
  v_pk_mul_f32 v[58:59], v[42:43], v[28:29] op_sel_hi:[1,0]
  v_pk_fma_f32 v[58:59], v[50:51], v[28:29], v[58:59] op_sel:[0,1,0] op_sel_hi:[1,1,1]
  v_pk_mul_f32 v[60:61], v[36:37], v[30:31] op_sel_hi:[1,0]
  v_pk_fma_f32 v[60:61], v[44:45], v[30:31], v[60:61] op_sel:[0,1,0] op_sel_hi:[1,1,1]
  v_pk_mul_f32 v[62:63], v[38:39], v[30:31] op_sel_hi:[1,0]
  v_pk_fma_f32 v[62:63], v[46:47], v[30:31], v[62:63] op_sel:[0,1,0] op_sel_hi:[1,1,1]
  v_pk_mul_f32 v[64:65], v[40:41], v[30:31] op_sel_hi:[1,0]
  v_pk_fma_f32 v[64:65], v[48:49], v[30:31], v[64:65] op_sel:[0,1,0] op_sel_hi:[1,1,1]
  v_pk_mul_f32 v[66:67], v[42:43], v[30:31] op_sel_hi:[1,0]
  v_pk_fma_f32 v[66:67], v[50:51], v[30:31], v[66:67] op_sel:[0,1,0] op_sel_hi:[1,1,1]
  s_nop 1
  v_permlane32_swap_b32 v52, v60
  v_permlane32_swap_b32 v53, v61
  v_permlane32_swap_b32 v54, v62
  v_permlane32_swap_b32 v55, v63
  v_permlane32_swap_b32 v56, v64
  v_permlane32_swap_b32 v57, v65
  v_permlane32_swap_b32 v58, v66
  v_permlane32_swap_b32 v59, v67
  v_add_f32 v52, v52, v60
  v_add_f32 v53, v53, v61
  v_add_f32 v54, v54, v62
  v_add_f32 v55, v55, v63
  v_add_f32 v56, v56, v64
  v_add_f32 v57, v57, v65
  v_add_f32 v58, v58, v66
  v_add_f32 v59, v59, v67
  s_nop 1
  v_permlane16_swap_b32 v52, v56
  v_permlane16_swap_b32 v53, v57
  v_permlane16_swap_b32 v54, v58
  v_permlane16_swap_b32 v55, v59
  v_add_f32 v52, v52, v56
  v_add_f32 v53, v53, v57
  v_add_f32 v54, v54, v58
  v_add_f32 v55, v55, v59
  v_add_f32_dpp v52, v52, v52 quad_perm:[1,0,3,2] row_mask:0xf bank_mask:0xf
  v_add_f32_dpp v53, v53, v53 quad_perm:[1,0,3,2] row_mask:0xf bank_mask:0xf
  v_add_f32_dpp v54, v54, v54 quad_perm:[1,0,3,2] row_mask:0xf bank_mask:0xf
  v_add_f32_dpp v55, v55, v55 quad_perm:[1,0,3,2] row_mask:0xf bank_mask:0xf
  v_add_f32_dpp v52, v52, v52 quad_perm:[2,3,0,1] row_mask:0xf bank_mask:0xf
  v_add_f32_dpp v53, v53, v53 quad_perm:[2,3,0,1] row_mask:0xf bank_mask:0xf
  v_add_f32_dpp v54, v54, v54 quad_perm:[2,3,0,1] row_mask:0xf bank_mask:0xf
  v_add_f32_dpp v55, v55, v55 quad_perm:[2,3,0,1] row_mask:0xf bank_mask:0xf
  v_add_f32_dpp v52, v52, v52 row_half_mirror row_mask:0xf bank_mask:0xf
  v_add_f32_dpp v53, v53, v53 row_half_mirror row_mask:0xf bank_mask:0xf
  v_add_f32_dpp v54, v54, v54 row_half_mirror row_mask:0xf bank_mask:0xf
  v_add_f32_dpp v55, v55, v55 row_half_mirror row_mask:0xf bank_mask:0xf
  v_add_f32_dpp v52, v52, v52 row_mirror row_mask:0xf bank_mask:0xf
  v_add_f32_dpp v53, v53, v53 row_mirror row_mask:0xf bank_mask:0xf
  v_add_f32_dpp v54, v54, v54 row_mirror row_mask:0xf bank_mask:0xf
  v_add_f32_dpp v55, v55, v55 row_mirror row_mask:0xf bank_mask:0xf
  s_lshl_b32 s68, s44, 6
  v_add_u32 v32, s68, v19
  ds_write_b128 v32, v[52:55] offset:1792
  s_waitcnt lgkmcnt(0)
  s_barrier
  ds_read_b128 v[52:55], v19 offset:1792
  ds_read_b128 v[56:59], v19 offset:1856
  ds_read_b128 v[60:63], v19 offset:1920
  ds_read_b128 v[64:67], v19 offset:1984
  v_lshrrev_b32 v32, 5, v1
  v_mul_u32_u24 v32, 1248, v32
  s_lshl_b32 s68, s5, 5
  s_cmp_lg_u32 s44, 0
  s_cmov_b32 s68, s25
  v_add3_u32 v213, v32, v19, s68
  s_waitcnt lgkmcnt(0)
  v_pk_add_f32 v[52:53], v[52:53], v[56:57]
  v_pk_add_f32 v[60:61], v[60:61], v[64:65]
  v_pk_add_f32 v[54:55], v[54:55], v[58:59]
  v_pk_add_f32 v[62:63], v[62:63], v[66:67]
  v_pk_add_f32 v[52:53], v[52:53], v[60:61]
  v_pk_add_f32 v[54:55], v[54:55], v[62:63]
  s_branch L_noemb0
L_pfail17:
  s_mov_b64 exec, vcc
  s_mov_b32 s55, 65536
L_poll14:
  buffer_load_dword v26, v18, s[28:31], s97 offen sc1
  s_waitcnt vmcnt(0)
  v_cmp_ne_u32 vcc, s49, v26
  s_cbranch_vccz L_prest16
  s_mov_b64 exec, vcc
  s_sub_u32 s55, s55, 1
  s_cbranch_scc0 L_poll14
L_prest16:
  s_mov_b64 exec, -1
  s_branch L_pdone15
L_pfail21:
  s_mov_b64 exec, vcc
  s_mov_b32 s55, 65536
L_poll18:
  buffer_load_dword v21, v164, s[28:31], s66 offen sc1
  s_waitcnt vmcnt(0)
  v_subrev_u32 v21, s49, v21
  v_cmp_lt_u32 vcc, 1, v21
  s_cbranch_vccz L_prest20
  s_mov_b64 exec, vcc
  s_sub_u32 s55, s55, 1
  s_cbranch_scc0 L_poll18
L_prest20:
  s_mov_b64 exec, -1
  s_branch L_pdone19
L_sfail22:
  s_mov_b32 s55, 65536
L_sfail22a:
  ds_read_b32 v211, v210 offset:0
  s_waitcnt lgkmcnt(0)
  v_cmp_le_u32 vcc, 4, v211
  s_cbranch_vccnz L_sok23
  s_sub_u32 s55, s55, 1
  s_cbranch_scc0 L_sfail22a
L_sgo24:
  s_branch L_sok23
L_sfail25:
  s_mov_b32 s55, 65536
L_sfail25a:
  ds_read_b32 v211, v210 offset:0
  s_waitcnt lgkmcnt(0)
  v_cmp_le_u32 vcc, 8, v211
  s_cbranch_vccnz L_sok26
  s_sub_u32 s55, s55, 1
  s_cbranch_scc0 L_sfail25a
L_sgo27:
  s_branch L_sok26
L_sfail28:
  s_mov_b32 s55, 65536
L_sfail28a:
  ds_read_b32 v211, v210 offset:0
  s_waitcnt lgkmcnt(0)
  v_cmp_le_u32 vcc, 12, v211
  s_cbranch_vccnz L_sok29
  s_sub_u32 s55, s55, 1
  s_cbranch_scc0 L_sfail28a
L_sgo30:
  s_branch L_sok29
L_sfail31:
  s_mov_b32 s55, 65536
L_sfail31a:
  ds_read_b32 v211, v210 offset:0
  s_waitcnt lgkmcnt(0)
  v_cmp_le_u32 vcc, 16, v211
  s_cbranch_vccnz L_sok32
  s_sub_u32 s55, s55, 1
  s_cbranch_scc0 L_sfail31a
L_sgo33:
  s_branch L_sok32
L_sfail34:
  s_mov_b32 s55, 65536
L_sfail34a:
  ds_read_b32 v211, v210 offset:0
  s_waitcnt lgkmcnt(0)
  v_cmp_le_u32 vcc, 20, v211
  s_cbranch_vccnz L_sok35
  s_sub_u32 s55, s55, 1
  s_cbranch_scc0 L_sfail34a
L_sgo36:
  s_branch L_sok35
L_sfail37:
  s_mov_b32 s55, 65536
L_sfail37a:
  ds_read_b32 v211, v210 offset:0
  s_waitcnt lgkmcnt(0)
  v_cmp_le_u32 vcc, 24, v211
  s_cbranch_vccnz L_sok38
  s_sub_u32 s55, s55, 1
  s_cbranch_scc0 L_sfail37a
L_sgo39:
  s_branch L_sok38
L_sfail40:
  s_mov_b32 s55, 65536
L_sfail40a:
  ds_read_b32 v211, v210 offset:0
  s_waitcnt lgkmcnt(0)
  v_cmp_le_u32 vcc, 28, v211
  s_cbranch_vccnz L_sok41
  s_sub_u32 s55, s55, 1
  s_cbranch_scc0 L_sfail40a
L_sgo42:
  s_branch L_sok41
L_sfail43:
  s_mov_b32 s55, 65536
L_sfail43a:
  ds_read_b32 v211, v210 offset:0
  s_waitcnt lgkmcnt(0)
  v_cmp_le_u32 vcc, 32, v211
  s_cbranch_vccnz L_sok44
  s_sub_u32 s55, s55, 1
  s_cbranch_scc0 L_sfail43a
L_sgo45:
  s_branch L_sok44
L_sfail46:
  s_mov_b32 s55, 65536
L_sfail46a:
  ds_read_b32 v211, v210 offset:0
  s_waitcnt lgkmcnt(0)
  v_cmp_le_u32 vcc, 36, v211
  s_cbranch_vccnz L_sok47
  s_sub_u32 s55, s55, 1
  s_cbranch_scc0 L_sfail46a
L_sgo48:
  s_branch L_sok47
L_sfail49:
  s_mov_b32 s55, 65536
L_sfail49a:
  ds_read_b32 v211, v210 offset:256
  s_waitcnt lgkmcnt(0)
  v_cmp_le_u32 vcc, 4, v211
  s_cbranch_vccnz L_sgo51
  s_sub_u32 s55, s55, 1
  s_cbranch_scc0 L_sfail49a
L_sgo51:
  ds_read_b128 v[28:31], v3 offset:1536
  ds_read_b128 v[48:51], v3 offset:42496
  ds_read_b128 v[68:71], v27 offset:1536
  ds_read_b128 v[88:91], v27 offset:42496
  s_waitcnt lgkmcnt(0)
  s_branch L_sok50
L_sfail52:
  s_mov_b32 s55, 65536
L_sfail52a:
  ds_read_b32 v211, v210 offset:512
  s_waitcnt lgkmcnt(0)
  v_cmp_le_u32 vcc, 4, v211
  s_cbranch_vccnz L_sgo54
  s_sub_u32 s55, s55, 1
  s_cbranch_scc0 L_sfail52a
L_sgo54:
  ds_read_b128 v[32:35], v3 offset:2560
  ds_read_b128 v[52:55], v3 offset:43520
  ds_read_b128 v[72:75], v27 offset:2560
  ds_read_b128 v[92:95], v27 offset:43520
  s_waitcnt lgkmcnt(0)
  s_branch L_sok53
L_sfail55:
  s_mov_b32 s55, 65536
L_sfail55a:
  ds_read_b32 v211, v210 offset:768
  s_waitcnt lgkmcnt(0)
  v_cmp_le_u32 vcc, 4, v211
  s_cbranch_vccnz L_sgo57
  s_sub_u32 s55, s55, 1
  s_cbranch_scc0 L_sfail55a
L_sgo57:
  ds_read_b128 v[36:39], v3 offset:3584
  ds_read_b128 v[56:59], v3 offset:44544
  ds_read_b128 v[76:79], v27 offset:3584
  ds_read_b128 v[96:99], v27 offset:44544
  s_waitcnt lgkmcnt(0)
  s_branch L_sok56
L_sfail58:
  s_mov_b32 s55, 65536
L_sfail58a:
  ds_read_b32 v211, v210 offset:1024
  s_waitcnt lgkmcnt(0)
  v_cmp_le_u32 vcc, 4, v211
  s_cbranch_vccnz L_sgo60
  s_sub_u32 s55, s55, 1
  s_cbranch_scc0 L_sfail58a
L_sgo60:
  ds_read_b128 v[40:43], v3 offset:4608
  ds_read_b128 v[60:63], v3 offset:45568
  ds_read_b128 v[80:83], v27 offset:4608
  ds_read_b128 v[100:103], v27 offset:45568
  s_waitcnt lgkmcnt(0)
  s_branch L_sok59
L_sfail61:
  s_mov_b32 s55, 65536
L_sfail61a:
  ds_read_b32 v211, v210 offset:1280
  s_waitcnt lgkmcnt(0)
  v_cmp_le_u32 vcc, 4, v211
  s_cbranch_vccnz L_sgo63
  s_sub_u32 s55, s55, 1
  s_cbranch_scc0 L_sfail61a
L_sgo63:
  ds_read_b128 v[44:47], v3 offset:5632
  ds_read_b128 v[64:67], v3 offset:46592
  ds_read_b128 v[84:87], v27 offset:5632
  ds_read_b128 v[104:107], v27 offset:46592
  s_waitcnt lgkmcnt(0)
  s_branch L_sok62
L_pfail76:
  s_mov_b64 exec, vcc
  s_mov_b32 s55, 65536
L_poll73:
  buffer_load_dword v26, v18, s[28:31], s97 offen sc1
  s_waitcnt vmcnt(0)
  v_cmp_ne_u32 vcc, s49, v26
  s_cbranch_vccz L_prest75
  s_mov_b64 exec, vcc
  s_sub_u32 s55, s55, 1
  s_cbranch_scc0 L_poll73
L_prest75:
  s_mov_b64 exec, -1
  s_branch L_pdone74
L_sfail77:
  s_mov_b32 s55, 65536
L_sfail77a:
  ds_read_b32 v211, v210 offset:0
  s_waitcnt lgkmcnt(0)
  v_cmp_le_u32 vcc, 40, v211
  s_cbranch_vccnz L_sok78
  s_sub_u32 s55, s55, 1
  s_cbranch_scc0 L_sfail77a
L_sgo79:
  s_branch L_sok78
L_sfail80:
  s_mov_b32 s55, 65536
L_sfail80a:
  ds_read_b32 v211, v210 offset:0
  s_waitcnt lgkmcnt(0)
  v_cmp_le_u32 vcc, 44, v211
  s_cbranch_vccnz L_sok81
  s_sub_u32 s55, s55, 1
  s_cbranch_scc0 L_sfail80a
L_sgo82:
  s_branch L_sok81
L_sfail83:
  s_mov_b32 s55, 65536
L_sfail83a:
  ds_read_b32 v211, v210 offset:0
  s_waitcnt lgkmcnt(0)
  v_cmp_le_u32 vcc, 48, v211
  s_cbranch_vccnz L_sok84
  s_sub_u32 s55, s55, 1
  s_cbranch_scc0 L_sfail83a
L_sgo85:
  s_branch L_sok84
L_sfail86:
  s_mov_b32 s55, 65536
L_sfail86a:
  ds_read_b32 v211, v210 offset:0
  s_waitcnt lgkmcnt(0)
  v_cmp_le_u32 vcc, 52, v211
  s_cbranch_vccnz L_sok87
  s_sub_u32 s55, s55, 1
  s_cbranch_scc0 L_sfail86a
L_sgo88:
  s_branch L_sok87
L_sfail89:
  s_mov_b32 s55, 65536
L_sfail89a:
  ds_read_b32 v211, v210 offset:0
  s_waitcnt lgkmcnt(0)
  v_cmp_le_u32 vcc, 56, v211
  s_cbranch_vccnz L_sok90
  s_sub_u32 s55, s55, 1
  s_cbranch_scc0 L_sfail89a
L_sgo91:
  s_branch L_sok90
L_sfail92:
  s_mov_b32 s55, 65536
L_sfail92a:
  ds_read_b32 v211, v210 offset:0
  s_waitcnt lgkmcnt(0)
  v_cmp_le_u32 vcc, 60, v211
  s_cbranch_vccnz L_sok93
  s_sub_u32 s55, s55, 1
  s_cbranch_scc0 L_sfail92a
L_sgo94:
  s_branch L_sok93
L_sfail95:
  s_mov_b32 s55, 65536
L_sfail95a:
  ds_read_b32 v211, v210 offset:0
  s_waitcnt lgkmcnt(0)
  v_cmp_le_u32 vcc, 64, v211
  s_cbranch_vccnz L_sok96
  s_sub_u32 s55, s55, 1
  s_cbranch_scc0 L_sfail95a
L_sgo97:
  s_branch L_sok96
L_sfail98:
  s_mov_b32 s55, 65536
L_sfail98a:
  ds_read_b32 v211, v210 offset:0
  s_waitcnt lgkmcnt(0)
  v_cmp_le_u32 vcc, 68, v211
  s_cbranch_vccnz L_sok99
  s_sub_u32 s55, s55, 1
  s_cbranch_scc0 L_sfail98a
L_sgo100:
  s_branch L_sok99
L_sfail101:
  s_mov_b32 s55, 65536
L_sfail101a:
  ds_read_b32 v211, v210 offset:0
  s_waitcnt lgkmcnt(0)
  v_cmp_le_u32 vcc, 72, v211
  s_cbranch_vccnz L_sok102
  s_sub_u32 s55, s55, 1
  s_cbranch_scc0 L_sfail101a
L_sgo103:
  s_branch L_sok102
L_sfail104:
  s_mov_b32 s55, 65536
L_sfail104a:
  ds_read_b32 v211, v210 offset:256
  s_waitcnt lgkmcnt(0)
  v_cmp_le_u32 vcc, 8, v211
  s_cbranch_vccnz L_sgo106
  s_sub_u32 s55, s55, 1
  s_cbranch_scc0 L_sfail104a
L_sgo106:
  ds_read_b128 v[28:31], v3 offset:1536
  ds_read_b128 v[48:51], v3 offset:42496
  ds_read_b128 v[68:71], v27 offset:1536
  ds_read_b128 v[88:91], v27 offset:42496
  s_waitcnt lgkmcnt(0)
  s_branch L_sok105
L_sfail107:
  s_mov_b32 s55, 65536
L_sfail107a:
  ds_read_b32 v211, v210 offset:512
  s_waitcnt lgkmcnt(0)
  v_cmp_le_u32 vcc, 8, v211
  s_cbranch_vccnz L_sgo109
  s_sub_u32 s55, s55, 1
  s_cbranch_scc0 L_sfail107a
L_sgo109:
  ds_read_b128 v[32:35], v3 offset:2560
  ds_read_b128 v[52:55], v3 offset:43520
  ds_read_b128 v[72:75], v27 offset:2560
  ds_read_b128 v[92:95], v27 offset:43520
  s_waitcnt lgkmcnt(0)
  s_branch L_sok108
L_sfail110:
  s_mov_b32 s55, 65536
L_sfail110a:
  ds_read_b32 v211, v210 offset:768
  s_waitcnt lgkmcnt(0)
  v_cmp_le_u32 vcc, 8, v211
  s_cbranch_vccnz L_sgo112
  s_sub_u32 s55, s55, 1
  s_cbranch_scc0 L_sfail110a
L_sgo112:
  ds_read_b128 v[36:39], v3 offset:3584
  ds_read_b128 v[56:59], v3 offset:44544
  ds_read_b128 v[76:79], v27 offset:3584
  ds_read_b128 v[96:99], v27 offset:44544
  s_waitcnt lgkmcnt(0)
  s_branch L_sok111
L_sfail113:
  s_mov_b32 s55, 65536
L_sfail113a:
  ds_read_b32 v211, v210 offset:1024
  s_waitcnt lgkmcnt(0)
  v_cmp_le_u32 vcc, 8, v211
  s_cbranch_vccnz L_sgo115
  s_sub_u32 s55, s55, 1
  s_cbranch_scc0 L_sfail113a
L_sgo115:
  ds_read_b128 v[40:43], v3 offset:4608
  ds_read_b128 v[60:63], v3 offset:45568
  ds_read_b128 v[80:83], v27 offset:4608
  ds_read_b128 v[100:103], v27 offset:45568
  s_waitcnt lgkmcnt(0)
  s_branch L_sok114
L_sfail116:
  s_mov_b32 s55, 65536
L_sfail116a:
  ds_read_b32 v211, v210 offset:1280
  s_waitcnt lgkmcnt(0)
  v_cmp_le_u32 vcc, 8, v211
  s_cbranch_vccnz L_sgo118
  s_sub_u32 s55, s55, 1
  s_cbranch_scc0 L_sfail116a
L_sgo118:
  ds_read_b128 v[44:47], v3 offset:5632
  ds_read_b128 v[64:67], v3 offset:46592
  ds_read_b128 v[84:87], v27 offset:5632
  ds_read_b128 v[104:107], v27 offset:46592
  s_waitcnt lgkmcnt(0)
  s_branch L_sok117
L_end:
L_wfix:
  s_cmp_lg_u32 s10, 0
  s_cbranch_scc1 L_wok
  s_mov_b32 s10, 1
  s_load_dwordx2 s[6:7], s[0:1], 32
  s_load_dwordx2 s[8:9], s[0:1], 64
  s_nop 7
  s_waitcnt vmcnt(0) lgkmcnt(0)
  v_add_u32 v191, 0, v1
  v_mul_u32_u24 v188, 7282, v191
  v_lshrrev_b32 v188, 16, v188
  v_mad_i32_i24 v191, v188, -9, v191
  v_add_u32 v192, 64, v1
  v_mul_u32_u24 v189, 7282, v192
  v_lshrrev_b32 v189, 16, v189
  v_mad_i32_i24 v192, v189, -9, v192
  v_add_u32 v193, 128, v1
  v_mul_u32_u24 v190, 7282, v193
  v_lshrrev_b32 v190, 16, v190
  v_mad_i32_i24 v193, v190, -9, v193
  s_mul_i32 s65, s3, 205
  s_lshr_b32 s65, s65, 11
  s_mul_i32 s66, s65, 10
  s_sub_u32 s66, s3, s66
  s_lshl2_add_u32 s66, s66, s44
  s_mul_i32 s67, s66, 205
  s_lshr_b32 s67, s67, 11
  s_mul_i32 s68, s67, 10
  s_sub_u32 s68, s66, s68
  s_mul_i32 s70, s68, 5
  s_add_u32 s70, s70, s65
  s_mul_i32 s70, s70, 12
  s_add_u32 s70, s70, s67
  s_mul_i32 s67, s46, 2400
  s_add_u32 s70, s70, s67
  s_lshl_b32 s5, s70, 8
  s_cmp_ge_u32 s3, 50
  s_cselect_b32 s67, s25, 0
  v_and_b32 v250, 15, v1
  v_mul_u32_u24 v212, 9600, v19
  v_lshl_add_u32 v212, v250, 4, v212
  v_or_b32 v212, s67, v212
  v_lshrrev_b32 v249, 2, v19
  v_lshl_add_u32 v249, v250, 4, v249
  s_add_u32 s67, s50, 9216
  v_mad_u32_u24 v249, v249, 9, s67
  s_lshr_b32 s67, s65, 1
  s_and_b32 s68, s65, 1
  s_lshl3_add_u32 s67, s67, s68
  s_lshl2_add_u32 s67, s67, 16
  s_cmp_lt_u32 s65, 4
  s_cselect_b32 s70, 12, 0
  s_cselect_b32 s67, s67, 0
  s_mul_i32 s68, s46, 80
  s_add_u32 s67, s67, s68
  s_mul_i32 s67, s67, 40
  s_add_u32 s67, s67, s66
  s_mul_i32 s67, s67, 144
  s_cmp_ge_u32 s3, 50
  s_cmov_b32 s67, 0x80000000
  s_movk_i32 s68, 360
  v_and_b32 v246, s70, v188
  v_add_u32 v246, v246, v188
  v_mad_u32_u24 v246, v246, s68, v191
  v_lshl_add_u32 v246, v246, 4, s67
  v_and_b32 v247, s70, v189
  v_add_u32 v247, v247, v189
  v_mad_u32_u24 v247, v247, s68, v192
  v_lshl_add_u32 v247, v247, 4, s67
  v_and_b32 v248, s70, v190
  v_add_u32 v248, v248, v190
  v_mad_u32_u24 v248, v248, s68, v193
  v_lshl_add_u32 v248, v248, 4, s67
  s_add_u32 m0, s50, 9216
  s_mov_b64 s[40:41], s[6:7]
  s_mov_b32 s42, 1843200
  buffer_load_dwordx4 v246, s[40:43], 0 offen lds
  s_addk_i32 m0, 1024
  s_nop 0
  buffer_load_dwordx4 v247, s[40:43], 0 offen lds
  s_addk_i32 m0, 1024
  s_mov_b64 exec, 0xffff
  buffer_load_dwordx4 v248, s[40:43], 0 offen lds
  s_mov_b64 exec, -1
  s_lshl_b32 s67, s65, 4
  s_mul_i32 s68, s46, 80
  s_add_u32 s67, s67, s68
  s_mul_i32 s67, s67, 40
  s_add_u32 s67, s67, s66
  s_mul_i32 s67, s67, 144
  s_cmp_ge_u32 s3, 50
  s_cmov_b32 s67, 0x80000000
  s_movk_i32 s68, 360
  v_mad_u32_u24 v246, v188, s68, v191
  v_lshl_add_u32 v246, v246, 4, s67
  v_mad_u32_u24 v247, v189, s68, v192
  v_lshl_add_u32 v247, v247, 4, s67
  v_mad_u32_u24 v248, v190, s68, v193
  v_lshl_add_u32 v248, v248, 4, s67
  s_add_u32 m0, s50, 12288
  s_mov_b64 s[40:41], s[8:9]
  s_mov_b32 s42, 1843200
  buffer_load_dwordx4 v246, s[40:43], 0 offen lds
  s_addk_i32 m0, 1024
  s_nop 0
  buffer_load_dwordx4 v247, s[40:43], 0 offen lds
  s_addk_i32 m0, 1024
  s_mov_b64 exec, 0xffff
  buffer_load_dwordx4 v248, s[40:43], 0 offen lds
  s_mov_b64 exec, -1
  s_waitcnt vmcnt(0) lgkmcnt(0)
  ds_read2_b32 v[168:169], v249 offset0:0 offset1:1
  ds_read2_b32 v[170:171], v249 offset0:2 offset1:3
  ds_read2_b32 v[172:173], v249 offset0:4 offset1:5
  ds_read2_b32 v[174:175], v249 offset0:6 offset1:7
  ds_read_b32 v176, v249 offset:32
  s_waitcnt vmcnt(0) lgkmcnt(0)
  v_add_u32 v249, 3072, v249
  ds_read2_b32 v[178:179], v249 offset0:0 offset1:1
  ds_read2_b32 v[180:181], v249 offset0:2 offset1:3
  ds_read2_b32 v[182:183], v249 offset0:4 offset1:5
  ds_read2_b32 v[184:185], v249 offset0:6 offset1:7
  ds_read_b32 v186, v249 offset:32
  s_waitcnt vmcnt(0) lgkmcnt(0)
  v_pk_maximum3_f16 v68, v168, v168, v168 neg_lo:[0,1,0] neg_hi:[0,1,0]
  v_pk_maximum3_f16 v68, v68, v169, v169 neg_lo:[0,0,1] neg_hi:[0,0,1]
  v_pk_maximum3_f16 v68, v68, v170, v170 neg_lo:[0,0,1] neg_hi:[0,0,1]
  v_pk_maximum3_f16 v68, v68, v171, v171 neg_lo:[0,0,1] neg_hi:[0,0,1]
  v_pk_maximum3_f16 v68, v68, v172, v172 neg_lo:[0,0,1] neg_hi:[0,0,1]
  v_pk_maximum3_f16 v68, v68, v173, v173 neg_lo:[0,0,1] neg_hi:[0,0,1]
  v_pk_maximum3_f16 v68, v68, v174, v174 neg_lo:[0,0,1] neg_hi:[0,0,1]
  v_pk_maximum3_f16 v68, v68, v175, v175 neg_lo:[0,0,1] neg_hi:[0,0,1]
  v_pk_maximum3_f16 v68, v68, v176, v176 neg_lo:[0,0,1] neg_hi:[0,0,1]
  v_lshlrev_b32 v69, 16, v68
  v_max_u32 v68, v68, v69
  v_pk_maximum3_f16 v70, v178, v178, v178 neg_lo:[0,1,0] neg_hi:[0,1,0]
  v_pk_maximum3_f16 v70, v70, v179, v179 neg_lo:[0,0,1] neg_hi:[0,0,1]
  v_pk_maximum3_f16 v70, v70, v180, v180 neg_lo:[0,0,1] neg_hi:[0,0,1]
  v_pk_maximum3_f16 v70, v70, v181, v181 neg_lo:[0,0,1] neg_hi:[0,0,1]
  v_pk_maximum3_f16 v70, v70, v182, v182 neg_lo:[0,0,1] neg_hi:[0,0,1]
  v_pk_maximum3_f16 v70, v70, v183, v183 neg_lo:[0,0,1] neg_hi:[0,0,1]
  v_pk_maximum3_f16 v70, v70, v184, v184 neg_lo:[0,0,1] neg_hi:[0,0,1]
  v_pk_maximum3_f16 v70, v70, v185, v185 neg_lo:[0,0,1] neg_hi:[0,0,1]
  v_pk_maximum3_f16 v70, v70, v186, v186 neg_lo:[0,0,1] neg_hi:[0,0,1]
  v_lshlrev_b32 v71, 16, v70
  v_max_u32 v70, v70, v71
  s_nop 1
  v_max_u32_dpp v68, v68, v68 quad_perm:[1,0,3,2] row_mask:0xf bank_mask:0xf
  v_max_u32_dpp v70, v70, v70 quad_perm:[1,0,3,2] row_mask:0xf bank_mask:0xf
  s_nop 0
  v_max_u32_dpp v68, v68, v68 quad_perm:[2,3,0,1] row_mask:0xf bank_mask:0xf
  v_max_u32_dpp v70, v70, v70 quad_perm:[2,3,0,1] row_mask:0xf bank_mask:0xf
  s_nop 0
  v_max_u32_dpp v68, v68, v68 row_half_mirror row_mask:0xf bank_mask:0xf
  v_max_u32_dpp v70, v70, v70 row_half_mirror row_mask:0xf bank_mask:0xf
  s_nop 0
  v_max_u32_dpp v68, v68, v68 row_mirror row_mask:0xf bank_mask:0xf
  v_max_u32_dpp v70, v70, v70 row_mirror row_mask:0xf bank_mask:0xf
  s_nop 0
  v_max_u32_dpp v68, v68, v68 row_bcast:15 row_mask:0xa bank_mask:0xf
  v_max_u32_dpp v70, v70, v70 row_bcast:15 row_mask:0xa bank_mask:0xf
  s_nop 0
  v_max_u32_dpp v68, v68, v68 row_bcast:31 row_mask:0xc bank_mask:0xf
  v_max_u32_dpp v70, v70, v70 row_bcast:31 row_mask:0xc bank_mask:0xf
  s_nop 0
  v_lshrrev_b32 v68, 23, v68
  v_lshrrev_b32 v70, 23, v70
  v_lshl_or_b32 v68, v70, 16, v68
  v_mov_b32 v69, s49
  s_mul_i32 s69, s46, 50
  s_add_u32 s69, s69, s3
  s_lshl2_add_u32 s69, s69, s44
  s_cmp_ge_u32 s3, 50
  s_cbranch_scc1 L_wf1
  s_lshl3_add_u32 s65, s69, 16515072
  s_mov_b32 exec_lo, 0
  s_brev_b32 exec_hi, 1
  buffer_store_dwordx2 v[68:69], off, s[28:31], s65 sc1
  s_mov_b64 exec, -1
L_wf1:
  s_mul_i32 s65, s46, 1600
  s_add_u32 s65, s65, 16515072
  v_min_u32 v24, 784, v2
  s_mov_b32 s55, 65536
L_poll119:
  buffer_load_dwordx4 v[156:159], v24, s[28:31], s65 offen sc1
  buffer_load_dwordx4 v[160:163], v24, s[28:31], s65 offen offset:800 sc1
  s_waitcnt vmcnt(0)
  v_bitop3_b32 v20, v157, v159, s49 bitop3:0x7e
  v_bitop3_b32 v21, v161, v163, s49 bitop3:0x7e
  v_or_b32 v20, v20, v21
  v_cmp_ne_u32 vcc, 0, v20
  s_cbranch_vccz L_prest121
  s_mov_b64 exec, vcc
  s_sub_u32 s55, s55, 1
  s_cbranch_scc0 L_poll119
L_prest121:
  s_mov_b64 exec, -1
  v_pk_max_u16 v156, v156, v158
  v_pk_max_u16 v160, v160, v162
  v_pk_max_u16 v156, v156, v160
  v_lshrrev_b32 v157, 16, v156
  v_and_b32 v156, 0xffff, v156
  s_nop 1
  v_max_u32_dpp v156, v156, v156 quad_perm:[1,0,3,2] row_mask:0xf bank_mask:0xf
  v_max_u32_dpp v157, v157, v157 quad_perm:[1,0,3,2] row_mask:0xf bank_mask:0xf
  s_nop 0
  v_max_u32_dpp v156, v156, v156 quad_perm:[2,3,0,1] row_mask:0xf bank_mask:0xf
  v_max_u32_dpp v157, v157, v157 quad_perm:[2,3,0,1] row_mask:0xf bank_mask:0xf
  s_nop 0
  v_max_u32_dpp v156, v156, v156 row_half_mirror row_mask:0xf bank_mask:0xf
  v_max_u32_dpp v157, v157, v157 row_half_mirror row_mask:0xf bank_mask:0xf
  s_nop 0
  v_max_u32_dpp v156, v156, v156 row_mirror row_mask:0xf bank_mask:0xf
  v_max_u32_dpp v157, v157, v157 row_mirror row_mask:0xf bank_mask:0xf
  s_nop 0
  v_max_u32_dpp v156, v156, v156 row_bcast:15 row_mask:0xa bank_mask:0xf
  v_max_u32_dpp v157, v157, v157 row_bcast:15 row_mask:0xa bank_mask:0xf
  s_nop 0
  v_max_u32_dpp v156, v156, v156 row_bcast:31 row_mask:0xc bank_mask:0xf
  v_max_u32_dpp v157, v157, v157 row_bcast:31 row_mask:0xc bank_mask:0xf
  s_nop 0
  v_readlane_b32 s66, v156, 63
  s_max_u32 s66, s66, 80
  s_min_u32 s66, s66, 200
  s_sub_u32 s4, 267, s66
  s_lshl_b32 s4, s4, 23
  s_sub_u32 s67, s66, 13
  s_lshl_b32 s67, s67, 23
  s_sub_u32 s12, s4, 0x800000
  s_add_u32 s22, s57, s67
  s_sub_u32 s22, s22, 1065353216
  v_lshlrev_b32 v216, 16, v168
  v_and_b32 v217, s23, v172
  v_and_b32 v218, s23, v168
  v_lshlrev_b32 v219, 16, v173
  v_lshlrev_b32 v220, 16, v169
  v_and_b32 v221, s23, v173
  v_pk_add_f32 v[222:223], v[216:217], v[220:221]
  v_pk_mul_f32 v[216:217], v[216:217], s[4:5] op_sel_hi:[1,0]
  v_pk_mul_f32 v[222:223], v[222:223], s[12:13] op_sel_hi:[1,0]
  v_pk_mul_f32 v[220:221], v[220:221], s[4:5] op_sel_hi:[1,0]
  v_pk_fma_f32 v[224:225], v[218:219], s[12:13], v[222:223] op_sel_hi:[1,0,1]
  v_pk_fma_f32 v[218:219], v[218:219], s[12:13], v[222:223] op_sel_hi:[1,0,1] neg_lo:[1,0,0] neg_hi:[1,0,0]
  v_cvt_pk_f16_f32 v188, v216, v217
  v_cvt_pk_f16_f32 v189, v224, v225
  v_cvt_pk_f16_f32 v190, v218, v219
  v_cvt_pk_f16_f32 v191, v220, v221
  v_and_b32 v226, s23, v169
  v_lshlrev_b32 v227, 16, v174
  v_lshlrev_b32 v228, 16, v170
  v_and_b32 v229, s23, v174
  v_and_b32 v230, s23, v170
  v_lshlrev_b32 v231, 16, v175
  v_pk_add_f32 v[232:233], v[226:227], v[230:231]
  v_pk_mul_f32 v[226:227], v[226:227], s[4:5] op_sel_hi:[1,0]
  v_pk_mul_f32 v[232:233], v[232:233], s[12:13] op_sel_hi:[1,0]
  v_pk_mul_f32 v[230:231], v[230:231], s[4:5] op_sel_hi:[1,0]
  v_pk_fma_f32 v[234:235], v[228:229], s[12:13], v[232:233] op_sel_hi:[1,0,1]
  v_pk_fma_f32 v[228:229], v[228:229], s[12:13], v[232:233] op_sel_hi:[1,0,1] neg_lo:[1,0,0] neg_hi:[1,0,0]
  v_cvt_pk_f16_f32 v192, v226, v227
  v_cvt_pk_f16_f32 v193, v234, v235
  v_cvt_pk_f16_f32 v194, v228, v229
  v_cvt_pk_f16_f32 v195, v230, v231
  v_lshlrev_b32 v236, 16, v171
  v_and_b32 v237, s23, v175
  v_and_b32 v238, s23, v171
  v_lshlrev_b32 v239, 16, v176
  v_lshlrev_b32 v240, 16, v172
  v_and_b32 v241, s23, v176
  v_pk_add_f32 v[242:243], v[236:237], v[240:241]
  v_pk_mul_f32 v[236:237], v[236:237], s[4:5] op_sel_hi:[1,0]
  v_pk_mul_f32 v[242:243], v[242:243], s[12:13] op_sel_hi:[1,0]
  v_pk_mul_f32 v[240:241], v[240:241], s[4:5] op_sel_hi:[1,0]
  v_pk_fma_f32 v[244:245], v[238:239], s[12:13], v[242:243] op_sel_hi:[1,0,1]
  v_pk_fma_f32 v[238:239], v[238:239], s[12:13], v[242:243] op_sel_hi:[1,0,1] neg_lo:[1,0,0] neg_hi:[1,0,0]
  v_cvt_pk_f16_f32 v196, v236, v237
  v_cvt_pk_f16_f32 v197, v244, v245
  v_cvt_pk_f16_f32 v198, v238, v239
  v_cvt_pk_f16_f32 v199, v240, v241
  v_permlane32_swap_b32 v188, v190
  v_permlane32_swap_b32 v189, v191
  v_permlane32_swap_b32 v192, v194
  v_permlane32_swap_b32 v193, v195
  v_permlane32_swap_b32 v196, v198
  v_permlane32_swap_b32 v197, v199
  v_permlane16_swap_b32 v188, v189
  v_permlane16_swap_b32 v190, v191
  v_permlane16_swap_b32 v192, v193
  v_permlane16_swap_b32 v194, v195
  v_permlane16_swap_b32 v196, v197
  v_permlane16_swap_b32 v198, v199
  s_add_u32 s65, s5, 10616832
  buffer_store_dwordx4 v[188:191], v212, s[28:31], s65 offen offset:0 sc1
  buffer_store_dwordx4 v[192:195], v212, s[28:31], s65 offen offset:1024 sc1
  buffer_store_dwordx4 v[196:199], v212, s[28:31], s65 offen offset:2048 sc1
  v_readlane_b32 s66, v157, 63
  s_max_u32 s66, s66, 80
  s_min_u32 s66, s66, 200
  s_sub_u32 s4, 267, s66
  s_lshl_b32 s4, s4, 23
  s_sub_u32 s67, s66, 13
  s_lshl_b32 s67, s67, 23
  s_sub_u32 s12, s4, 0x800000
  s_add_u32 s24, s59, s67
  s_sub_u32 s24, s24, 1065353216
  v_lshlrev_b32 v216, 16, v178
  v_and_b32 v217, s23, v182
  v_and_b32 v218, s23, v178
  v_lshlrev_b32 v219, 16, v183
  v_lshlrev_b32 v220, 16, v179
  v_and_b32 v221, s23, v183
  v_pk_add_f32 v[222:223], v[216:217], v[220:221]
  v_pk_mul_f32 v[216:217], v[216:217], s[4:5] op_sel_hi:[1,0]
  v_pk_mul_f32 v[222:223], v[222:223], s[12:13] op_sel_hi:[1,0]
  v_pk_mul_f32 v[220:221], v[220:221], s[4:5] op_sel_hi:[1,0]
  v_pk_fma_f32 v[224:225], v[218:219], s[12:13], v[222:223] op_sel_hi:[1,0,1]
  v_pk_fma_f32 v[218:219], v[218:219], s[12:13], v[222:223] op_sel_hi:[1,0,1] neg_lo:[1,0,0] neg_hi:[1,0,0]
  v_cvt_pk_f16_f32 v200, v216, v217
  v_cvt_pk_f16_f32 v201, v224, v225
  v_cvt_pk_f16_f32 v202, v218, v219
  v_cvt_pk_f16_f32 v203, v220, v221
  v_and_b32 v226, s23, v179
  v_lshlrev_b32 v227, 16, v184
  v_lshlrev_b32 v228, 16, v180
  v_and_b32 v229, s23, v184
  v_and_b32 v230, s23, v180
  v_lshlrev_b32 v231, 16, v185
  v_pk_add_f32 v[232:233], v[226:227], v[230:231]
  v_pk_mul_f32 v[226:227], v[226:227], s[4:5] op_sel_hi:[1,0]
  v_pk_mul_f32 v[232:233], v[232:233], s[12:13] op_sel_hi:[1,0]
  v_pk_mul_f32 v[230:231], v[230:231], s[4:5] op_sel_hi:[1,0]
  v_pk_fma_f32 v[234:235], v[228:229], s[12:13], v[232:233] op_sel_hi:[1,0,1]
  v_pk_fma_f32 v[228:229], v[228:229], s[12:13], v[232:233] op_sel_hi:[1,0,1] neg_lo:[1,0,0] neg_hi:[1,0,0]
  v_cvt_pk_f16_f32 v204, v226, v227
  v_cvt_pk_f16_f32 v205, v234, v235
  v_cvt_pk_f16_f32 v206, v228, v229
  v_cvt_pk_f16_f32 v207, v230, v231
  v_lshlrev_b32 v236, 16, v181
  v_and_b32 v237, s23, v185
  v_and_b32 v238, s23, v181
  v_lshlrev_b32 v239, 16, v186
  v_lshlrev_b32 v240, 16, v182
  v_and_b32 v241, s23, v186
  v_pk_add_f32 v[242:243], v[236:237], v[240:241]
  v_pk_mul_f32 v[236:237], v[236:237], s[4:5] op_sel_hi:[1,0]
  v_pk_mul_f32 v[242:243], v[242:243], s[12:13] op_sel_hi:[1,0]
  v_pk_mul_f32 v[240:241], v[240:241], s[4:5] op_sel_hi:[1,0]
  v_pk_fma_f32 v[244:245], v[238:239], s[12:13], v[242:243] op_sel_hi:[1,0,1]
  v_pk_fma_f32 v[238:239], v[238:239], s[12:13], v[242:243] op_sel_hi:[1,0,1] neg_lo:[1,0,0] neg_hi:[1,0,0]
  v_cvt_pk_f16_f32 v208, v236, v237
  v_cvt_pk_f16_f32 v209, v244, v245
  v_cvt_pk_f16_f32 v210, v238, v239
  v_cvt_pk_f16_f32 v211, v240, v241
  v_permlane32_swap_b32 v200, v202
  v_permlane32_swap_b32 v201, v203
  v_permlane32_swap_b32 v204, v206
  v_permlane32_swap_b32 v205, v207
  v_permlane32_swap_b32 v208, v210
  v_permlane32_swap_b32 v209, v211
  v_permlane16_swap_b32 v200, v201
  v_permlane16_swap_b32 v202, v203
  v_permlane16_swap_b32 v204, v205
  v_permlane16_swap_b32 v206, v207
  v_permlane16_swap_b32 v208, v209
  v_permlane16_swap_b32 v210, v211
  s_add_u32 s65, s5, 13074432
  buffer_store_dwordx4 v[200:203], v212, s[28:31], s65 offen offset:0 sc1
  buffer_store_dwordx4 v[204:207], v212, s[28:31], s65 offen offset:1024 sc1
  buffer_store_dwordx4 v[208:211], v212, s[28:31], s65 offen offset:2048 sc1
  s_waitcnt vmcnt(0) lgkmcnt(0)
  s_cmp_ge_u32 s3, 50
  s_cbranch_scc1 L_wf2
  s_lshl2_add_u32 s65, s69, 16523264
  s_mov_b64 exec, 1
  buffer_store_dword v0, off, s[28:31], s65 sc1
  s_mov_b64 exec, -1
L_wf2:
  s_mul_i32 s65, s46, 800
  s_add_u32 s65, s65, 16523264
  s_mov_b32 s55, 65536
L_poll122:
  buffer_load_dwordx4 v[156:159], v24, s[28:31], s65 offen sc1
  s_waitcnt vmcnt(0)
  v_bitop3_b32 v20, v156, v157, s49 bitop3:0x7e
  v_bitop3_b32 v21, v158, v159, s49 bitop3:0x7e
  v_or_b32 v20, v20, v21
  v_cmp_ne_u32 vcc, 0, v20
  s_cbranch_vccz L_prest124
  s_mov_b64 exec, vcc
  s_sub_u32 s55, s55, 1
  s_cbranch_scc0 L_poll122
L_prest124:
  s_mov_b64 exec, -1
  s_add_u32 s51, s61, 10616832
  buffer_load_dwordx4 a[0:3], v10, s[28:31], s51 offen offset:0 sc1
  buffer_load_dwordx4 a[4:7], v13, s[28:31], s51 offen offset:0 sc1
  buffer_load_dwordx4 a[8:11], v14, s[28:31], s51 offen offset:0 sc1
  buffer_load_dwordx4 a[12:15], v10, s[28:31], s51 offen offset:3072 sc1
  buffer_load_dwordx4 a[16:19], v13, s[28:31], s51 offen offset:3072 sc1
  buffer_load_dwordx4 a[20:23], v14, s[28:31], s51 offen offset:3072 sc1
  s_add_u32 s19, s51, s18
  buffer_load_dwordx4 a[24:27], v10, s[28:31], s19 offen offset:0 sc1
  buffer_load_dwordx4 a[28:31], v13, s[28:31], s19 offen offset:0 sc1
  buffer_load_dwordx4 a[32:35], v14, s[28:31], s19 offen offset:0 sc1
  s_addk_i32 s51, 15360
  buffer_load_dwordx4 a[36:39], v10, s[28:31], s51 offen offset:0 sc1
  buffer_load_dwordx4 a[40:43], v13, s[28:31], s51 offen offset:0 sc1
  buffer_load_dwordx4 a[44:47], v14, s[28:31], s51 offen offset:0 sc1
  s_lshl2_add_u32 s8, s45, s44
  s_mul_i32 s8, s8, 657408
  s_lshl_b32 s52, s47, 9
  s_add_u32 s8, s8, s52
  s_add_u32 s8, s8, 16780800
  s_waitcnt vmcnt(0) lgkmcnt(0)
  s_barrier
  s_add_u32 m0, s50, 16384
  s_add_u32 s52, s8, 0
  buffer_load_dwordx4 v4, s[28:31], s52 offen sc1 lds
  s_addk_i32 m0, 1024
  s_nop 0
  buffer_load_dwordx4 v5, s[28:31], s52 offen sc1 lds
  s_addk_i32 m0, 1024
  s_nop 0
  buffer_load_dwordx4 v6, s[28:31], s52 offen sc1 lds
  s_addk_i32 m0, 1024
  s_nop 0
  buffer_load_dwordx4 v7, s[28:31], s52 offen sc1 lds
  s_addk_i32 m0, 1024
  s_nop 0
  buffer_load_dwordx4 v8, s[28:31], s52 offen sc1 lds
  s_addk_i32 m0, 1024
  s_nop 0
  buffer_load_dwordx4 v9, s[28:31], s52 offen sc1 lds
  s_add_u32 m0, s50, 22528
  s_add_u32 s52, s8, 65536
  buffer_load_dwordx4 v4, s[28:31], s52 offen sc1 lds
  s_addk_i32 m0, 1024
  s_nop 0
  buffer_load_dwordx4 v5, s[28:31], s52 offen sc1 lds
  s_addk_i32 m0, 1024
  s_nop 0
  buffer_load_dwordx4 v6, s[28:31], s52 offen sc1 lds
  s_addk_i32 m0, 1024
  s_nop 0
  buffer_load_dwordx4 v7, s[28:31], s52 offen sc1 lds
  s_addk_i32 m0, 1024
  s_nop 0
  buffer_load_dwordx4 v8, s[28:31], s52 offen sc1 lds
  s_addk_i32 m0, 1024
  s_nop 0
  buffer_load_dwordx4 v9, s[28:31], s52 offen sc1 lds
  v_mov_b32 v26, s49
  v_min_u32 v164, 59, v1
  v_lshlrev_b32 v164, 5, v164
  s_lshl_b32 s67, s16, 7
  v_lshl_add_u32 v165, v19, 1, s67
  v_add_u32 v167, s50, v2
  s_lshr_b32 s66, s13, 2
  s_add_u32 s66, s66, 15892480
  v_mov_b32 v24, 1536
  s_mul_i32 s67, s54, 320
  s_add_u32 s67, s67, 16527360
  v_mov_b32 v100, 0
  v_mov_b32 v101, 0
  v_mov_b32 v102, 0
  v_mov_b32 v103, 0
  ds_write_b128 v2, v[100:103]
  ds_write_b128 v2, v[100:103] offset:512
  v_lshlrev_b32 v210, 2, v1
  v_mov_b32 v209, 1
  s_waitcnt lgkmcnt(0)
  s_waitcnt vmcnt(0) lgkmcnt(0)
  s_branch L_conv1
.section .rodata,"a"
.p2align 6
.amdhsa_kernel standalone__adm_resblock__diffusion_kernel
  .amdhsa_next_free_vgpr 512
  .amdhsa_next_free_sgpr 102
  .amdhsa_accum_offset 256
  .amdhsa_group_segment_fixed_size 0
  .amdhsa_kernarg_size 96
  .amdhsa_user_sgpr_count 2
  .amdhsa_user_sgpr_kernarg_segment_ptr 1
  .amdhsa_system_sgpr_workgroup_id_x 1
.end_amdhsa_kernel
.p2align 7
dma_slots:
.long 0x80000000, 0x280, 0x600, 0xb80, 0x80000000, 0x290, 0x610, 0xb90
.long 0x80000000, 0x2a0, 0x620, 0xba0, 0x80000000, 0x2b0, 0x630, 0xbb0
.long 0x100, 0x2c0, 0x640, 0xbc0, 0x110, 0x2d0, 0x650, 0xbd0
.long 0x120, 0x2e0, 0x660, 0xbe0, 0x130, 0x2f0, 0x670, 0xbf0
.long 0x140, 0x8200, 0x680, 0xa00, 0x150, 0x80000000, 0x690, 0xa10
.long 0x160, 0x80000000, 0x6a0, 0xa20, 0x170, 0x80000000, 0x6b0, 0xa30
.long 0x180, 0x500, 0x6c0, 0xa40, 0x190, 0x510, 0x6d0, 0xa50
.long 0x1a0, 0x520, 0x6e0, 0xa60, 0x1b0, 0x530, 0x6f0, 0xa70
.long 0x1c0, 0x540, 0x8600, 0xa80, 0x1d0, 0x550, 0x80000000, 0xa90
.long 0x1e0, 0x560, 0x80000000, 0xaa0, 0x1f0, 0x570, 0x80000000, 0xab0
.long 0x0, 0x580, 0x900, 0xac0, 0x10, 0x590, 0x910, 0xad0
.long 0x20, 0x5a0, 0x920, 0xae0, 0x30, 0x5b0, 0x930, 0xaf0
.long 0x40, 0x5c0, 0x940, 0x8a00, 0x50, 0x5d0, 0x950, 0x80000000
.long 0x60, 0x5e0, 0x960, 0x80000000, 0x70, 0x5f0, 0x970, 0x80000000
.long 0x80, 0x400, 0x980, 0xd00, 0x90, 0x410, 0x990, 0xd10
.long 0xa0, 0x420, 0x9a0, 0xd20, 0xb0, 0x430, 0x9b0, 0xd30
.long 0xc0, 0x440, 0x9c0, 0xd40, 0xd0, 0x450, 0x9d0, 0xd50
.long 0xe0, 0x460, 0x9e0, 0xd60, 0xf0, 0x470, 0x9f0, 0xd70
.long 0x8000, 0x480, 0x800, 0xd80, 0x80000000, 0x490, 0x810, 0xd90
.long 0x80000000, 0x4a0, 0x820, 0xda0, 0x80000000, 0x4b0, 0x830, 0xdb0
.long 0x300, 0x4c0, 0x840, 0xdc0, 0x310, 0x4d0, 0x850, 0xdd0
.long 0x320, 0x4e0, 0x860, 0xde0, 0x330, 0x4f0, 0x870, 0xdf0
.long 0x340, 0x8400, 0x880, 0xc00, 0x350, 0x80000000, 0x890, 0xc10
.long 0x360, 0x80000000, 0x8a0, 0xc20, 0x370, 0x80000000, 0x8b0, 0xc30
.long 0x380, 0x700, 0x8c0, 0xc40, 0x390, 0x710, 0x8d0, 0xc50
.long 0x3a0, 0x720, 0x8e0, 0xc60, 0x3b0, 0x730, 0x8f0, 0xc70
.long 0x3c0, 0x740, 0x8800, 0xc80, 0x3d0, 0x750, 0x80000000, 0xc90
.long 0x3e0, 0x760, 0x80000000, 0xca0, 0x3f0, 0x770, 0x80000000, 0xcb0
.long 0x200, 0x780, 0xb00, 0xcc0, 0x210, 0x790, 0xb10, 0xcd0
.long 0x220, 0x7a0, 0xb20, 0xce0, 0x230, 0x7b0, 0xb30, 0xcf0
.long 0x240, 0x7c0, 0xb40, 0x8c00, 0x250, 0x7d0, 0xb50, 0x80000000
.long 0x260, 0x7e0, 0xb60, 0x80000000, 0x270, 0x7f0, 0xb70, 0x80000000
.long 0xf00, 0x10c0, 0xf10, 0x10d0, 0xf20, 0x10e0, 0xf30, 0x10f0
.long 0xf40, 0x9000, 0xf50, 0x80000000, 0xf60, 0x80000000, 0xf70, 0x80000000
.long 0xf80, 0x1300, 0xf90, 0x1310, 0xfa0, 0x1320, 0xfb0, 0x1330
.long 0xfc0, 0x1340, 0xfd0, 0x1350, 0xfe0, 0x1360, 0xff0, 0x1370
.long 0xe00, 0x1380, 0xe10, 0x1390, 0xe20, 0x13a0, 0xe30, 0x13b0
.long 0xe40, 0x13c0, 0xe50, 0x13d0, 0xe60, 0x13e0, 0xe70, 0x13f0
.long 0xe80, 0x1200, 0xe90, 0x1210, 0xea0, 0x1220, 0xeb0, 0x1230
.long 0xec0, 0x1240, 0xed0, 0x1250, 0xee0, 0x1260, 0xef0, 0x1270
.long 0x8e00, 0x1280, 0x80000000, 0x1290, 0x80000000, 0x12a0, 0x80000000, 0x12b0
.long 0x1100, 0x12c0, 0x1110, 0x12d0, 0x1120, 0x12e0, 0x1130, 0x12f0
.long 0x1140, 0x9200, 0x1150, 0x80000000, 0x1160, 0x80000000, 0x1170, 0x80000000
.long 0x1180, 0x80000000, 0x1190, 0x80000000, 0x11a0, 0x80000000, 0x11b0, 0x80000000
.long 0x11c0, 0x80000000, 0x11d0, 0x80000000, 0x11e0, 0x80000000, 0x11f0, 0x80000000
.long 0x1000, 0x80000000, 0x1010, 0x80000000, 0x1020, 0x80000000, 0x1030, 0x80000000
.long 0x1040, 0x80000000, 0x1050, 0x80000000, 0x1060, 0x80000000, 0x1070, 0x80000000
.long 0x1080, 0x80000000, 0x1090, 0x80000000, 0x10a0, 0x80000000, 0x10b0, 0x80000000
.long 0x80000000, 0x8280, 0x8600, 0x8b80, 0x80000000, 0x8290, 0x8610, 0x8b90
.long 0x80000000, 0x82a0, 0x8620, 0x8ba0, 0x1f0, 0x82b0, 0x8630, 0x8bb0
.long 0x8100, 0x82c0, 0x8640, 0x8bc0, 0x8110, 0x82d0, 0x8650, 0x8bd0
.long 0x8120, 0x82e0, 0x8660, 0x8be0, 0x8130, 0x82f0, 0x8670, 0x8bf0
.long 0x8140, 0x80000000, 0x8680, 0x8a00, 0x8150, 0x80000000, 0x8690, 0x8a10
.long 0x8160, 0x80000000, 0x86a0, 0x8a20, 0x8170, 0x5f0, 0x86b0, 0x8a30
.long 0x8180, 0x8500, 0x86c0, 0x8a40, 0x8190, 0x8510, 0x86d0, 0x8a50
.long 0x81a0, 0x8520, 0x86e0, 0x8a60, 0x81b0, 0x8530, 0x86f0, 0x8a70
.long 0x81c0, 0x8540, 0x80000000, 0x8a80, 0x81d0, 0x8550, 0x80000000, 0x8a90
.long 0x81e0, 0x8560, 0x80000000, 0x8aa0, 0x81f0, 0x8570, 0x9f0, 0x8ab0
.long 0x8000, 0x8580, 0x8900, 0x8ac0, 0x8010, 0x8590, 0x8910, 0x8ad0
.long 0x8020, 0x85a0, 0x8920, 0x8ae0, 0x8030, 0x85b0, 0x8930, 0x8af0
.long 0x8040, 0x85c0, 0x8940, 0x80000000, 0x8050, 0x85d0, 0x8950, 0x80000000
.long 0x8060, 0x85e0, 0x8960, 0x80000000, 0x8070, 0x85f0, 0x8970, 0xdf0
.long 0x8080, 0x8400, 0x8980, 0x8d00, 0x8090, 0x8410, 0x8990, 0x8d10
.long 0x80a0, 0x8420, 0x89a0, 0x8d20, 0x80b0, 0x8430, 0x89b0, 0x8d30
.long 0x80c0, 0x8440, 0x89c0, 0x8d40, 0x80d0, 0x8450, 0x89d0, 0x8d50
.long 0x80e0, 0x8460, 0x89e0, 0x8d60, 0x80f0, 0x8470, 0x89f0, 0x8d70
.long 0x80000000, 0x8480, 0x8800, 0x8d80, 0x80000000, 0x8490, 0x8810, 0x8d90
.long 0x80000000, 0x84a0, 0x8820, 0x8da0, 0x3f0, 0x84b0, 0x8830, 0x8db0
.long 0x8300, 0x84c0, 0x8840, 0x8dc0, 0x8310, 0x84d0, 0x8850, 0x8dd0
.long 0x8320, 0x84e0, 0x8860, 0x8de0, 0x8330, 0x84f0, 0x8870, 0x8df0
.long 0x8340, 0x80000000, 0x8880, 0x8c00, 0x8350, 0x80000000, 0x8890, 0x8c10
.long 0x8360, 0x80000000, 0x88a0, 0x8c20, 0x8370, 0x7f0, 0x88b0, 0x8c30
.long 0x8380, 0x8700, 0x88c0, 0x8c40, 0x8390, 0x8710, 0x88d0, 0x8c50
.long 0x83a0, 0x8720, 0x88e0, 0x8c60, 0x83b0, 0x8730, 0x88f0, 0x8c70
.long 0x83c0, 0x8740, 0x80000000, 0x8c80, 0x83d0, 0x8750, 0x80000000, 0x8c90
.long 0x83e0, 0x8760, 0x80000000, 0x8ca0, 0x83f0, 0x8770, 0xbf0, 0x8cb0
.long 0x8200, 0x8780, 0x8b00, 0x8cc0, 0x8210, 0x8790, 0x8b10, 0x8cd0
.long 0x8220, 0x87a0, 0x8b20, 0x8ce0, 0x8230, 0x87b0, 0x8b30, 0x8cf0
.long 0x8240, 0x87c0, 0x8b40, 0x80000000, 0x8250, 0x87d0, 0x8b50, 0x80000000
.long 0x8260, 0x87e0, 0x8b60, 0x80000000, 0x8270, 0x87f0, 0x8b70, 0xff0
.long 0x8f00, 0x90c0, 0x8f10, 0x90d0, 0x8f20, 0x90e0, 0x8f30, 0x90f0
.long 0x8f40, 0x80000000, 0x8f50, 0x80000000, 0x8f60, 0x80000000, 0x8f70, 0x13f0
.long 0x8f80, 0x9300, 0x8f90, 0x9310, 0x8fa0, 0x9320, 0x8fb0, 0x9330
.long 0x8fc0, 0x9340, 0x8fd0, 0x9350, 0x8fe0, 0x9360, 0x8ff0, 0x9370
.long 0x8e00, 0x9380, 0x8e10, 0x9390, 0x8e20, 0x93a0, 0x8e30, 0x93b0
.long 0x8e40, 0x93c0, 0x8e50, 0x93d0, 0x8e60, 0x93e0, 0x8e70, 0x93f0
.long 0x8e80, 0x9200, 0x8e90, 0x9210, 0x8ea0, 0x9220, 0x8eb0, 0x9230
.long 0x8ec0, 0x9240, 0x8ed0, 0x9250, 0x8ee0, 0x9260, 0x8ef0, 0x9270
.long 0x80000000, 0x9280, 0x80000000, 0x9290, 0x80000000, 0x92a0, 0x11f0, 0x92b0
.long 0x9100, 0x92c0, 0x9110, 0x92d0, 0x9120, 0x92e0, 0x9130, 0x92f0
.long 0x9140, 0x80000000, 0x9150, 0x80000000, 0x9160, 0x80000000, 0x9170, 0x80000000
.long 0x9180, 0x80000000, 0x9190, 0x80000000, 0x91a0, 0x80000000, 0x91b0, 0x80000000
.long 0x91c0, 0x80000000, 0x91d0, 0x80000000, 0x91e0, 0x80000000, 0x91f0, 0x80000000
.long 0x9000, 0x80000000, 0x9010, 0x80000000, 0x9020, 0x80000000, 0x9030, 0x80000000
.long 0x9040, 0x80000000, 0x9050, 0x80000000, 0x9060, 0x80000000, 0x9070, 0x80000000
.long 0x9080, 0x80000000, 0x9090, 0x80000000, 0x90a0, 0x80000000, 0x90b0, 0x80000000
.long 0x80000000, 0x1080, 0xc00, 0x980, 0x80000000, 0x1090, 0xc10, 0x990
.long 0x80000000, 0x10a0, 0xc20, 0x9a0, 0x80000000, 0x10b0, 0xc30, 0x9b0
.long 0x1300, 0x10c0, 0xc40, 0x9c0, 0x1310, 0x10d0, 0xc50, 0x9d0
.long 0x1320, 0x10e0, 0xc60, 0x9e0, 0x1330, 0x10f0, 0xc70, 0x9f0
.long 0x1340, 0x9000, 0xc80, 0x800, 0x1350, 0x80000000, 0xc90, 0x810
.long 0x1360, 0x80000000, 0xca0, 0x820, 0x1370, 0x80000000, 0xcb0, 0x830
.long 0x1380, 0xf00, 0xcc0, 0x840, 0x1390, 0xf10, 0xcd0, 0x850
.long 0x13a0, 0xf20, 0xce0, 0x860, 0x13b0, 0xf30, 0xcf0, 0x870
.long 0x13c0, 0xf40, 0x8c00, 0x880, 0x13d0, 0xf50, 0x80000000, 0x890
.long 0x13e0, 0xf60, 0x80000000, 0x8a0, 0x13f0, 0xf70, 0x80000000, 0x8b0
.long 0x1200, 0xf80, 0xb00, 0x8c0, 0x1210, 0xf90, 0xb10, 0x8d0
.long 0x1220, 0xfa0, 0xb20, 0x8e0, 0x1230, 0xfb0, 0xb30, 0x8f0
.long 0x1240, 0xfc0, 0xb40, 0x8800, 0x1250, 0xfd0, 0xb50, 0x80000000
.long 0x1260, 0xfe0, 0xb60, 0x80000000, 0x1270, 0xff0, 0xb70, 0x80000000
.long 0x1280, 0xe00, 0xb80, 0x700, 0x1290, 0xe10, 0xb90, 0x710
.long 0x12a0, 0xe20, 0xba0, 0x720, 0x12b0, 0xe30, 0xbb0, 0x730
.long 0x12c0, 0xe40, 0xbc0, 0x740, 0x12d0, 0xe50, 0xbd0, 0x750
.long 0x12e0, 0xe60, 0xbe0, 0x760, 0x12f0, 0xe70, 0xbf0, 0x770
.long 0x9200, 0xe80, 0xa00, 0x780, 0x80000000, 0xe90, 0xa10, 0x790
.long 0x80000000, 0xea0, 0xa20, 0x7a0, 0x80000000, 0xeb0, 0xa30, 0x7b0
.long 0x1100, 0xec0, 0xa40, 0x7c0, 0x1110, 0xed0, 0xa50, 0x7d0
.long 0x1120, 0xee0, 0xa60, 0x7e0, 0x1130, 0xef0, 0xa70, 0x7f0
.long 0x1140, 0x8e00, 0xa80, 0x600, 0x1150, 0x80000000, 0xa90, 0x610
.long 0x1160, 0x80000000, 0xaa0, 0x620, 0x1170, 0x80000000, 0xab0, 0x630
.long 0x1180, 0xd00, 0xac0, 0x640, 0x1190, 0xd10, 0xad0, 0x650
.long 0x11a0, 0xd20, 0xae0, 0x660, 0x11b0, 0xd30, 0xaf0, 0x670
.long 0x11c0, 0xd40, 0x8a00, 0x680, 0x11d0, 0xd50, 0x80000000, 0x690
.long 0x11e0, 0xd60, 0x80000000, 0x6a0, 0x11f0, 0xd70, 0x80000000, 0x6b0
.long 0x1000, 0xd80, 0x900, 0x6c0, 0x1010, 0xd90, 0x910, 0x6d0
.long 0x1020, 0xda0, 0x920, 0x6e0, 0x1030, 0xdb0, 0x930, 0x6f0
.long 0x1040, 0xdc0, 0x940, 0x8600, 0x1050, 0xdd0, 0x950, 0x80000000
.long 0x1060, 0xde0, 0x960, 0x80000000, 0x1070, 0xdf0, 0x970, 0x80000000
.long 0x500, 0x2c0, 0x510, 0x2d0, 0x520, 0x2e0, 0x530, 0x2f0
.long 0x540, 0x8200, 0x550, 0x80000000, 0x560, 0x80000000, 0x570, 0x80000000
.long 0x580, 0x100, 0x590, 0x110, 0x5a0, 0x120, 0x5b0, 0x130
.long 0x5c0, 0x140, 0x5d0, 0x150, 0x5e0, 0x160, 0x5f0, 0x170
.long 0x400, 0x180, 0x410, 0x190, 0x420, 0x1a0, 0x430, 0x1b0
.long 0x440, 0x1c0, 0x450, 0x1d0, 0x460, 0x1e0, 0x470, 0x1f0
.long 0x480, 0x0, 0x490, 0x10, 0x4a0, 0x20, 0x4b0, 0x30
.long 0x4c0, 0x40, 0x4d0, 0x50, 0x4e0, 0x60, 0x4f0, 0x70
.long 0x8400, 0x80, 0x80000000, 0x90, 0x80000000, 0xa0, 0x80000000, 0xb0
.long 0x300, 0xc0, 0x310, 0xd0, 0x320, 0xe0, 0x330, 0xf0
.long 0x340, 0x8000, 0x350, 0x80000000, 0x360, 0x80000000, 0x370, 0x80000000
.long 0x380, 0x80000000, 0x390, 0x80000000, 0x3a0, 0x80000000, 0x3b0, 0x80000000
.long 0x3c0, 0x80000000, 0x3d0, 0x80000000, 0x3e0, 0x80000000, 0x3f0, 0x80000000
.long 0x200, 0x80000000, 0x210, 0x80000000, 0x220, 0x80000000, 0x230, 0x80000000
.long 0x240, 0x80000000, 0x250, 0x80000000, 0x260, 0x80000000, 0x270, 0x80000000
.long 0x280, 0x80000000, 0x290, 0x80000000, 0x2a0, 0x80000000, 0x2b0, 0x80000000
.long 0x80000000, 0x9080, 0x8c00, 0x8980, 0x80000000, 0x9090, 0x8c10, 0x8990
.long 0x80000000, 0x90a0, 0x8c20, 0x89a0, 0x13f0, 0x90b0, 0x8c30, 0x89b0
.long 0x9300, 0x90c0, 0x8c40, 0x89c0, 0x9310, 0x90d0, 0x8c50, 0x89d0
.long 0x9320, 0x90e0, 0x8c60, 0x89e0, 0x9330, 0x90f0, 0x8c70, 0x89f0
.long 0x9340, 0x80000000, 0x8c80, 0x8800, 0x9350, 0x80000000, 0x8c90, 0x8810
.long 0x9360, 0x80000000, 0x8ca0, 0x8820, 0x9370, 0xff0, 0x8cb0, 0x8830
.long 0x9380, 0x8f00, 0x8cc0, 0x8840, 0x9390, 0x8f10, 0x8cd0, 0x8850
.long 0x93a0, 0x8f20, 0x8ce0, 0x8860, 0x93b0, 0x8f30, 0x8cf0, 0x8870
.long 0x93c0, 0x8f40, 0x80000000, 0x8880, 0x93d0, 0x8f50, 0x80000000, 0x8890
.long 0x93e0, 0x8f60, 0x80000000, 0x88a0, 0x93f0, 0x8f70, 0xbf0, 0x88b0
.long 0x9200, 0x8f80, 0x8b00, 0x88c0, 0x9210, 0x8f90, 0x8b10, 0x88d0
.long 0x9220, 0x8fa0, 0x8b20, 0x88e0, 0x9230, 0x8fb0, 0x8b30, 0x88f0
.long 0x9240, 0x8fc0, 0x8b40, 0x80000000, 0x9250, 0x8fd0, 0x8b50, 0x80000000
.long 0x9260, 0x8fe0, 0x8b60, 0x80000000, 0x9270, 0x8ff0, 0x8b70, 0x7f0
.long 0x9280, 0x8e00, 0x8b80, 0x8700, 0x9290, 0x8e10, 0x8b90, 0x8710
.long 0x92a0, 0x8e20, 0x8ba0, 0x8720, 0x92b0, 0x8e30, 0x8bb0, 0x8730
.long 0x92c0, 0x8e40, 0x8bc0, 0x8740, 0x92d0, 0x8e50, 0x8bd0, 0x8750
.long 0x92e0, 0x8e60, 0x8be0, 0x8760, 0x92f0, 0x8e70, 0x8bf0, 0x8770
.long 0x80000000, 0x8e80, 0x8a00, 0x8780, 0x80000000, 0x8e90, 0x8a10, 0x8790
.long 0x80000000, 0x8ea0, 0x8a20, 0x87a0, 0x11f0, 0x8eb0, 0x8a30, 0x87b0
.long 0x9100, 0x8ec0, 0x8a40, 0x87c0, 0x9110, 0x8ed0, 0x8a50, 0x87d0
.long 0x9120, 0x8ee0, 0x8a60, 0x87e0, 0x9130, 0x8ef0, 0x8a70, 0x87f0
.long 0x9140, 0x80000000, 0x8a80, 0x8600, 0x9150, 0x80000000, 0x8a90, 0x8610
.long 0x9160, 0x80000000, 0x8aa0, 0x8620, 0x9170, 0xdf0, 0x8ab0, 0x8630
.long 0x9180, 0x8d00, 0x8ac0, 0x8640, 0x9190, 0x8d10, 0x8ad0, 0x8650
.long 0x91a0, 0x8d20, 0x8ae0, 0x8660, 0x91b0, 0x8d30, 0x8af0, 0x8670
.long 0x91c0, 0x8d40, 0x80000000, 0x8680, 0x91d0, 0x8d50, 0x80000000, 0x8690
.long 0x91e0, 0x8d60, 0x80000000, 0x86a0, 0x91f0, 0x8d70, 0x9f0, 0x86b0
.long 0x9000, 0x8d80, 0x8900, 0x86c0, 0x9010, 0x8d90, 0x8910, 0x86d0
.long 0x9020, 0x8da0, 0x8920, 0x86e0, 0x9030, 0x8db0, 0x8930, 0x86f0
.long 0x9040, 0x8dc0, 0x8940, 0x80000000, 0x9050, 0x8dd0, 0x8950, 0x80000000
.long 0x9060, 0x8de0, 0x8960, 0x80000000, 0x9070, 0x8df0, 0x8970, 0x5f0
.long 0x8500, 0x82c0, 0x8510, 0x82d0, 0x8520, 0x82e0, 0x8530, 0x82f0
.long 0x8540, 0x80000000, 0x8550, 0x80000000, 0x8560, 0x80000000, 0x8570, 0x1f0
.long 0x8580, 0x8100, 0x8590, 0x8110, 0x85a0, 0x8120, 0x85b0, 0x8130
.long 0x85c0, 0x8140, 0x85d0, 0x8150, 0x85e0, 0x8160, 0x85f0, 0x8170
.long 0x8400, 0x8180, 0x8410, 0x8190, 0x8420, 0x81a0, 0x8430, 0x81b0
.long 0x8440, 0x81c0, 0x8450, 0x81d0, 0x8460, 0x81e0, 0x8470, 0x81f0
.long 0x8480, 0x8000, 0x8490, 0x8010, 0x84a0, 0x8020, 0x84b0, 0x8030
.long 0x84c0, 0x8040, 0x84d0, 0x8050, 0x84e0, 0x8060, 0x84f0, 0x8070
.long 0x80000000, 0x8080, 0x80000000, 0x8090, 0x80000000, 0x80a0, 0x3f0, 0x80b0
.long 0x8300, 0x80c0, 0x8310, 0x80d0, 0x8320, 0x80e0, 0x8330, 0x80f0
.long 0x8340, 0x80000000, 0x8350, 0x80000000, 0x8360, 0x80000000, 0x8370, 0x80000000
.long 0x8380, 0x80000000, 0x8390, 0x80000000, 0x83a0, 0x80000000, 0x83b0, 0x80000000
.long 0x83c0, 0x80000000, 0x83d0, 0x80000000, 0x83e0, 0x80000000, 0x83f0, 0x80000000
.long 0x8200, 0x80000000, 0x8210, 0x80000000, 0x8220, 0x80000000, 0x8230, 0x80000000
.long 0x8240, 0x80000000, 0x8250, 0x80000000, 0x8260, 0x80000000, 0x8270, 0x80000000
.long 0x8280, 0x80000000, 0x8290, 0x80000000, 0x82a0, 0x80000000, 0x82b0, 0x80000000
```
